```python
import torch

def _softmax(x, axis=-1):
    return torch.softmax(x, dim=axis)
def _gelu(x):
    return torch.nn.functional.gelu(x, approximate="tanh")
def _silu(x):
    return torch.nn.functional.silu(x)
def _sigmoid(x):
    return torch.sigmoid(x)
def _layernorm(x, axis=-1, eps=1e-5):
    m = x.mean(dim=axis, keepdim=True)
    v = x.var(dim=axis, keepdim=True, unbiased=False)
    return (x - m) / torch.sqrt(v + eps)
def _scatter_add(tgt, idx, src, axis=0):
    return tgt.clone().index_add_(axis, idx, src)
def _segment_sum(src, seg, n):
    out = torch.zeros((n,) + src.shape[1:], dtype=src.dtype)
    return out.index_add_(0, seg, src)
def _pad(x, pw):
    flat = tuple(v for pair in reversed(pw) for v in pair)
    return torch.nn.functional.pad(x, flat)

kernel_name = 'gated_mix__mha_block__linear_attn_block__prompt'

def setup_inputs():

    _w = (lambda a: (lambda t: t.to(torch.bfloat16) if t.is_floating_point() else t)(torch.as_tensor(a)))
    def _A_setup():
        B, S, D, H = 1, 2048, 576, 32
        return {
            "x": _w((lambda *s: torch.randn(*s, dtype=torch.bfloat16) * 0.05)(B, S, D)),
            "wqkv": _w((lambda *s: torch.randn(*s, dtype=torch.bfloat16) * 0.8)(D, 3 * D)),
            "wo": _w((lambda *s: torch.randn(*s, dtype=torch.bfloat16) * 0.05)(D, D)),
        }
    _A_in = _A_setup()

    def _B_setup():
        B, S, D = 1, 2048, 576
        return {
            "x": _w((lambda *s: torch.randn(*s, dtype=torch.bfloat16) * 0.05)(B, S, D)),
            "wqkv": _w((lambda *s: torch.randn(*s, dtype=torch.bfloat16) * 0.8)(D, 3 * D)),
            "wo": _w((lambda *s: torch.randn(*s, dtype=torch.bfloat16) * 0.1)(D, D)),
        }
    _B_in = _B_setup()

    return {
        "A_x": _A_in["x"],
        "A_wqkv": _A_in["wqkv"],
        "A_wo": _A_in["wo"],
        "B_x": _B_in["x"],
        "B_wqkv": _B_in["wqkv"],
        "B_wo": _B_in["wo"],
        "gate_w": _w((lambda *s: torch.randn(*s, dtype=torch.bfloat16) * 0.05)(576) * 16.0),
    }

def reference(A_x, A_wqkv, A_wo, B_x, B_wqkv, B_wo, gate_w):
    def _A_ref(x, wqkv, wo):
        B, S, D = x.shape
        H = 32
        Dh = D // H
        qkv = (lambda x, *d: x.permute(*d))((x @ wqkv).reshape(B, S, 3, H, Dh), 2, 0, 3, 1, 4)
        q, k, v = qkv[0], qkv[1], qkv[2]
        scores = torch.einsum("bhqd,bhkd->bhqk", q, k) * (Dh ** -0.5)
        p = _softmax(scores, axis=-1)
        o = torch.einsum("bhqk,bhkd->bhqd", p, v)
        return (lambda x, *d: x.permute(*d))(o, 0, 2, 1, 3).reshape(B, S, D) @ wo

    def _B_ref(x, wqkv, wo):
        B, S, D = x.shape
        H = 32; Dh = D // H
        qkv = (lambda x, *d: x.permute(*d))((x @ wqkv).reshape(B, S, 3, H, Dh), 2, 0, 3, 1, 4)
        q, k, v = qkv[0], qkv[1], qkv[2]
        phi = lambda t: torch.where(t > 0, t + 1, torch.exp(t)) + 1e-6
        pq, pk = phi(q), phi(k)
        kv = torch.einsum("bhsd,bhse->bhde", pk, v)
        z = torch.einsum("bhsd->bhd", pk)
        num = torch.einsum("bhqd,bhde->bhqe", pq, kv)
        den = torch.einsum("bhqd,bhd->bhq", pq, z)[..., None] + 1e-6
        o = num / den
        return (lambda x, *d: x.permute(*d))(o, 0, 2, 1, 3).reshape(B, S, D) @ wo

    x = A_x
    g = _sigmoid((x * gate_w).sum(-1, keepdims=True))
    a = _A_ref(x, A_wqkv, A_wo)
    b = _B_ref(x, B_wqkv, B_wo)
    return g * a + (1 - g) * b
```

```asm
; @launch grid=(256,1,1) block=(768,1,1) lds=153600
.amdgcn_target "amdgcn-amd-amdhsa--gfx950"
.text
.p2align 8
.globl gated_mix__mha_block__linear_attn_block__prompt_kernel
.type gated_mix__mha_block__linear_attn_block__prompt_kernel,@function
gated_mix__mha_block__linear_attn_block__prompt_kernel:
  s_cmp_ge_u32 s2, 256
  s_cbranch_scc1 K2_END
  s_load_dwordx4 s[4:7], s[0:1], 0
  s_load_dwordx2 s[8:9], s[0:1], 32
  s_load_dwordx2 s[10:11], s[0:1], 48
  s_load_dwordx2 s[12:13], s[0:1], 72
  s_load_dwordx2 s[14:15], s[0:1], 16
  s_load_dwordx2 s[32:33], s[0:1], 40
  s_load_dwordx2 s[82:83], s[0:1], 64
  v_lshrrev_b32 v1, 6, v0
  v_and_b32 v2, 63, v0
  v_readfirstlane_b32 s36, v1
  s_and_b32 s37, s2, 7
  s_lshr_b32 s38, s2, 3
  s_and_b32 s39, s37, 1
  s_lshl_b32 s39, s39, 3
  s_and_b32 s40, s38, 7
  s_add_u32 s39, s39, s40
  s_lshr_b32 s40, s37, 1
  s_lshl_b32 s40, s40, 2
  s_lshr_b32 s41, s38, 3
  s_add_u32 s40, s40, s41
  s_lshr_b32 s41, s40, 3
  s_and_b32 s42, s40, 7
  s_and_b32 s43, s36, 1
  s_bfe_u32 s44, s36, 0x10001
  s_cmp_ge_u32 s36, 8
  s_cbranch_scc1 K1_HELPER
  s_cmp_lt_u32 s36, 4
  s_cbranch_scc1 K1_COMPUTE
  s_mov_b32 s34, 0xF7FFFFFF
  s_mov_b32 s35, 0x007FFFFF
  v_cmp_le_u32 vcc, 28, v2
  v_mov_b32 v4, 0
  v_mov_b32 v5, 3008
  v_cndmask_b32 v4, v4, v5, vcc
  v_lshl_add_u32 v3, v2, 4, v4
  s_mul_i32 s58, s42, 432
  v_add_u32 v3, s58, v3
  v_lshrrev_b32 v5, 3, v2
  v_and_b32 v6, 7, v2
  v_and_b32 v7, 2, v5
  v_lshlrev_b32 v7, 1, v7
  s_lshl_b32 s58, s43, 1
  v_or_b32 v7, s58, v7
  v_xor_b32 v6, v6, v7
  v_mul_u32_u24 v5, 1152, v5
  v_lshl_add_u32 v4, v6, 4, v5
  s_mul_i32 s60, s44, 7200
  s_mul_i32 s58, s43, 3616
  s_add_u32 s60, s60, s58
  s_and_b32 s58, s36, 3
  s_mul_i32 s61, s58, 27648
  s_lshl_b32 s58, s43, 1
  s_lshl_b32 s59, s44, 3
  s_add_u32 s58, s58, s59
  s_lshl_b32 s62, s58, 10
  s_add_u32 s62, s62, 86400
  s_lshl_b32 s59, s39, 4
  s_add_u32 s58, s58, s59
  s_mul_i32 s63, s58, 9216
  s_and_b32 s58, s38, 7
  s_lshr_b32 s59, s38, 3
  s_lshl_b32 s59, s59, 1
  s_add_u32 s58, s58, s59
  s_sub_u32 s59, s58, 9
  s_cmp_ge_u32 s58, 9
  s_cselect_b32 s66, s59, s58
  s_waitcnt lgkmcnt(0)
  s_mov_b32 s16, s4
  s_mov_b32 s17, s5
  s_mov_b32 s18, 2359296
  s_mov_b32 s19, 0x00020000
  s_cmp_eq_u32 s41, 0
  s_cselect_b32 s20, s6, s8
  s_cselect_b32 s21, s7, s9
  s_mov_b32 s22, 1990656
  s_mov_b32 s23, 0x00020000
  s_mov_b32 s28, s10
  s_mov_b32 s29, s11
  s_mov_b32 s30, 1152
  s_mov_b32 s31, 0x00020000
  s_add_u32 s67, s66, 0
  s_sub_u32 s58, s67, 9
  s_cmp_ge_u32 s67, 9
  s_cselect_b32 s67, s58, s67
  s_lshl_b32 s69, s67, 7
  s_add_u32 s69, s69, s63
  s_add_u32 m0, s62, 0
  s_add_u32 s65, s69, 0
  buffer_load_dwordx4 v4, s[16:19], s65 offen lds
  s_add_u32 m0, s62, 1024
  s_add_u32 s65, s69, 9216
  buffer_load_dwordx4 v4, s[16:19], s65 offen lds
  s_add_u32 m0, s62, 4096
  s_add_u32 s65, s69, 36864
  buffer_load_dwordx4 v4, s[16:19], s65 offen lds
  s_add_u32 m0, s62, 5120
  s_add_u32 s65, s69, 46080
  buffer_load_dwordx4 v4, s[16:19], s65 offen lds
  s_add_u32 s67, s66, 0
  s_sub_u32 s58, s67, 9
  s_cmp_ge_u32 s67, 9
  s_cselect_b32 s67, s58, s67
  s_mul_i32 s68, s67, 221184
  s_add_u32 s68, s68, s61
  s_mov_b64 exec, s[34:35]
  s_add_u32 m0, s60, 0
  s_add_u32 s64, s68, 0
  buffer_load_dwordx4 v3, s[20:23], s64 offen lds
  s_add_u32 m0, s60, 896
  s_add_u32 s64, s68, 6912
  buffer_load_dwordx4 v3, s[20:23], s64 offen lds
  s_add_u32 m0, s60, 1792
  s_add_u32 s64, s68, 13824
  buffer_load_dwordx4 v3, s[20:23], s64 offen lds
  s_add_u32 m0, s60, 2688
  s_add_u32 s64, s68, 20736
  buffer_load_dwordx4 v3, s[20:23], s64 offen lds
  s_mov_b64 exec, -1
  s_lshl_b32 s72, s40, 3
  s_or_b32 s72, s72, s36
  s_cmp_lg_u32 s72, 4
  s_cbranch_scc1 K1_NGL
  v_lshlrev_b32 v19, 1, v2
  s_add_u32 s67, s66, 0
  s_sub_u32 s58, s67, 9
  s_cmp_ge_u32 s67, 9
  s_cselect_b32 s67, s58, s67
  s_lshl_b32 s58, s67, 7
  buffer_load_ushort v41, v19, s[28:31], s58 offen
  s_add_u32 s67, s66, 1
  s_sub_u32 s58, s67, 9
  s_cmp_ge_u32 s67, 9
  s_cselect_b32 s67, s58, s67
  s_lshl_b32 s58, s67, 7
  buffer_load_ushort v42, v19, s[28:31], s58 offen
  s_add_u32 s67, s66, 2
  s_sub_u32 s58, s67, 9
  s_cmp_ge_u32 s67, 9
  s_cselect_b32 s67, s58, s67
  s_lshl_b32 s58, s67, 7
  buffer_load_ushort v43, v19, s[28:31], s58 offen
  s_add_u32 s67, s66, 3
  s_sub_u32 s58, s67, 9
  s_cmp_ge_u32 s67, 9
  s_cselect_b32 s67, s58, s67
  s_lshl_b32 s58, s67, 7
  buffer_load_ushort v44, v19, s[28:31], s58 offen
  s_add_u32 s67, s66, 4
  s_sub_u32 s58, s67, 9
  s_cmp_ge_u32 s67, 9
  s_cselect_b32 s67, s58, s67
  s_lshl_b32 s58, s67, 7
  buffer_load_ushort v45, v19, s[28:31], s58 offen
  s_add_u32 s67, s66, 5
  s_sub_u32 s58, s67, 9
  s_cmp_ge_u32 s67, 9
  s_cselect_b32 s67, s58, s67
  s_lshl_b32 s58, s67, 7
  buffer_load_ushort v46, v19, s[28:31], s58 offen
  s_add_u32 s67, s66, 6
  s_sub_u32 s58, s67, 9
  s_cmp_ge_u32 s67, 9
  s_cselect_b32 s67, s58, s67
  s_lshl_b32 s58, s67, 7
  buffer_load_ushort v47, v19, s[28:31], s58 offen
  s_add_u32 s67, s66, 7
  s_sub_u32 s58, s67, 9
  s_cmp_ge_u32 s67, 9
  s_cselect_b32 s67, s58, s67
  s_lshl_b32 s58, s67, 7
  buffer_load_ushort v48, v19, s[28:31], s58 offen
  s_add_u32 s67, s66, 8
  s_sub_u32 s58, s67, 9
  s_cmp_ge_u32 s67, 9
  s_cselect_b32 s67, s58, s67
  s_lshl_b32 s58, s67, 7
  buffer_load_ushort v49, v19, s[28:31], s58 offen
K1_NGL:
  s_mov_b64 exec, s[34:35]
  s_add_u32 m0, s60, 14400
  s_add_u32 s64, s68, 110592
  buffer_load_dwordx4 v3, s[20:23], s64 offen lds
  s_add_u32 m0, s60, 15296
  s_add_u32 s64, s68, 117504
  buffer_load_dwordx4 v3, s[20:23], s64 offen lds
  s_add_u32 m0, s60, 16192
  s_add_u32 s64, s68, 124416
  buffer_load_dwordx4 v3, s[20:23], s64 offen lds
  s_add_u32 m0, s60, 17088
  s_add_u32 s64, s68, 131328
  buffer_load_dwordx4 v3, s[20:23], s64 offen lds
  s_mov_b64 exec, -1
  v_bfe_u32 v6, v2, 4, 1
  v_mul_u32_u24 v18, 7200, v6
  v_and_b32 v6, 15, v2
  v_mul_u32_u24 v6, 448, v6
  v_add_u32 v18, v18, v6
  v_bfe_u32 v6, v2, 3, 1
  v_lshl_add_u32 v18, v6, 5, v18
  v_lshrrev_b32 v6, 5, v2
  v_mul_u32_u24 v6, 14400, v6
  v_add_u32 v18, v18, v6
  v_add_u32 v18, 432, v18
  v_add_u32 v17, 57600, v18
  s_waitcnt vmcnt(4)
  s_cmp_lg_u32 s72, 4
  s_cbranch_scc1 K1_NG0
  ds_write_b16 v18, v41 offset:0
K1_NG0:
  s_cmp_lg_u32 s72, 4
  s_cbranch_scc1 K1_NG1
  ds_write_b16 v18, v42 offset:28800
K1_NG1:
  s_cmp_lg_u32 s72, 4
  s_cbranch_scc1 K1_NG2
  ds_write_b16 v17, v43
K1_NG2:
  s_waitcnt lgkmcnt(0)
  s_barrier
  s_add_u32 s67, s66, 1
  s_sub_u32 s58, s67, 9
  s_cmp_ge_u32 s67, 9
  s_cselect_b32 s67, s58, s67
  s_lshl_b32 s69, s67, 7
  s_add_u32 s69, s69, s63
  s_add_u32 m0, s62, 16384
  s_add_u32 s65, s69, 0
  buffer_load_dwordx4 v4, s[16:19], s65 offen lds
  s_add_u32 m0, s62, 17408
  s_add_u32 s65, s69, 9216
  buffer_load_dwordx4 v4, s[16:19], s65 offen lds
  s_add_u32 m0, s62, 20480
  s_add_u32 s65, s69, 36864
  buffer_load_dwordx4 v4, s[16:19], s65 offen lds
  s_add_u32 m0, s62, 21504
  s_add_u32 s65, s69, 46080
  buffer_load_dwordx4 v4, s[16:19], s65 offen lds
  s_add_u32 s67, s66, 1
  s_sub_u32 s58, s67, 9
  s_cmp_ge_u32 s67, 9
  s_cselect_b32 s67, s58, s67
  s_mul_i32 s68, s67, 221184
  s_add_u32 s68, s68, s61
  s_mov_b64 exec, s[34:35]
  s_add_u32 m0, s60, 28800
  s_add_u32 s64, s68, 0
  buffer_load_dwordx4 v3, s[20:23], s64 offen lds
  s_add_u32 m0, s60, 29696
  s_add_u32 s64, s68, 6912
  buffer_load_dwordx4 v3, s[20:23], s64 offen lds
  s_add_u32 m0, s60, 30592
  s_add_u32 s64, s68, 13824
  buffer_load_dwordx4 v3, s[20:23], s64 offen lds
  s_add_u32 m0, s60, 31488
  s_add_u32 s64, s68, 20736
  buffer_load_dwordx4 v3, s[20:23], s64 offen lds
  s_mov_b64 exec, -1
  s_mov_b64 exec, s[34:35]
  s_add_u32 m0, s60, 43200
  s_add_u32 s64, s68, 110592
  buffer_load_dwordx4 v3, s[20:23], s64 offen lds
  s_add_u32 m0, s60, 44096
  s_add_u32 s64, s68, 117504
  buffer_load_dwordx4 v3, s[20:23], s64 offen lds
  s_add_u32 m0, s60, 44992
  s_add_u32 s64, s68, 124416
  buffer_load_dwordx4 v3, s[20:23], s64 offen lds
  s_add_u32 m0, s60, 45888
  s_add_u32 s64, s68, 131328
  buffer_load_dwordx4 v3, s[20:23], s64 offen lds
  s_mov_b64 exec, -1
  s_waitcnt vmcnt(12)
  s_waitcnt lgkmcnt(0)
  s_barrier
  s_add_u32 s67, s66, 2
  s_sub_u32 s58, s67, 9
  s_cmp_ge_u32 s67, 9
  s_cselect_b32 s67, s58, s67
  s_lshl_b32 s69, s67, 7
  s_add_u32 s69, s69, s63
  s_add_u32 m0, s62, 32768
  s_add_u32 s65, s69, 0
  buffer_load_dwordx4 v4, s[16:19], s65 offen lds
  s_add_u32 m0, s62, 33792
  s_add_u32 s65, s69, 9216
  buffer_load_dwordx4 v4, s[16:19], s65 offen lds
  s_add_u32 m0, s62, 36864
  s_add_u32 s65, s69, 36864
  buffer_load_dwordx4 v4, s[16:19], s65 offen lds
  s_add_u32 m0, s62, 37888
  s_add_u32 s65, s69, 46080
  buffer_load_dwordx4 v4, s[16:19], s65 offen lds
  s_add_u32 s67, s66, 2
  s_sub_u32 s58, s67, 9
  s_cmp_ge_u32 s67, 9
  s_cselect_b32 s67, s58, s67
  s_mul_i32 s68, s67, 221184
  s_add_u32 s68, s68, s61
  s_mov_b64 exec, s[34:35]
  s_add_u32 m0, s60, 57600
  s_add_u32 s64, s68, 0
  buffer_load_dwordx4 v3, s[20:23], s64 offen lds
  s_add_u32 m0, s60, 58496
  s_add_u32 s64, s68, 6912
  buffer_load_dwordx4 v3, s[20:23], s64 offen lds
  s_add_u32 m0, s60, 59392
  s_add_u32 s64, s68, 13824
  buffer_load_dwordx4 v3, s[20:23], s64 offen lds
  s_add_u32 m0, s60, 60288
  s_add_u32 s64, s68, 20736
  buffer_load_dwordx4 v3, s[20:23], s64 offen lds
  s_mov_b64 exec, -1
  s_mov_b64 exec, s[34:35]
  s_add_u32 m0, s60, 72000
  s_add_u32 s64, s68, 110592
  buffer_load_dwordx4 v3, s[20:23], s64 offen lds
  s_add_u32 m0, s60, 72896
  s_add_u32 s64, s68, 117504
  buffer_load_dwordx4 v3, s[20:23], s64 offen lds
  s_add_u32 m0, s60, 73792
  s_add_u32 s64, s68, 124416
  buffer_load_dwordx4 v3, s[20:23], s64 offen lds
  s_add_u32 m0, s60, 74688
  s_add_u32 s64, s68, 131328
  buffer_load_dwordx4 v3, s[20:23], s64 offen lds
  s_mov_b64 exec, -1
  s_waitcnt vmcnt(16)
  s_waitcnt lgkmcnt(0)
  s_barrier
  s_add_u32 s67, s66, 3
  s_sub_u32 s58, s67, 9
  s_cmp_ge_u32 s67, 9
  s_cselect_b32 s67, s58, s67
  s_lshl_b32 s69, s67, 7
  s_add_u32 s69, s69, s63
  s_add_u32 m0, s62, 49152
  s_add_u32 s65, s69, 0
  buffer_load_dwordx4 v4, s[16:19], s65 offen lds
  s_add_u32 m0, s62, 50176
  s_add_u32 s65, s69, 9216
  buffer_load_dwordx4 v4, s[16:19], s65 offen lds
  s_add_u32 m0, s62, 53248
  s_add_u32 s65, s69, 36864
  buffer_load_dwordx4 v4, s[16:19], s65 offen lds
  s_add_u32 m0, s62, 54272
  s_add_u32 s65, s69, 46080
  buffer_load_dwordx4 v4, s[16:19], s65 offen lds
  s_add_u32 s67, s66, 3
  s_sub_u32 s58, s67, 9
  s_cmp_ge_u32 s67, 9
  s_cselect_b32 s67, s58, s67
  s_mul_i32 s68, s67, 221184
  s_add_u32 s68, s68, s61
  s_mov_b64 exec, s[34:35]
  s_add_u32 m0, s60, 0
  s_add_u32 s64, s68, 0
  buffer_load_dwordx4 v3, s[20:23], s64 offen lds
  s_add_u32 m0, s60, 896
  s_add_u32 s64, s68, 6912
  buffer_load_dwordx4 v3, s[20:23], s64 offen lds
  s_add_u32 m0, s60, 1792
  s_add_u32 s64, s68, 13824
  buffer_load_dwordx4 v3, s[20:23], s64 offen lds
  s_add_u32 m0, s60, 2688
  s_add_u32 s64, s68, 20736
  buffer_load_dwordx4 v3, s[20:23], s64 offen lds
  s_mov_b64 exec, -1
  s_mov_b64 exec, s[34:35]
  s_add_u32 m0, s60, 14400
  s_add_u32 s64, s68, 110592
  buffer_load_dwordx4 v3, s[20:23], s64 offen lds
  s_add_u32 m0, s60, 15296
  s_add_u32 s64, s68, 117504
  buffer_load_dwordx4 v3, s[20:23], s64 offen lds
  s_add_u32 m0, s60, 16192
  s_add_u32 s64, s68, 124416
  buffer_load_dwordx4 v3, s[20:23], s64 offen lds
  s_add_u32 m0, s60, 17088
  s_add_u32 s64, s68, 131328
  buffer_load_dwordx4 v3, s[20:23], s64 offen lds
  s_mov_b64 exec, -1
  s_add_u32 s67, s66, 4
  s_sub_u32 s58, s67, 9
  s_cmp_ge_u32 s67, 9
  s_cselect_b32 s67, s58, s67
  s_lshl_b32 s69, s67, 7
  s_add_u32 s69, s69, s63
  s_add_u32 m0, s62, 0
  s_add_u32 s65, s69, 0
  buffer_load_dwordx4 v4, s[16:19], s65 offen lds
  s_add_u32 m0, s62, 1024
  s_add_u32 s65, s69, 9216
  buffer_load_dwordx4 v4, s[16:19], s65 offen lds
  s_cmp_lg_u32 s72, 4
  s_cbranch_scc1 K1_NG3
  ds_write_b16 v18, v44 offset:0
K1_NG3:
  s_waitcnt vmcnt(26)
  s_waitcnt lgkmcnt(0)
  s_barrier
  s_add_u32 m0, s62, 4096
  s_add_u32 s65, s69, 36864
  buffer_load_dwordx4 v4, s[16:19], s65 offen lds
  s_add_u32 m0, s62, 5120
  s_add_u32 s65, s69, 46080
  buffer_load_dwordx4 v4, s[16:19], s65 offen lds
  s_add_u32 s67, s66, 4
  s_sub_u32 s58, s67, 9
  s_cmp_ge_u32 s67, 9
  s_cselect_b32 s67, s58, s67
  s_mul_i32 s68, s67, 221184
  s_add_u32 s68, s68, s61
  s_mov_b64 exec, s[34:35]
  s_add_u32 m0, s60, 28800
  s_add_u32 s64, s68, 0
  buffer_load_dwordx4 v3, s[20:23], s64 offen lds
  s_add_u32 m0, s60, 29696
  s_add_u32 s64, s68, 6912
  buffer_load_dwordx4 v3, s[20:23], s64 offen lds
  s_add_u32 m0, s60, 30592
  s_add_u32 s64, s68, 13824
  buffer_load_dwordx4 v3, s[20:23], s64 offen lds
  s_add_u32 m0, s60, 31488
  s_add_u32 s64, s68, 20736
  buffer_load_dwordx4 v3, s[20:23], s64 offen lds
  s_mov_b64 exec, -1
  s_waitcnt vmcnt(24)
  s_waitcnt lgkmcnt(0)
  s_barrier
  s_add_u32 s67, s66, 5
  s_sub_u32 s58, s67, 9
  s_cmp_ge_u32 s67, 9
  s_cselect_b32 s67, s58, s67
  s_lshl_b32 s69, s67, 7
  s_add_u32 s69, s69, s63
  s_add_u32 m0, s62, 16384
  s_add_u32 s65, s69, 0
  buffer_load_dwordx4 v4, s[16:19], s65 offen lds
  s_add_u32 m0, s62, 17408
  s_add_u32 s65, s69, 9216
  buffer_load_dwordx4 v4, s[16:19], s65 offen lds
  s_mov_b64 exec, s[34:35]
  s_add_u32 m0, s60, 43200
  s_add_u32 s64, s68, 110592
  buffer_load_dwordx4 v3, s[20:23], s64 offen lds
  s_add_u32 m0, s60, 44096
  s_add_u32 s64, s68, 117504
  buffer_load_dwordx4 v3, s[20:23], s64 offen lds
  s_add_u32 m0, s60, 44992
  s_add_u32 s64, s68, 124416
  buffer_load_dwordx4 v3, s[20:23], s64 offen lds
  s_add_u32 m0, s60, 45888
  s_add_u32 s64, s68, 131328
  buffer_load_dwordx4 v3, s[20:23], s64 offen lds
  s_mov_b64 exec, -1
  s_cmp_lg_u32 s72, 4
  s_cbranch_scc1 K1_NG4
  ds_write_b16 v18, v45 offset:28800
K1_NG4:
  s_waitcnt vmcnt(26)
  s_waitcnt lgkmcnt(0)
  s_barrier
  s_add_u32 m0, s62, 20480
  s_add_u32 s65, s69, 36864
  buffer_load_dwordx4 v4, s[16:19], s65 offen lds
  s_add_u32 m0, s62, 21504
  s_add_u32 s65, s69, 46080
  buffer_load_dwordx4 v4, s[16:19], s65 offen lds
  s_add_u32 s67, s66, 5
  s_sub_u32 s58, s67, 9
  s_cmp_ge_u32 s67, 9
  s_cselect_b32 s67, s58, s67
  s_mul_i32 s68, s67, 221184
  s_add_u32 s68, s68, s61
  s_mov_b64 exec, s[34:35]
  s_add_u32 m0, s60, 57600
  s_add_u32 s64, s68, 0
  buffer_load_dwordx4 v3, s[20:23], s64 offen lds
  s_add_u32 m0, s60, 58496
  s_add_u32 s64, s68, 6912
  buffer_load_dwordx4 v3, s[20:23], s64 offen lds
  s_add_u32 m0, s60, 59392
  s_add_u32 s64, s68, 13824
  buffer_load_dwordx4 v3, s[20:23], s64 offen lds
  s_add_u32 m0, s60, 60288
  s_add_u32 s64, s68, 20736
  buffer_load_dwordx4 v3, s[20:23], s64 offen lds
  s_mov_b64 exec, -1
  s_waitcnt vmcnt(24)
  s_waitcnt lgkmcnt(0)
  s_barrier
  s_add_u32 s67, s66, 6
  s_sub_u32 s58, s67, 9
  s_cmp_ge_u32 s67, 9
  s_cselect_b32 s67, s58, s67
  s_lshl_b32 s69, s67, 7
  s_add_u32 s69, s69, s63
  s_add_u32 m0, s62, 32768
  s_add_u32 s65, s69, 0
  buffer_load_dwordx4 v4, s[16:19], s65 offen lds
  s_add_u32 m0, s62, 33792
  s_add_u32 s65, s69, 9216
  buffer_load_dwordx4 v4, s[16:19], s65 offen lds
  s_mov_b64 exec, s[34:35]
  s_add_u32 m0, s60, 72000
  s_add_u32 s64, s68, 110592
  buffer_load_dwordx4 v3, s[20:23], s64 offen lds
  s_add_u32 m0, s60, 72896
  s_add_u32 s64, s68, 117504
  buffer_load_dwordx4 v3, s[20:23], s64 offen lds
  s_add_u32 m0, s60, 73792
  s_add_u32 s64, s68, 124416
  buffer_load_dwordx4 v3, s[20:23], s64 offen lds
  s_add_u32 m0, s60, 74688
  s_add_u32 s64, s68, 131328
  buffer_load_dwordx4 v3, s[20:23], s64 offen lds
  s_mov_b64 exec, -1
  s_cmp_lg_u32 s72, 4
  s_cbranch_scc1 K1_NG5
  ds_write_b16 v17, v46
K1_NG5:
  s_waitcnt vmcnt(26)
  s_waitcnt lgkmcnt(0)
  s_barrier
  s_add_u32 m0, s62, 36864
  s_add_u32 s65, s69, 36864
  buffer_load_dwordx4 v4, s[16:19], s65 offen lds
  s_add_u32 m0, s62, 37888
  s_add_u32 s65, s69, 46080
  buffer_load_dwordx4 v4, s[16:19], s65 offen lds
  s_add_u32 s67, s66, 6
  s_sub_u32 s58, s67, 9
  s_cmp_ge_u32 s67, 9
  s_cselect_b32 s67, s58, s67
  s_mul_i32 s68, s67, 221184
  s_add_u32 s68, s68, s61
  s_mov_b64 exec, s[34:35]
  s_add_u32 m0, s60, 0
  s_add_u32 s64, s68, 0
  buffer_load_dwordx4 v3, s[20:23], s64 offen lds
  s_add_u32 m0, s60, 896
  s_add_u32 s64, s68, 6912
  buffer_load_dwordx4 v3, s[20:23], s64 offen lds
  s_add_u32 m0, s60, 1792
  s_add_u32 s64, s68, 13824
  buffer_load_dwordx4 v3, s[20:23], s64 offen lds
  s_add_u32 m0, s60, 2688
  s_add_u32 s64, s68, 20736
  buffer_load_dwordx4 v3, s[20:23], s64 offen lds
  s_mov_b64 exec, -1
  s_waitcnt vmcnt(24)
  s_waitcnt lgkmcnt(0)
  s_barrier
  s_add_u32 s67, s66, 7
  s_sub_u32 s58, s67, 9
  s_cmp_ge_u32 s67, 9
  s_cselect_b32 s67, s58, s67
  s_lshl_b32 s69, s67, 7
  s_add_u32 s69, s69, s63
  s_add_u32 m0, s62, 49152
  s_add_u32 s65, s69, 0
  buffer_load_dwordx4 v4, s[16:19], s65 offen lds
  s_add_u32 m0, s62, 50176
  s_add_u32 s65, s69, 9216
  buffer_load_dwordx4 v4, s[16:19], s65 offen lds
  s_mov_b64 exec, s[34:35]
  s_add_u32 m0, s60, 14400
  s_add_u32 s64, s68, 110592
  buffer_load_dwordx4 v3, s[20:23], s64 offen lds
  s_add_u32 m0, s60, 15296
  s_add_u32 s64, s68, 117504
  buffer_load_dwordx4 v3, s[20:23], s64 offen lds
  s_add_u32 m0, s60, 16192
  s_add_u32 s64, s68, 124416
  buffer_load_dwordx4 v3, s[20:23], s64 offen lds
  s_add_u32 m0, s60, 17088
  s_add_u32 s64, s68, 131328
  buffer_load_dwordx4 v3, s[20:23], s64 offen lds
  s_mov_b64 exec, -1
  s_cmp_lg_u32 s72, 4
  s_cbranch_scc1 K1_NG6
  ds_write_b16 v18, v47 offset:0
K1_NG6:
  s_waitcnt vmcnt(24)
  s_waitcnt lgkmcnt(0)
  s_barrier
  s_add_u32 m0, s62, 53248
  s_add_u32 s65, s69, 36864
  buffer_load_dwordx4 v4, s[16:19], s65 offen lds
  s_add_u32 m0, s62, 54272
  s_add_u32 s65, s69, 46080
  buffer_load_dwordx4 v4, s[16:19], s65 offen lds
  s_add_u32 s67, s66, 7
  s_sub_u32 s58, s67, 9
  s_cmp_ge_u32 s67, 9
  s_cselect_b32 s67, s58, s67
  s_mul_i32 s68, s67, 221184
  s_add_u32 s68, s68, s61
  s_mov_b64 exec, s[34:35]
  s_add_u32 m0, s60, 28800
  s_add_u32 s64, s68, 0
  buffer_load_dwordx4 v3, s[20:23], s64 offen lds
  s_add_u32 m0, s60, 29696
  s_add_u32 s64, s68, 6912
  buffer_load_dwordx4 v3, s[20:23], s64 offen lds
  s_add_u32 m0, s60, 30592
  s_add_u32 s64, s68, 13824
  buffer_load_dwordx4 v3, s[20:23], s64 offen lds
  s_add_u32 m0, s60, 31488
  s_add_u32 s64, s68, 20736
  buffer_load_dwordx4 v3, s[20:23], s64 offen lds
  s_mov_b64 exec, -1
  s_waitcnt vmcnt(24)
  s_waitcnt lgkmcnt(0)
  s_barrier
  s_add_u32 s67, s66, 8
  s_sub_u32 s58, s67, 9
  s_cmp_ge_u32 s67, 9
  s_cselect_b32 s67, s58, s67
  s_lshl_b32 s69, s67, 7
  s_add_u32 s69, s69, s63
  s_add_u32 m0, s62, 0
  s_add_u32 s65, s69, 0
  buffer_load_dwordx4 v4, s[16:19], s65 offen lds
  s_add_u32 m0, s62, 1024
  s_add_u32 s65, s69, 9216
  buffer_load_dwordx4 v4, s[16:19], s65 offen lds
  s_mov_b64 exec, s[34:35]
  s_add_u32 m0, s60, 43200
  s_add_u32 s64, s68, 110592
  buffer_load_dwordx4 v3, s[20:23], s64 offen lds
  s_add_u32 m0, s60, 44096
  s_add_u32 s64, s68, 117504
  buffer_load_dwordx4 v3, s[20:23], s64 offen lds
  s_add_u32 m0, s60, 44992
  s_add_u32 s64, s68, 124416
  buffer_load_dwordx4 v3, s[20:23], s64 offen lds
  s_add_u32 m0, s60, 45888
  s_add_u32 s64, s68, 131328
  buffer_load_dwordx4 v3, s[20:23], s64 offen lds
  s_mov_b64 exec, -1
  s_cmp_lg_u32 s72, 4
  s_cbranch_scc1 K1_NG7
  ds_write_b16 v18, v48 offset:28800
K1_NG7:
  s_waitcnt vmcnt(24)
  s_waitcnt lgkmcnt(0)
  s_barrier
  s_add_u32 m0, s62, 4096
  s_add_u32 s65, s69, 36864
  buffer_load_dwordx4 v4, s[16:19], s65 offen lds
  s_add_u32 m0, s62, 5120
  s_add_u32 s65, s69, 46080
  buffer_load_dwordx4 v4, s[16:19], s65 offen lds
  s_add_u32 s67, s66, 8
  s_sub_u32 s58, s67, 9
  s_cmp_ge_u32 s67, 9
  s_cselect_b32 s67, s58, s67
  s_mul_i32 s68, s67, 221184
  s_add_u32 s68, s68, s61
  s_mov_b64 exec, s[34:35]
  s_add_u32 m0, s60, 57600
  s_add_u32 s64, s68, 0
  buffer_load_dwordx4 v3, s[20:23], s64 offen lds
  s_add_u32 m0, s60, 58496
  s_add_u32 s64, s68, 6912
  buffer_load_dwordx4 v3, s[20:23], s64 offen lds
  s_add_u32 m0, s60, 59392
  s_add_u32 s64, s68, 13824
  buffer_load_dwordx4 v3, s[20:23], s64 offen lds
  s_add_u32 m0, s60, 60288
  s_add_u32 s64, s68, 20736
  buffer_load_dwordx4 v3, s[20:23], s64 offen lds
  s_mov_b64 exec, -1
  s_waitcnt vmcnt(24)
  s_waitcnt lgkmcnt(0)
  s_barrier
  s_mov_b64 exec, s[34:35]
  s_add_u32 m0, s60, 72000
  s_add_u32 s64, s68, 110592
  buffer_load_dwordx4 v3, s[20:23], s64 offen lds
  s_add_u32 m0, s60, 72896
  s_add_u32 s64, s68, 117504
  buffer_load_dwordx4 v3, s[20:23], s64 offen lds
  s_add_u32 m0, s60, 73792
  s_add_u32 s64, s68, 124416
  buffer_load_dwordx4 v3, s[20:23], s64 offen lds
  s_add_u32 m0, s60, 74688
  s_add_u32 s64, s68, 131328
  buffer_load_dwordx4 v3, s[20:23], s64 offen lds
  s_mov_b64 exec, -1
  s_cmp_lg_u32 s72, 4
  s_cbranch_scc1 K1_NG8
  ds_write_b16 v17, v49
K1_NG8:
  s_waitcnt vmcnt(22)
  s_waitcnt lgkmcnt(0)
  s_barrier
  s_waitcnt vmcnt(16)
  s_waitcnt lgkmcnt(0)
  s_barrier
  s_waitcnt vmcnt(10)
  s_waitcnt lgkmcnt(0)
  s_barrier
  s_waitcnt vmcnt(4)
  s_waitcnt lgkmcnt(0)
  s_barrier
  s_waitcnt vmcnt(0)
  s_waitcnt lgkmcnt(0)
  s_barrier
  s_waitcnt lgkmcnt(0)
  s_barrier
  s_barrier
  s_branch K2_ENTRY
K1_HELPER:
  s_waitcnt lgkmcnt(0)
  s_mov_b32 s20, s82
  s_mov_b32 s21, s83
  s_mov_b32 s22, 256
  s_mov_b32 s23, 0x00020000
  s_cmp_lg_u32 s36, 8
  s_cbranch_scc1 K1_HT0
  s_memrealtime s[78:79]
  s_waitcnt lgkmcnt(0)
  s_or_b32 s79, s79, 0x80000000
  v_mov_b32 v4, s78
  v_mov_b32 v5, s79
  v_mov_b32 v6, 0
  v_mov_b32 v7, 0
  v_mov_b32 v8, 0
  s_mov_b64 exec, 1
  buffer_atomic_cmpswap_x2 v[4:7], v8, s[20:23], 0 offen sc0
  s_mov_b64 exec, -1
K1_HT0:
  v_mov_b32 v9, 153568
  s_barrier
  s_getpc_b64 s[60:61]
K1_PC:
  s_lshl_b32 s58, s38, 2
  s_and_b32 s59, s36, 3
  s_add_u32 s58, s58, s59
  s_lshl_b32 s58, s58, 10
  s_cmp_ge_u32 s58, K2_TEXT_END - K1_PC - 1024
  s_cbranch_scc1 K1_NOCP
  v_lshlrev_b32 v10, 4, v2
  v_add_u32 v10, s58, v10
  v_mov_b32 v11, s61
  v_add_co_u32 v10, vcc, s60, v10
  s_nop 1
  v_addc_co_u32 v11, vcc, 0, v11, vcc
  global_load_dwordx4 v[16:19], v[10:11], off
K1_NOCP:
  s_barrier
  s_barrier
  s_barrier
  s_barrier
  s_barrier
  s_barrier
  s_barrier
  s_barrier
  s_barrier
  s_barrier
  s_waitcnt vmcnt(0)
  s_cmp_lg_u32 s36, 8
  s_cbranch_scc1 K1_HT1
  v_readfirstlane_b32 s76, v4
  v_readfirstlane_b32 s77, v5
  s_nop 0
  s_cmp_eq_u64 s[76:77], 0
  s_cselect_b64 s[78:79], s[78:79], s[76:77]
  v_mov_b32 v4, s78
  v_mov_b32 v5, s79
  ds_write_b64 v9, v[4:5]
  s_waitcnt lgkmcnt(0)
K1_HT1:
  s_barrier
  ds_read_b64 v[4:5], v9
  s_waitcnt lgkmcnt(0)
  v_readfirstlane_b32 s78, v4
  v_readfirstlane_b32 s79, v5
  s_barrier
  s_lshl_b32 s53, s2, 2
  s_and_b32 s58, s36, 3
  s_add_u32 s53, s53, s58
  s_mul_hi_u32 s54, s53, 119304648
  s_mul_i32 s55, s54, 36
  s_sub_u32 s55, s53, s55
  s_cmp_ge_u32 s55, 18
  s_cselect_b32 s28, s32, s14
  s_cselect_b32 s29, s33, s15
  s_cselect_b32 s56, 18, 0
  s_sub_u32 s55, s55, s56
  s_mov_b32 s30, 663552
  s_mov_b32 s31, 0x00020000
  s_mul_i32 s56, s55, 36
  s_mul_i32 s57, s55, 288
  s_sub_u32 s57, s57, 4592
  s_cmp_ge_u32 s55, 16
  s_cselect_b32 s56, s57, s56
  s_cselect_b32 s57, 144, 20
  s_cselect_b32 s58, 72, 8
  s_cselect_b32 s59, 36, 4
  s_mul_i32 s59, s59, 1152
  v_lshrrev_b32 v13, 5, v2
  v_mul_lo_u32 v13, v13, s57
  v_bfe_u32 v14, v2, 4, 1
  v_mul_lo_u32 v14, v14, s58
  v_add3_u32 v13, v13, v14, s56
  v_mul_u32_u24 v13, 1152, v13
  v_and_b32 v14, 15, v2
  v_lshl_add_u32 v13, v14, 1, v13
  s_lshl_b32 s56, s54, 5
  s_cmp_lt_u32 s53, 1296
  s_cselect_b32 s56, s56, 0x7FF00000
  v_add_u32 v13, s56, v13
  s_lshl_b32 s70, s53, 10
  s_add_u32 s70, s70, 14876672
  s_cmp_lt_u32 s53, 1296
  s_cselect_b32 s70, s70, 0x7FF00000
  buffer_load_ushort v64, v13, s[28:31], 0 offen offset:0
  buffer_load_ushort v65, v13, s[28:31], 0 offen offset:1152
  buffer_load_ushort v66, v13, s[28:31], 0 offen offset:2304
  buffer_load_ushort v67, v13, s[28:31], 0 offen offset:3456
  buffer_load_ushort v68, v13, s[28:31], s59 offen offset:0
  buffer_load_ushort v69, v13, s[28:31], s59 offen offset:1152
  buffer_load_ushort v70, v13, s[28:31], s59 offen offset:2304
  buffer_load_ushort v71, v13, s[28:31], s59 offen offset:3456
  s_lshl_b32 s53, s2, 2
  s_and_b32 s58, s36, 3
  s_add_u32 s53, s53, s58
  s_add_u32 s53, s53, 1024
  s_mul_hi_u32 s54, s53, 119304648
  s_mul_i32 s55, s54, 36
  s_sub_u32 s55, s53, s55
  s_cmp_ge_u32 s55, 18
  s_cselect_b32 s28, s32, s14
  s_cselect_b32 s29, s33, s15
  s_cselect_b32 s56, 18, 0
  s_sub_u32 s55, s55, s56
  s_mov_b32 s30, 663552
  s_mov_b32 s31, 0x00020000
  s_mul_i32 s56, s55, 36
  s_mul_i32 s57, s55, 288
  s_sub_u32 s57, s57, 4592
  s_cmp_ge_u32 s55, 16
  s_cselect_b32 s56, s57, s56
  s_cselect_b32 s57, 144, 20
  s_cselect_b32 s58, 72, 8
  s_cselect_b32 s59, 36, 4
  s_mul_i32 s59, s59, 1152
  v_lshrrev_b32 v13, 5, v2
  v_mul_lo_u32 v13, v13, s57
  v_bfe_u32 v14, v2, 4, 1
  v_mul_lo_u32 v14, v14, s58
  v_add3_u32 v13, v13, v14, s56
  v_mul_u32_u24 v13, 1152, v13
  v_and_b32 v14, 15, v2
  v_lshl_add_u32 v13, v14, 1, v13
  s_lshl_b32 s56, s54, 5
  s_cmp_lt_u32 s53, 1296
  s_cselect_b32 s56, s56, 0x7FF00000
  v_add_u32 v13, s56, v13
  s_lshl_b32 s71, s53, 10
  s_add_u32 s71, s71, 14876672
  s_cmp_lt_u32 s53, 1296
  s_cselect_b32 s71, s71, 0x7FF00000
  buffer_load_ushort v80, v13, s[28:31], 0 offen offset:0
  buffer_load_ushort v81, v13, s[28:31], 0 offen offset:1152
  buffer_load_ushort v82, v13, s[28:31], 0 offen offset:2304
  buffer_load_ushort v83, v13, s[28:31], 0 offen offset:3456
  buffer_load_ushort v84, v13, s[28:31], s59 offen offset:0
  buffer_load_ushort v85, v13, s[28:31], s59 offen offset:1152
  buffer_load_ushort v86, v13, s[28:31], s59 offen offset:2304
  buffer_load_ushort v87, v13, s[28:31], s59 offen offset:3456
  s_barrier
  s_barrier
  s_barrier
  s_barrier
  s_mov_b32 s24, s12
  s_mov_b32 s25, s13
  s_mov_b32 s26, 21889024
  s_mov_b32 s27, 0x00020000
  v_lshlrev_b32 v15, 4, v2
  s_waitcnt vmcnt(14)
  v_lshl_or_b32 v72, v65, 16, v64
  s_waitcnt vmcnt(12)
  v_lshl_or_b32 v73, v67, 16, v66
  s_waitcnt vmcnt(10)
  v_lshl_or_b32 v74, v69, 16, v68
  s_waitcnt vmcnt(8)
  v_lshl_or_b32 v75, v71, 16, v70
  buffer_store_dwordx4 v[72:75], v15, s[24:27], s70 offen sc1
  s_waitcnt vmcnt(7)
  v_lshl_or_b32 v88, v81, 16, v80
  s_waitcnt vmcnt(5)
  v_lshl_or_b32 v89, v83, 16, v82
  s_waitcnt vmcnt(3)
  v_lshl_or_b32 v90, v85, 16, v84
  s_waitcnt vmcnt(1)
  v_lshl_or_b32 v91, v87, 16, v86
  buffer_store_dwordx4 v[88:91], v15, s[24:27], s71 offen sc1
  s_barrier
  s_barrier
  s_lshl_b32 s58, s39, 4
  s_add_u32 s58, s58, s40
  s_lshl_b32 s58, s58, 7
  s_add_u32 s58, s58, 21495808
  v_mov_b32 v6, 0
  v_mov_b32 v7, 1
  v_mov_b32 v8, 8
  s_waitcnt vmcnt(0)
  s_barrier
  s_cmp_lg_u32 s36, 8
  s_cbranch_scc1 K2_ENTRY
  s_mov_b64 exec, 1
  buffer_store_dwordx2 v[4:5], v6, s[24:27], s58 offen sc1
  buffer_atomic_add v7, v8, s[20:23], 0 offen
  s_mov_b64 exec, -1
  s_branch K2_ENTRY
K1_COMPUTE:
  s_setprio 3
  s_cmp_eq_u32 s42, 5
  s_cselect_b32 s45, 2, 0
  s_cselect_b32 s46, 0, 4
  s_add_u32 s47, s45, 3
  s_add_u32 s48, s45, 1
  s_cmp_eq_u32 s44, 0
  s_cselect_b32 s47, s45, s47
  s_cselect_b32 s48, s48, s46
  s_cselect_b32 s49, s45, s46
  s_cselect_b32 s50, 4, 2
  s_mul_i32 s51, s42, 6
  s_mul_i32 s52, s41, 3
  s_add_u32 s53, s51, s47
  s_add_u32 s54, s51, s48
  s_add_u32 s55, s51, s49
  s_lshr_b32 s56, s53, 4
  s_add_u32 s56, s56, s52
  s_lshr_b32 s57, s54, 4
  s_add_u32 s57, s57, s52
  s_and_b32 s53, s53, 15
  s_and_b32 s54, s54, 15
  s_and_b32 s55, s55, 15
  v_lshrrev_b32 v25, 5, v2
  v_mul_u32_u24 v24, 7200, v25
  v_bfe_u32 v25, v2, 4, 1
  v_mul_u32_u24 v25, 3616, v25
  v_add_u32 v24, v24, v25
  v_bfe_u32 v25, v2, 2, 2
  v_mul_u32_u24 v25, 448, v25
  v_add_u32 v24, v24, v25
  v_and_b32 v25, 3, v2
  v_lshl_add_u32 v26, v25, 3, v24
  s_mul_i32 s58, s47, 72
  v_add_u32 v3, s58, v26
  s_mul_i32 s58, s48, 72
  v_add_u32 v5, s58, v26
  v_add_u32 v27, s49, v25
  v_mul_u32_u24 v27, 72, v27
  v_add_u32 v27, 32, v27
  v_lshlrev_b32 v28, 3, v25
  v_add_u32 v28, 416, v28
  v_cmp_gt_u32 vcc, s50, v25
  s_nop 1
  v_cndmask_b32 v27, v28, v27, vcc
  v_add_u32 v4, v24, v27
  v_and_b32 v25, 15, v2
  v_lshrrev_b32 v26, 2, v25
  v_and_b32 v27, 3, v25
  v_lshl_add_u32 v29, v26, 3, v27
  s_lshl_b32 s58, s43, 6
  v_add_u32 v28, s58, v29
  v_lshlrev_b32 v28, 7, v28
  v_and_b32 v27, 2, v27
  v_lshlrev_b32 v27, 1, v27
  v_and_b32 v26, 2, v26
  v_or_b32 v26, v26, v27
  v_lshrrev_b32 v30, 4, v2
  v_xor_b32 v27, v30, v26
  v_lshl_add_u32 v9, v27, 4, v28
  v_add_u32 v9, 86400, v9
  v_xor_b32 v10, 64, v9
  v_mov_b32 v11, v9
  s_mov_b32 s79, 0
  v_add_u32 v6, 43200, v3
  v_add_u32 v7, 43200, v4
  v_add_u32 v8, 43200, v5
  s_lshr_b32 s58, 0x18, s56
  s_and_b32 s66, s58, 1
  s_lshr_b32 s58, 0x18, s57
  s_and_b32 s67, s58, 1
  s_mul_i32 s68, s66, 897988541
  s_mul_i32 s69, s67, 897988541
  v_mov_b32 v56, s68
  v_mov_b32 v57, s68
  v_mov_b32 v58, s68
  v_mov_b32 v59, s68
  v_mov_b32 v60, s68
  v_mov_b32 v61, s68
  v_mov_b32 v62, s68
  v_mov_b32 v63, s68
  v_mov_b32 v64, s68
  v_mov_b32 v65, s68
  v_mov_b32 v66, s68
  v_mov_b32 v67, s68
  v_mov_b32 v68, s68
  v_mov_b32 v69, s68
  v_mov_b32 v70, s68
  v_mov_b32 v71, s68
  v_mov_b32 v72, s68
  v_mov_b32 v73, s68
  v_mov_b32 v74, s68
  v_mov_b32 v75, s68
  v_mov_b32 v76, s68
  v_mov_b32 v77, s68
  v_mov_b32 v78, s68
  v_mov_b32 v79, s68
  v_mov_b32 v80, s68
  v_mov_b32 v81, s68
  v_mov_b32 v82, s68
  v_mov_b32 v83, s68
  v_mov_b32 v84, s68
  v_mov_b32 v85, s68
  v_mov_b32 v86, s68
  v_mov_b32 v87, s68
  v_mov_b32 v88, s69
  v_mov_b32 v89, s69
  v_mov_b32 v90, s69
  v_mov_b32 v91, s69
  v_mov_b32 v92, s69
  v_mov_b32 v93, s69
  v_mov_b32 v94, s69
  v_mov_b32 v95, s69
  v_mov_b32 v96, s69
  v_mov_b32 v97, s69
  v_mov_b32 v98, s69
  v_mov_b32 v99, s69
  v_mov_b32 v100, s69
  v_mov_b32 v101, s69
  v_mov_b32 v102, s69
  v_mov_b32 v103, s69
  v_mov_b32 v104, s69
  v_mov_b32 v105, s69
  v_mov_b32 v106, s69
  v_mov_b32 v107, s69
  v_mov_b32 v108, s69
  v_mov_b32 v109, s69
  v_mov_b32 v110, s69
  v_mov_b32 v111, s69
  v_mov_b32 v112, s69
  v_mov_b32 v113, s69
  v_mov_b32 v114, s69
  v_mov_b32 v115, s69
  v_mov_b32 v116, s69
  v_mov_b32 v117, s69
  v_mov_b32 v118, s69
  v_mov_b32 v119, s69
  v_mov_b32 v120, s69
  v_mov_b32 v121, s69
  v_mov_b32 v122, s69
  v_mov_b32 v123, s69
  v_mov_b32 v124, s69
  v_mov_b32 v125, s69
  v_mov_b32 v126, s69
  v_mov_b32 v127, s69
  v_mov_b32 v128, s69
  v_mov_b32 v129, s69
  v_mov_b32 v130, s69
  v_mov_b32 v131, s69
  v_mov_b32 v132, s69
  v_mov_b32 v133, s69
  v_mov_b32 v134, s69
  v_mov_b32 v135, s69
  v_mov_b32 v136, s69
  v_mov_b32 v137, s69
  v_mov_b32 v138, s69
  v_mov_b32 v139, s69
  v_mov_b32 v140, s69
  v_mov_b32 v141, s69
  v_mov_b32 v142, s69
  v_mov_b32 v143, s69
  v_mov_b32 v144, s69
  v_mov_b32 v145, s69
  v_mov_b32 v146, s69
  v_mov_b32 v147, s69
  v_mov_b32 v148, s69
  v_mov_b32 v149, s69
  v_mov_b32 v150, s69
  v_mov_b32 v151, s69
  v_mov_b32 v152, s69
  v_mov_b32 v153, s69
  v_mov_b32 v154, s69
  v_mov_b32 v155, s69
  v_mov_b32 v156, s69
  v_mov_b32 v157, s69
  v_mov_b32 v158, s69
  v_mov_b32 v159, s69
  v_mov_b32 v160, s69
  v_mov_b32 v161, s69
  v_mov_b32 v162, s69
  v_mov_b32 v163, s69
  v_mov_b32 v164, s69
  v_mov_b32 v165, s69
  v_mov_b32 v166, s69
  v_mov_b32 v167, s69
  s_lshr_b32 s58, 0x34, s56
  s_and_b32 s70, s58, 1
  s_lshr_b32 s58, 0x34, s57
  s_and_b32 s71, s58, 1
  s_lshl_b32 s58, s70, 1
  s_or_b32 s72, s58, s71
  s_waitcnt lgkmcnt(0)
  s_mov_b32 s24, s12
  s_mov_b32 s25, s13
  s_mov_b32 s26, 21889024
  s_mov_b32 s27, 0x00020000
  s_lshl_b32 s77, s39, 7
  s_lshl_b32 s58, s43, 6
  s_add_u32 s77, s77, s58
  s_mov_b32 s73, 3
  s_cmp_eq_u32 s72, 1
  s_cbranch_scc1 K1_TN
  s_cmp_eq_u32 s72, 2
  s_cbranch_scc1 K1_NT
  s_cmp_eq_u32 s72, 3
  s_cbranch_scc1 K1_NN
K1_TT:
  s_cmp_eq_u32 s56, 3
  s_cselect_b32 s58, 2, s56
  s_lshl_b32 s58, s58, 21
  s_lshl_b32 s59, s53, 17
  s_add_u32 s80, s58, s59
  s_cmp_eq_u32 s57, 3
  s_cselect_b32 s58, 2, s57
  s_lshl_b32 s58, s58, 21
  s_lshl_b32 s59, s54, 17
  s_add_u32 s81, s58, s59
  s_cmp_eq_u32 s57, 3
  s_cselect_b32 s58, 2, s57
  s_lshl_b32 s58, s58, 18
  s_lshl_b32 s59, s55, 14
  s_add_u32 s82, s58, s59
  s_add_u32 s82, s82, 6291456
  s_cmp_eq_u32 s56, 0
  s_cselect_b32 s30, 1051597459, 1.0
  s_mov_b32 s31, s30
  s_cmp_eq_u32 s57, 0
  s_cselect_b32 s14, 1051597459, 1.0
  s_mov_b32 s15, s14
  s_mov_b32 s74, 1069066811
  s_mov_b32 s75, 1069066811
  s_mov_b32 s76, 897988541
  s_barrier
  ds_read_b64_tr_b16 v[12:13], v3 offset:0
  ds_read_b64_tr_b16 v[14:15], v3 offset:1792
  ds_read_b128 v[24:27], v9 offset:0
  ds_read_b128 v[28:31], v9 offset:512
  ds_read_b128 v[32:35], v9 offset:4096
  ds_read_b128 v[36:39], v9 offset:4608
  ds_read_b64_tr_b16 v[16:17], v3 offset:40
  ds_read_b64_tr_b16 v[18:19], v3 offset:1832
  ds_read_b64_tr_b16 v[20:21], v4 offset:0
  ds_read_b64_tr_b16 v[22:23], v4 offset:1792
  s_waitcnt lgkmcnt(10)
K1_TT_LOOP:
  s_waitcnt lgkmcnt(7)
  v_mfma_f32_16x16x32_bf16 v[56:59], v[12:15], v[24:27], v[56:59]
  s_waitcnt lgkmcnt(6)
  v_mfma_f32_16x16x32_bf16 v[60:63], v[12:15], v[28:31], v[60:63]
  s_waitcnt lgkmcnt(5)
  v_mfma_f32_16x16x32_bf16 v[64:67], v[12:15], v[32:35], v[64:67]
  s_waitcnt lgkmcnt(4)
  v_mfma_f32_16x16x32_bf16 v[68:71], v[12:15], v[36:39], v[68:71]
  ds_read_b64_tr_b16 v[12:13], v5 offset:0
  ds_read_b64_tr_b16 v[14:15], v5 offset:1792
  s_waitcnt lgkmcnt(4)
  v_mfma_f32_16x16x32_bf16 v[72:75], v[16:19], v[24:27], v[72:75]
  v_mfma_f32_16x16x32_bf16 v[76:79], v[16:19], v[28:31], v[76:79]
  v_mfma_f32_16x16x32_bf16 v[80:83], v[16:19], v[32:35], v[80:83]
  v_mfma_f32_16x16x32_bf16 v[84:87], v[16:19], v[36:39], v[84:87]
  ds_read_b64_tr_b16 v[16:17], v5 offset:40
  ds_read_b64_tr_b16 v[18:19], v5 offset:1832
  s_waitcnt lgkmcnt(4)
  v_mfma_f32_16x16x32_bf16 v[88:91], v[20:23], v[24:27], v[88:91]
  v_mfma_f32_16x16x32_bf16 v[92:95], v[20:23], v[28:31], v[92:95]
  v_mfma_f32_16x16x32_bf16 v[96:99], v[20:23], v[32:35], v[96:99]
  v_mfma_f32_16x16x32_bf16 v[100:103], v[20:23], v[36:39], v[100:103]
  ds_read_b64_tr_b16 v[20:21], v5 offset:72
  ds_read_b64_tr_b16 v[22:23], v5 offset:1864
  s_waitcnt lgkmcnt(4)
  v_mfma_f32_16x16x32_bf16 v[104:107], v[12:15], v[24:27], v[104:107]
  v_mfma_f32_16x16x32_bf16 v[108:111], v[12:15], v[28:31], v[108:111]
  v_mfma_f32_16x16x32_bf16 v[112:115], v[12:15], v[32:35], v[112:115]
  v_mfma_f32_16x16x32_bf16 v[116:119], v[12:15], v[36:39], v[116:119]
  ds_read_b64_tr_b16 v[12:13], v5 offset:112
  ds_read_b64_tr_b16 v[14:15], v5 offset:1904
  s_waitcnt lgkmcnt(4)
  v_mfma_f32_16x16x32_bf16 v[120:123], v[16:19], v[24:27], v[120:123]
  v_mfma_f32_16x16x32_bf16 v[124:127], v[16:19], v[28:31], v[124:127]
  v_mfma_f32_16x16x32_bf16 v[128:131], v[16:19], v[32:35], v[128:131]
  v_mfma_f32_16x16x32_bf16 v[132:135], v[16:19], v[36:39], v[132:135]
  s_waitcnt lgkmcnt(0)
  s_barrier
  ds_read_b64_tr_b16 v[16:17], v3 offset:14400
  ds_read_b64_tr_b16 v[18:19], v3 offset:16192
  v_mfma_f32_16x16x32_bf16 v[136:139], v[20:23], v[24:27], v[136:139]
  ds_read_b128 v[40:43], v10 offset:0
  v_mfma_f32_16x16x32_bf16 v[140:143], v[20:23], v[28:31], v[140:143]
  ds_read_b128 v[44:47], v10 offset:512
  v_mfma_f32_16x16x32_bf16 v[144:147], v[20:23], v[32:35], v[144:147]
  ds_read_b128 v[48:51], v10 offset:4096
  v_mfma_f32_16x16x32_bf16 v[148:151], v[20:23], v[36:39], v[148:151]
  ds_read_b128 v[52:55], v10 offset:4608
  ds_read_b64_tr_b16 v[20:21], v3 offset:14440
  ds_read_b64_tr_b16 v[22:23], v3 offset:16232
  v_mfma_f32_16x16x32_bf16 v[152:155], v[12:15], v[24:27], v[152:155]
  v_mfma_f32_16x16x32_bf16 v[156:159], v[12:15], v[28:31], v[156:159]
  s_add_u32 s79, s79, 16384
  s_and_b32 s79, s79, 65535
  v_add_u32 v9, s79, v11
  v_xor_b32 v10, 64, v9
  v_mfma_f32_16x16x32_bf16 v[160:163], v[12:15], v[32:35], v[160:163]
  v_mfma_f32_16x16x32_bf16 v[164:167], v[12:15], v[36:39], v[164:167]
  ds_read_b64_tr_b16 v[12:13], v4 offset:14400
  ds_read_b64_tr_b16 v[14:15], v4 offset:16192
  s_waitcnt lgkmcnt(7)
  v_mfma_f32_16x16x32_bf16 v[56:59], v[16:19], v[40:43], v[56:59]
  s_waitcnt lgkmcnt(6)
  v_mfma_f32_16x16x32_bf16 v[60:63], v[16:19], v[44:47], v[60:63]
  s_waitcnt lgkmcnt(5)
  v_mfma_f32_16x16x32_bf16 v[64:67], v[16:19], v[48:51], v[64:67]
  s_waitcnt lgkmcnt(4)
  v_mfma_f32_16x16x32_bf16 v[68:71], v[16:19], v[52:55], v[68:71]
  ds_read_b64_tr_b16 v[16:17], v5 offset:14400
  ds_read_b64_tr_b16 v[18:19], v5 offset:16192
  s_waitcnt lgkmcnt(4)
  v_mfma_f32_16x16x32_bf16 v[72:75], v[20:23], v[40:43], v[72:75]
  v_mfma_f32_16x16x32_bf16 v[76:79], v[20:23], v[44:47], v[76:79]
  v_mfma_f32_16x16x32_bf16 v[80:83], v[20:23], v[48:51], v[80:83]
  v_mfma_f32_16x16x32_bf16 v[84:87], v[20:23], v[52:55], v[84:87]
  ds_read_b64_tr_b16 v[20:21], v5 offset:14440
  ds_read_b64_tr_b16 v[22:23], v5 offset:16232
  s_waitcnt lgkmcnt(4)
  v_mfma_f32_16x16x32_bf16 v[88:91], v[12:15], v[40:43], v[88:91]
  v_mfma_f32_16x16x32_bf16 v[92:95], v[12:15], v[44:47], v[92:95]
  v_mfma_f32_16x16x32_bf16 v[96:99], v[12:15], v[48:51], v[96:99]
  v_mfma_f32_16x16x32_bf16 v[100:103], v[12:15], v[52:55], v[100:103]
  ds_read_b64_tr_b16 v[12:13], v5 offset:14472
  ds_read_b64_tr_b16 v[14:15], v5 offset:16264
  s_waitcnt lgkmcnt(4)
  v_mfma_f32_16x16x32_bf16 v[104:107], v[16:19], v[40:43], v[104:107]
  v_mfma_f32_16x16x32_bf16 v[108:111], v[16:19], v[44:47], v[108:111]
  v_mfma_f32_16x16x32_bf16 v[112:115], v[16:19], v[48:51], v[112:115]
  v_mfma_f32_16x16x32_bf16 v[116:119], v[16:19], v[52:55], v[116:119]
  ds_read_b64_tr_b16 v[16:17], v5 offset:14512
  ds_read_b64_tr_b16 v[18:19], v5 offset:16304
  s_waitcnt lgkmcnt(4)
  v_mfma_f32_16x16x32_bf16 v[120:123], v[20:23], v[40:43], v[120:123]
  v_mfma_f32_16x16x32_bf16 v[124:127], v[20:23], v[44:47], v[124:127]
  v_mfma_f32_16x16x32_bf16 v[128:131], v[20:23], v[48:51], v[128:131]
  v_mfma_f32_16x16x32_bf16 v[132:135], v[20:23], v[52:55], v[132:135]
  s_waitcnt lgkmcnt(0)
  s_barrier
  ds_read_b64_tr_b16 v[20:21], v3 offset:28800
  ds_read_b64_tr_b16 v[22:23], v3 offset:30592
  v_mfma_f32_16x16x32_bf16 v[136:139], v[12:15], v[40:43], v[136:139]
  ds_read_b128 v[24:27], v9 offset:0
  v_mfma_f32_16x16x32_bf16 v[140:143], v[12:15], v[44:47], v[140:143]
  ds_read_b128 v[28:31], v9 offset:512
  v_mfma_f32_16x16x32_bf16 v[144:147], v[12:15], v[48:51], v[144:147]
  ds_read_b128 v[32:35], v9 offset:4096
  v_mfma_f32_16x16x32_bf16 v[148:151], v[12:15], v[52:55], v[148:151]
  ds_read_b128 v[36:39], v9 offset:4608
  ds_read_b64_tr_b16 v[12:13], v3 offset:28840
  ds_read_b64_tr_b16 v[14:15], v3 offset:30632
  v_mfma_f32_16x16x32_bf16 v[152:155], v[16:19], v[40:43], v[152:155]
  v_mfma_f32_16x16x32_bf16 v[156:159], v[16:19], v[44:47], v[156:159]
  v_mfma_f32_16x16x32_bf16 v[160:163], v[16:19], v[48:51], v[160:163]
  v_mfma_f32_16x16x32_bf16 v[164:167], v[16:19], v[52:55], v[164:167]
  ds_read_b64_tr_b16 v[16:17], v4 offset:28800
  ds_read_b64_tr_b16 v[18:19], v4 offset:30592
  s_waitcnt lgkmcnt(7)
  v_mfma_f32_16x16x32_bf16 v[56:59], v[20:23], v[24:27], v[56:59]
  s_waitcnt lgkmcnt(6)
  v_mfma_f32_16x16x32_bf16 v[60:63], v[20:23], v[28:31], v[60:63]
  s_waitcnt lgkmcnt(5)
  v_mfma_f32_16x16x32_bf16 v[64:67], v[20:23], v[32:35], v[64:67]
  s_waitcnt lgkmcnt(4)
  v_mfma_f32_16x16x32_bf16 v[68:71], v[20:23], v[36:39], v[68:71]
  ds_read_b64_tr_b16 v[20:21], v5 offset:28800
  ds_read_b64_tr_b16 v[22:23], v5 offset:30592
  s_waitcnt lgkmcnt(4)
  v_mfma_f32_16x16x32_bf16 v[72:75], v[12:15], v[24:27], v[72:75]
  v_mfma_f32_16x16x32_bf16 v[76:79], v[12:15], v[28:31], v[76:79]
  v_mfma_f32_16x16x32_bf16 v[80:83], v[12:15], v[32:35], v[80:83]
  v_mfma_f32_16x16x32_bf16 v[84:87], v[12:15], v[36:39], v[84:87]
  ds_read_b64_tr_b16 v[12:13], v5 offset:28840
  ds_read_b64_tr_b16 v[14:15], v5 offset:30632
  s_waitcnt lgkmcnt(4)
  v_mfma_f32_16x16x32_bf16 v[88:91], v[16:19], v[24:27], v[88:91]
  v_mfma_f32_16x16x32_bf16 v[92:95], v[16:19], v[28:31], v[92:95]
  v_mfma_f32_16x16x32_bf16 v[96:99], v[16:19], v[32:35], v[96:99]
  v_mfma_f32_16x16x32_bf16 v[100:103], v[16:19], v[36:39], v[100:103]
  ds_read_b64_tr_b16 v[16:17], v5 offset:28872
  ds_read_b64_tr_b16 v[18:19], v5 offset:30664
  s_waitcnt lgkmcnt(4)
  v_mfma_f32_16x16x32_bf16 v[104:107], v[20:23], v[24:27], v[104:107]
  v_mfma_f32_16x16x32_bf16 v[108:111], v[20:23], v[28:31], v[108:111]
  v_mfma_f32_16x16x32_bf16 v[112:115], v[20:23], v[32:35], v[112:115]
  v_mfma_f32_16x16x32_bf16 v[116:119], v[20:23], v[36:39], v[116:119]
  ds_read_b64_tr_b16 v[20:21], v5 offset:28912
  ds_read_b64_tr_b16 v[22:23], v5 offset:30704
  s_waitcnt lgkmcnt(4)
  v_mfma_f32_16x16x32_bf16 v[120:123], v[12:15], v[24:27], v[120:123]
  v_mfma_f32_16x16x32_bf16 v[124:127], v[12:15], v[28:31], v[124:127]
  v_mfma_f32_16x16x32_bf16 v[128:131], v[12:15], v[32:35], v[128:131]
  v_mfma_f32_16x16x32_bf16 v[132:135], v[12:15], v[36:39], v[132:135]
  s_waitcnt lgkmcnt(0)
  s_barrier
  ds_read_b64_tr_b16 v[12:13], v6 offset:0
  ds_read_b64_tr_b16 v[14:15], v6 offset:1792
  v_mfma_f32_16x16x32_bf16 v[136:139], v[16:19], v[24:27], v[136:139]
  ds_read_b128 v[40:43], v10 offset:0
  v_mfma_f32_16x16x32_bf16 v[140:143], v[16:19], v[28:31], v[140:143]
  ds_read_b128 v[44:47], v10 offset:512
  v_mfma_f32_16x16x32_bf16 v[144:147], v[16:19], v[32:35], v[144:147]
  ds_read_b128 v[48:51], v10 offset:4096
  v_mfma_f32_16x16x32_bf16 v[148:151], v[16:19], v[36:39], v[148:151]
  ds_read_b128 v[52:55], v10 offset:4608
  ds_read_b64_tr_b16 v[16:17], v6 offset:40
  ds_read_b64_tr_b16 v[18:19], v6 offset:1832
  v_mfma_f32_16x16x32_bf16 v[152:155], v[20:23], v[24:27], v[152:155]
  v_mfma_f32_16x16x32_bf16 v[156:159], v[20:23], v[28:31], v[156:159]
  s_add_u32 s79, s79, 16384
  s_and_b32 s79, s79, 65535
  v_add_u32 v9, s79, v11
  v_xor_b32 v10, 64, v9
  v_mfma_f32_16x16x32_bf16 v[160:163], v[20:23], v[32:35], v[160:163]
  v_mfma_f32_16x16x32_bf16 v[164:167], v[20:23], v[36:39], v[164:167]
  ds_read_b64_tr_b16 v[20:21], v7 offset:0
  ds_read_b64_tr_b16 v[22:23], v7 offset:1792
  s_waitcnt lgkmcnt(7)
  v_mfma_f32_16x16x32_bf16 v[56:59], v[12:15], v[40:43], v[56:59]
  s_waitcnt lgkmcnt(6)
  v_mfma_f32_16x16x32_bf16 v[60:63], v[12:15], v[44:47], v[60:63]
  s_waitcnt lgkmcnt(5)
  v_mfma_f32_16x16x32_bf16 v[64:67], v[12:15], v[48:51], v[64:67]
  s_waitcnt lgkmcnt(4)
  v_mfma_f32_16x16x32_bf16 v[68:71], v[12:15], v[52:55], v[68:71]
  ds_read_b64_tr_b16 v[12:13], v8 offset:0
  ds_read_b64_tr_b16 v[14:15], v8 offset:1792
  s_waitcnt lgkmcnt(4)
  v_mfma_f32_16x16x32_bf16 v[72:75], v[16:19], v[40:43], v[72:75]
  v_mfma_f32_16x16x32_bf16 v[76:79], v[16:19], v[44:47], v[76:79]
  v_mfma_f32_16x16x32_bf16 v[80:83], v[16:19], v[48:51], v[80:83]
  v_mfma_f32_16x16x32_bf16 v[84:87], v[16:19], v[52:55], v[84:87]
  ds_read_b64_tr_b16 v[16:17], v8 offset:40
  ds_read_b64_tr_b16 v[18:19], v8 offset:1832
  s_waitcnt lgkmcnt(4)
  v_mfma_f32_16x16x32_bf16 v[88:91], v[20:23], v[40:43], v[88:91]
  v_mfma_f32_16x16x32_bf16 v[92:95], v[20:23], v[44:47], v[92:95]
  v_mfma_f32_16x16x32_bf16 v[96:99], v[20:23], v[48:51], v[96:99]
  v_mfma_f32_16x16x32_bf16 v[100:103], v[20:23], v[52:55], v[100:103]
  ds_read_b64_tr_b16 v[20:21], v8 offset:72
  ds_read_b64_tr_b16 v[22:23], v8 offset:1864
  s_waitcnt lgkmcnt(4)
  v_mfma_f32_16x16x32_bf16 v[104:107], v[12:15], v[40:43], v[104:107]
  v_mfma_f32_16x16x32_bf16 v[108:111], v[12:15], v[44:47], v[108:111]
  v_mfma_f32_16x16x32_bf16 v[112:115], v[12:15], v[48:51], v[112:115]
  v_mfma_f32_16x16x32_bf16 v[116:119], v[12:15], v[52:55], v[116:119]
  ds_read_b64_tr_b16 v[12:13], v8 offset:112
  ds_read_b64_tr_b16 v[14:15], v8 offset:1904
  s_waitcnt lgkmcnt(4)
  v_mfma_f32_16x16x32_bf16 v[120:123], v[16:19], v[40:43], v[120:123]
  v_mfma_f32_16x16x32_bf16 v[124:127], v[16:19], v[44:47], v[124:127]
  v_mfma_f32_16x16x32_bf16 v[128:131], v[16:19], v[48:51], v[128:131]
  v_mfma_f32_16x16x32_bf16 v[132:135], v[16:19], v[52:55], v[132:135]
  s_waitcnt lgkmcnt(0)
  s_barrier
  ds_read_b64_tr_b16 v[16:17], v6 offset:14400
  ds_read_b64_tr_b16 v[18:19], v6 offset:16192
  v_mfma_f32_16x16x32_bf16 v[136:139], v[20:23], v[40:43], v[136:139]
  ds_read_b128 v[24:27], v9 offset:0
  v_mfma_f32_16x16x32_bf16 v[140:143], v[20:23], v[44:47], v[140:143]
  ds_read_b128 v[28:31], v9 offset:512
  v_mfma_f32_16x16x32_bf16 v[144:147], v[20:23], v[48:51], v[144:147]
  ds_read_b128 v[32:35], v9 offset:4096
  v_mfma_f32_16x16x32_bf16 v[148:151], v[20:23], v[52:55], v[148:151]
  ds_read_b128 v[36:39], v9 offset:4608
  ds_read_b64_tr_b16 v[20:21], v6 offset:14440
  ds_read_b64_tr_b16 v[22:23], v6 offset:16232
  v_mfma_f32_16x16x32_bf16 v[152:155], v[12:15], v[40:43], v[152:155]
  v_mfma_f32_16x16x32_bf16 v[156:159], v[12:15], v[44:47], v[156:159]
  v_mfma_f32_16x16x32_bf16 v[160:163], v[12:15], v[48:51], v[160:163]
  v_mfma_f32_16x16x32_bf16 v[164:167], v[12:15], v[52:55], v[164:167]
  ds_read_b64_tr_b16 v[12:13], v7 offset:14400
  ds_read_b64_tr_b16 v[14:15], v7 offset:16192
  s_waitcnt lgkmcnt(7)
  v_mfma_f32_16x16x32_bf16 v[56:59], v[16:19], v[24:27], v[56:59]
  s_waitcnt lgkmcnt(6)
  v_mfma_f32_16x16x32_bf16 v[60:63], v[16:19], v[28:31], v[60:63]
  s_waitcnt lgkmcnt(5)
  v_mfma_f32_16x16x32_bf16 v[64:67], v[16:19], v[32:35], v[64:67]
  s_waitcnt lgkmcnt(4)
  v_mfma_f32_16x16x32_bf16 v[68:71], v[16:19], v[36:39], v[68:71]
  ds_read_b64_tr_b16 v[16:17], v8 offset:14400
  ds_read_b64_tr_b16 v[18:19], v8 offset:16192
  s_waitcnt lgkmcnt(4)
  v_mfma_f32_16x16x32_bf16 v[72:75], v[20:23], v[24:27], v[72:75]
  v_mfma_f32_16x16x32_bf16 v[76:79], v[20:23], v[28:31], v[76:79]
  v_mfma_f32_16x16x32_bf16 v[80:83], v[20:23], v[32:35], v[80:83]
  v_mfma_f32_16x16x32_bf16 v[84:87], v[20:23], v[36:39], v[84:87]
  ds_read_b64_tr_b16 v[20:21], v8 offset:14440
  ds_read_b64_tr_b16 v[22:23], v8 offset:16232
  s_waitcnt lgkmcnt(4)
  v_mfma_f32_16x16x32_bf16 v[88:91], v[12:15], v[24:27], v[88:91]
  v_mfma_f32_16x16x32_bf16 v[92:95], v[12:15], v[28:31], v[92:95]
  v_mfma_f32_16x16x32_bf16 v[96:99], v[12:15], v[32:35], v[96:99]
  v_mfma_f32_16x16x32_bf16 v[100:103], v[12:15], v[36:39], v[100:103]
  ds_read_b64_tr_b16 v[12:13], v8 offset:14472
  ds_read_b64_tr_b16 v[14:15], v8 offset:16264
  s_waitcnt lgkmcnt(4)
  v_mfma_f32_16x16x32_bf16 v[104:107], v[16:19], v[24:27], v[104:107]
  v_mfma_f32_16x16x32_bf16 v[108:111], v[16:19], v[28:31], v[108:111]
  v_mfma_f32_16x16x32_bf16 v[112:115], v[16:19], v[32:35], v[112:115]
  v_mfma_f32_16x16x32_bf16 v[116:119], v[16:19], v[36:39], v[116:119]
  ds_read_b64_tr_b16 v[16:17], v8 offset:14512
  ds_read_b64_tr_b16 v[18:19], v8 offset:16304
  s_waitcnt lgkmcnt(4)
  v_mfma_f32_16x16x32_bf16 v[120:123], v[20:23], v[24:27], v[120:123]
  v_mfma_f32_16x16x32_bf16 v[124:127], v[20:23], v[28:31], v[124:127]
  v_mfma_f32_16x16x32_bf16 v[128:131], v[20:23], v[32:35], v[128:131]
  v_mfma_f32_16x16x32_bf16 v[132:135], v[20:23], v[36:39], v[132:135]
  s_waitcnt lgkmcnt(0)
  s_barrier
  ds_read_b64_tr_b16 v[20:21], v6 offset:28800
  ds_read_b64_tr_b16 v[22:23], v6 offset:30592
  v_mfma_f32_16x16x32_bf16 v[136:139], v[12:15], v[24:27], v[136:139]
  ds_read_b128 v[40:43], v10 offset:0
  v_mfma_f32_16x16x32_bf16 v[140:143], v[12:15], v[28:31], v[140:143]
  ds_read_b128 v[44:47], v10 offset:512
  v_mfma_f32_16x16x32_bf16 v[144:147], v[12:15], v[32:35], v[144:147]
  ds_read_b128 v[48:51], v10 offset:4096
  v_mfma_f32_16x16x32_bf16 v[148:151], v[12:15], v[36:39], v[148:151]
  ds_read_b128 v[52:55], v10 offset:4608
  ds_read_b64_tr_b16 v[12:13], v6 offset:28840
  ds_read_b64_tr_b16 v[14:15], v6 offset:30632
  v_mfma_f32_16x16x32_bf16 v[152:155], v[16:19], v[24:27], v[152:155]
  v_mfma_f32_16x16x32_bf16 v[156:159], v[16:19], v[28:31], v[156:159]
  s_add_u32 s79, s79, 16384
  s_and_b32 s79, s79, 65535
  v_add_u32 v9, s79, v11
  v_xor_b32 v10, 64, v9
  v_mfma_f32_16x16x32_bf16 v[160:163], v[16:19], v[32:35], v[160:163]
  v_mfma_f32_16x16x32_bf16 v[164:167], v[16:19], v[36:39], v[164:167]
  ds_read_b64_tr_b16 v[16:17], v7 offset:28800
  ds_read_b64_tr_b16 v[18:19], v7 offset:30592
  s_waitcnt lgkmcnt(7)
  v_mfma_f32_16x16x32_bf16 v[56:59], v[20:23], v[40:43], v[56:59]
  s_waitcnt lgkmcnt(6)
  v_mfma_f32_16x16x32_bf16 v[60:63], v[20:23], v[44:47], v[60:63]
  s_waitcnt lgkmcnt(5)
  v_mfma_f32_16x16x32_bf16 v[64:67], v[20:23], v[48:51], v[64:67]
  s_waitcnt lgkmcnt(4)
  v_mfma_f32_16x16x32_bf16 v[68:71], v[20:23], v[52:55], v[68:71]
  ds_read_b64_tr_b16 v[20:21], v8 offset:28800
  ds_read_b64_tr_b16 v[22:23], v8 offset:30592
  s_waitcnt lgkmcnt(4)
  v_mfma_f32_16x16x32_bf16 v[72:75], v[12:15], v[40:43], v[72:75]
  v_mfma_f32_16x16x32_bf16 v[76:79], v[12:15], v[44:47], v[76:79]
  v_mfma_f32_16x16x32_bf16 v[80:83], v[12:15], v[48:51], v[80:83]
  v_mfma_f32_16x16x32_bf16 v[84:87], v[12:15], v[52:55], v[84:87]
  ds_read_b64_tr_b16 v[12:13], v8 offset:28840
  ds_read_b64_tr_b16 v[14:15], v8 offset:30632
  s_waitcnt lgkmcnt(4)
  v_mfma_f32_16x16x32_bf16 v[88:91], v[16:19], v[40:43], v[88:91]
  v_mfma_f32_16x16x32_bf16 v[92:95], v[16:19], v[44:47], v[92:95]
  v_mfma_f32_16x16x32_bf16 v[96:99], v[16:19], v[48:51], v[96:99]
  v_mfma_f32_16x16x32_bf16 v[100:103], v[16:19], v[52:55], v[100:103]
  ds_read_b64_tr_b16 v[16:17], v8 offset:28872
  ds_read_b64_tr_b16 v[18:19], v8 offset:30664
  s_waitcnt lgkmcnt(4)
  v_mfma_f32_16x16x32_bf16 v[104:107], v[20:23], v[40:43], v[104:107]
  v_mfma_f32_16x16x32_bf16 v[108:111], v[20:23], v[44:47], v[108:111]
  v_mfma_f32_16x16x32_bf16 v[112:115], v[20:23], v[48:51], v[112:115]
  v_mfma_f32_16x16x32_bf16 v[116:119], v[20:23], v[52:55], v[116:119]
  ds_read_b64_tr_b16 v[20:21], v8 offset:28912
  ds_read_b64_tr_b16 v[22:23], v8 offset:30704
  s_waitcnt lgkmcnt(4)
  v_mfma_f32_16x16x32_bf16 v[120:123], v[12:15], v[40:43], v[120:123]
  v_mfma_f32_16x16x32_bf16 v[124:127], v[12:15], v[44:47], v[124:127]
  v_mfma_f32_16x16x32_bf16 v[128:131], v[12:15], v[48:51], v[128:131]
  v_mfma_f32_16x16x32_bf16 v[132:135], v[12:15], v[52:55], v[132:135]
  s_waitcnt lgkmcnt(0)
  s_barrier
  ds_read_b64_tr_b16 v[12:13], v3 offset:0
  ds_read_b64_tr_b16 v[14:15], v3 offset:1792
  v_mfma_f32_16x16x32_bf16 v[136:139], v[16:19], v[40:43], v[136:139]
  ds_read_b128 v[24:27], v9 offset:0
  v_mfma_f32_16x16x32_bf16 v[140:143], v[16:19], v[44:47], v[140:143]
  ds_read_b128 v[28:31], v9 offset:512
  v_mfma_f32_16x16x32_bf16 v[144:147], v[16:19], v[48:51], v[144:147]
  ds_read_b128 v[32:35], v9 offset:4096
  v_mfma_f32_16x16x32_bf16 v[148:151], v[16:19], v[52:55], v[148:151]
  ds_read_b128 v[36:39], v9 offset:4608
  ds_read_b64_tr_b16 v[16:17], v3 offset:40
  ds_read_b64_tr_b16 v[18:19], v3 offset:1832
  v_mfma_f32_16x16x32_bf16 v[152:155], v[20:23], v[40:43], v[152:155]
  v_mfma_f32_16x16x32_bf16 v[156:159], v[20:23], v[44:47], v[156:159]
  v_mfma_f32_16x16x32_bf16 v[160:163], v[20:23], v[48:51], v[160:163]
  v_mfma_f32_16x16x32_bf16 v[164:167], v[20:23], v[52:55], v[164:167]
  ds_read_b64_tr_b16 v[20:21], v4 offset:0
  ds_read_b64_tr_b16 v[22:23], v4 offset:1792
  s_sub_u32 s73, s73, 1
  s_cmp_lg_u32 s73, 0
  s_cbranch_scc1 K1_TT_LOOP
  s_waitcnt lgkmcnt(0)
  v_and_b32 v19, 15, v2
  v_lshrrev_b32 v20, 2, v19
  v_and_b32 v19, 3, v19
  v_lshl_add_u32 v12, v20, 3, v19
  v_lshrrev_b32 v13, 4, v2
  v_mov_b32 v22, 3049366176
  v_mov_b32 v23, 3049366176
  v_and_b32 v19, 1, v13
  v_lshl_add_u32 v19, v19, 2, v12
  v_lshlrev_b32 v19, 4, v19
  v_lshrrev_b32 v20, 1, v13
  v_lshl_add_u32 v14, v20, 9, v19
  s_lshl_b32 s58, s77, 5
  v_add_u32 v14, s58, v14
  v_add_u32 v19, s77, v12
  v_lshlrev_b32 v19, 3, v19
  v_lshl_add_u32 v15, v13, 14, v19
  v_mov_b32 v20, 0x7FF00000
  v_cmp_gt_u32 vcc, s50, v13
  s_nop 1
  v_cndmask_b32 v15, v20, v15, vcc
  v_add_u32 v19, s77, v12
  v_lshlrev_b32 v19, 2, v19
  v_mov_b32 v20, 0x7FF00000
  v_cmp_eq_u32 vcc, 2, v13
  s_nop 1
  v_cndmask_b32 v18, v20, v19, vcc
  s_lshl_b32 s58, s40, 1
  s_or_b32 s58, s58, s44
  s_cmp_eq_u32 s58, 1
  s_mov_b32 s83, 14811136
  s_cselect_b32 s83, s83, 0x7FF00000
  v_mul_f32 v3, 0xBFB8AA3B, v88
  v_mul_f32 v4, 0xBFB8AA3B, v92
  v_mul_f32 v5, 0xBFB8AA3B, v96
  v_mul_f32 v6, 0xBFB8AA3B, v100
  v_exp_f32 v3, v3
  v_exp_f32 v4, v4
  v_exp_f32 v5, v5
  v_exp_f32 v6, v6
  v_add_f32 v3, 1.0, v3
  v_add_f32 v4, 1.0, v4
  v_add_f32 v5, 1.0, v5
  v_add_f32 v6, 1.0, v6
  v_rcp_f32 v3, v3
  v_rcp_f32 v4, v4
  v_rcp_f32 v5, v5
  v_rcp_f32 v6, v6
  buffer_store_dword v3, v18, s[24:27], s83 offen offset:0 sc1
  buffer_store_dword v4, v18, s[24:27], s83 offen offset:16 sc1
  buffer_store_dword v5, v18, s[24:27], s83 offen offset:128 sc1
  buffer_store_dword v6, v18, s[24:27], s83 offen offset:144 sc1
  s_cmp_eq_u32 s66, 0
  s_cbranch_scc1 K1_TT_a_nophi
  v_pk_fma_f32 v[24:25], v[56:57], s[74:75], v[22:23]
  v_pk_fma_f32 v[26:27], v[58:59], s[74:75], v[22:23]
  v_pk_fma_f32 v[28:29], v[60:61], s[74:75], v[22:23]
  v_pk_fma_f32 v[30:31], v[62:63], s[74:75], v[22:23]
  v_pk_fma_f32 v[32:33], v[64:65], s[74:75], v[22:23]
  v_pk_fma_f32 v[34:35], v[66:67], s[74:75], v[22:23]
  v_pk_fma_f32 v[36:37], v[68:69], s[74:75], v[22:23]
  v_pk_fma_f32 v[38:39], v[70:71], s[74:75], v[22:23]
  v_exp_f32_e64 v24, v24 clamp
  v_max_f32 v56, s76, v56
  v_exp_f32_e64 v25, v25 clamp
  v_max_f32 v57, s76, v57
  v_exp_f32_e64 v26, v26 clamp
  v_max_f32 v58, s76, v58
  v_exp_f32_e64 v27, v27 clamp
  v_max_f32 v59, s76, v59
  v_exp_f32_e64 v28, v28 clamp
  v_max_f32 v60, s76, v60
  v_exp_f32_e64 v29, v29 clamp
  v_max_f32 v61, s76, v61
  v_exp_f32_e64 v30, v30 clamp
  v_max_f32 v62, s76, v62
  v_exp_f32_e64 v31, v31 clamp
  v_max_f32 v63, s76, v63
  v_exp_f32_e64 v32, v32 clamp
  v_max_f32 v64, s76, v64
  v_exp_f32_e64 v33, v33 clamp
  v_max_f32 v65, s76, v65
  v_exp_f32_e64 v34, v34 clamp
  v_max_f32 v66, s76, v66
  v_exp_f32_e64 v35, v35 clamp
  v_max_f32 v67, s76, v67
  v_exp_f32_e64 v36, v36 clamp
  v_max_f32 v68, s76, v68
  v_exp_f32_e64 v37, v37 clamp
  v_max_f32 v69, s76, v69
  v_exp_f32_e64 v38, v38 clamp
  v_max_f32 v70, s76, v70
  v_exp_f32_e64 v39, v39 clamp
  v_max_f32 v71, s76, v71
  v_pk_add_f32 v[56:57], v[56:57], v[24:25]
  v_pk_add_f32 v[58:59], v[58:59], v[26:27]
  v_pk_add_f32 v[60:61], v[60:61], v[28:29]
  v_pk_add_f32 v[62:63], v[62:63], v[30:31]
  v_pk_add_f32 v[64:65], v[64:65], v[32:33]
  v_pk_add_f32 v[66:67], v[66:67], v[34:35]
  v_pk_add_f32 v[68:69], v[68:69], v[36:37]
  v_pk_add_f32 v[70:71], v[70:71], v[38:39]
  v_cvt_pk_bf16_f32 v40, v56, v57
  v_cvt_pk_bf16_f32 v41, v58, v59
  v_cvt_pk_bf16_f32 v42, v60, v61
  v_cvt_pk_bf16_f32 v43, v62, v63
  s_add_u32 s58, s80, 0
  v_permlane16_swap_b32 v40, v42
  v_permlane16_swap_b32 v41, v43
  buffer_store_dwordx4 v[40:43], v14, s[24:27], s58 offen sc1
  v_cvt_pk_bf16_f32 v44, v64, v65
  v_cvt_pk_bf16_f32 v45, v66, v67
  v_cvt_pk_bf16_f32 v46, v68, v69
  v_cvt_pk_bf16_f32 v47, v70, v71
  s_add_u32 s58, s80, 1024
  v_permlane16_swap_b32 v44, v46
  v_permlane16_swap_b32 v45, v47
  buffer_store_dwordx4 v[44:47], v14, s[24:27], s58 offen sc1
  v_pk_fma_f32 v[24:25], v[72:73], s[74:75], v[22:23]
  v_pk_fma_f32 v[26:27], v[74:75], s[74:75], v[22:23]
  v_pk_fma_f32 v[28:29], v[76:77], s[74:75], v[22:23]
  v_pk_fma_f32 v[30:31], v[78:79], s[74:75], v[22:23]
  v_pk_fma_f32 v[32:33], v[80:81], s[74:75], v[22:23]
  v_pk_fma_f32 v[34:35], v[82:83], s[74:75], v[22:23]
  v_pk_fma_f32 v[36:37], v[84:85], s[74:75], v[22:23]
  v_pk_fma_f32 v[38:39], v[86:87], s[74:75], v[22:23]
  v_exp_f32_e64 v24, v24 clamp
  v_max_f32 v72, s76, v72
  v_exp_f32_e64 v25, v25 clamp
  v_max_f32 v73, s76, v73
  v_exp_f32_e64 v26, v26 clamp
  v_max_f32 v74, s76, v74
  v_exp_f32_e64 v27, v27 clamp
  v_max_f32 v75, s76, v75
  v_exp_f32_e64 v28, v28 clamp
  v_max_f32 v76, s76, v76
  v_exp_f32_e64 v29, v29 clamp
  v_max_f32 v77, s76, v77
  v_exp_f32_e64 v30, v30 clamp
  v_max_f32 v78, s76, v78
  v_exp_f32_e64 v31, v31 clamp
  v_max_f32 v79, s76, v79
  v_exp_f32_e64 v32, v32 clamp
  v_max_f32 v80, s76, v80
  v_exp_f32_e64 v33, v33 clamp
  v_max_f32 v81, s76, v81
  v_exp_f32_e64 v34, v34 clamp
  v_max_f32 v82, s76, v82
  v_exp_f32_e64 v35, v35 clamp
  v_max_f32 v83, s76, v83
  v_exp_f32_e64 v36, v36 clamp
  v_max_f32 v84, s76, v84
  v_exp_f32_e64 v37, v37 clamp
  v_max_f32 v85, s76, v85
  v_exp_f32_e64 v38, v38 clamp
  v_max_f32 v86, s76, v86
  v_exp_f32_e64 v39, v39 clamp
  v_max_f32 v87, s76, v87
  v_pk_add_f32 v[72:73], v[72:73], v[24:25]
  v_pk_add_f32 v[74:75], v[74:75], v[26:27]
  v_pk_add_f32 v[76:77], v[76:77], v[28:29]
  v_pk_add_f32 v[78:79], v[78:79], v[30:31]
  v_pk_add_f32 v[80:81], v[80:81], v[32:33]
  v_pk_add_f32 v[82:83], v[82:83], v[34:35]
  v_pk_add_f32 v[84:85], v[84:85], v[36:37]
  v_pk_add_f32 v[86:87], v[86:87], v[38:39]
  v_cvt_pk_bf16_f32 v48, v72, v73
  v_cvt_pk_bf16_f32 v49, v74, v75
  v_cvt_pk_bf16_f32 v50, v76, v77
  v_cvt_pk_bf16_f32 v51, v78, v79
  s_add_u32 s58, s80, 65536
  v_permlane16_swap_b32 v48, v50
  v_permlane16_swap_b32 v49, v51
  buffer_store_dwordx4 v[48:51], v14, s[24:27], s58 offen sc1
  v_cvt_pk_bf16_f32 v52, v80, v81
  v_cvt_pk_bf16_f32 v53, v82, v83
  v_cvt_pk_bf16_f32 v54, v84, v85
  v_cvt_pk_bf16_f32 v55, v86, v87
  s_add_u32 s58, s80, 66560
  v_permlane16_swap_b32 v52, v54
  v_permlane16_swap_b32 v53, v55
  buffer_store_dwordx4 v[52:55], v14, s[24:27], s58 offen sc1
  s_branch K1_TT_a_done
K1_TT_a_nophi:
  v_pk_mul_f32 v[56:57], v[56:57], s[30:31]
  v_pk_mul_f32 v[58:59], v[58:59], s[30:31]
  v_pk_mul_f32 v[60:61], v[60:61], s[30:31]
  v_pk_mul_f32 v[62:63], v[62:63], s[30:31]
  v_pk_mul_f32 v[64:65], v[64:65], s[30:31]
  v_pk_mul_f32 v[66:67], v[66:67], s[30:31]
  v_pk_mul_f32 v[68:69], v[68:69], s[30:31]
  v_pk_mul_f32 v[70:71], v[70:71], s[30:31]
  v_cvt_pk_bf16_f32 v40, v56, v57
  v_cvt_pk_bf16_f32 v41, v58, v59
  v_cvt_pk_bf16_f32 v42, v60, v61
  v_cvt_pk_bf16_f32 v43, v62, v63
  s_add_u32 s58, s80, 0
  v_permlane16_swap_b32 v40, v42
  v_permlane16_swap_b32 v41, v43
  buffer_store_dwordx4 v[40:43], v14, s[24:27], s58 offen sc1
  v_cvt_pk_bf16_f32 v44, v64, v65
  v_cvt_pk_bf16_f32 v45, v66, v67
  v_cvt_pk_bf16_f32 v46, v68, v69
  v_cvt_pk_bf16_f32 v47, v70, v71
  s_add_u32 s58, s80, 1024
  v_permlane16_swap_b32 v44, v46
  v_permlane16_swap_b32 v45, v47
  buffer_store_dwordx4 v[44:47], v14, s[24:27], s58 offen sc1
  v_pk_mul_f32 v[72:73], v[72:73], s[30:31]
  v_pk_mul_f32 v[74:75], v[74:75], s[30:31]
  v_pk_mul_f32 v[76:77], v[76:77], s[30:31]
  v_pk_mul_f32 v[78:79], v[78:79], s[30:31]
  v_pk_mul_f32 v[80:81], v[80:81], s[30:31]
  v_pk_mul_f32 v[82:83], v[82:83], s[30:31]
  v_pk_mul_f32 v[84:85], v[84:85], s[30:31]
  v_pk_mul_f32 v[86:87], v[86:87], s[30:31]
  v_cvt_pk_bf16_f32 v48, v72, v73
  v_cvt_pk_bf16_f32 v49, v74, v75
  v_cvt_pk_bf16_f32 v50, v76, v77
  v_cvt_pk_bf16_f32 v51, v78, v79
  s_add_u32 s58, s80, 65536
  v_permlane16_swap_b32 v48, v50
  v_permlane16_swap_b32 v49, v51
  buffer_store_dwordx4 v[48:51], v14, s[24:27], s58 offen sc1
  v_cvt_pk_bf16_f32 v52, v80, v81
  v_cvt_pk_bf16_f32 v53, v82, v83
  v_cvt_pk_bf16_f32 v54, v84, v85
  v_cvt_pk_bf16_f32 v55, v86, v87
  s_add_u32 s58, s80, 66560
  v_permlane16_swap_b32 v52, v54
  v_permlane16_swap_b32 v53, v55
  buffer_store_dwordx4 v[52:55], v14, s[24:27], s58 offen sc1
K1_TT_a_done:
  s_nop 1
  s_cmp_eq_u32 s67, 0
  s_cbranch_scc1 K1_TT_b_nophi
  v_pk_fma_f32 v[24:25], v[88:89], s[74:75], v[22:23]
  v_pk_fma_f32 v[26:27], v[90:91], s[74:75], v[22:23]
  v_pk_fma_f32 v[28:29], v[92:93], s[74:75], v[22:23]
  v_pk_fma_f32 v[30:31], v[94:95], s[74:75], v[22:23]
  v_pk_fma_f32 v[32:33], v[96:97], s[74:75], v[22:23]
  v_pk_fma_f32 v[34:35], v[98:99], s[74:75], v[22:23]
  v_pk_fma_f32 v[36:37], v[100:101], s[74:75], v[22:23]
  v_pk_fma_f32 v[38:39], v[102:103], s[74:75], v[22:23]
  v_exp_f32_e64 v24, v24 clamp
  v_max_f32 v88, s76, v88
  v_exp_f32_e64 v25, v25 clamp
  v_max_f32 v89, s76, v89
  v_exp_f32_e64 v26, v26 clamp
  v_max_f32 v90, s76, v90
  v_exp_f32_e64 v27, v27 clamp
  v_max_f32 v91, s76, v91
  v_exp_f32_e64 v28, v28 clamp
  v_max_f32 v92, s76, v92
  v_exp_f32_e64 v29, v29 clamp
  v_max_f32 v93, s76, v93
  v_exp_f32_e64 v30, v30 clamp
  v_max_f32 v94, s76, v94
  v_exp_f32_e64 v31, v31 clamp
  v_max_f32 v95, s76, v95
  v_exp_f32_e64 v32, v32 clamp
  v_max_f32 v96, s76, v96
  v_exp_f32_e64 v33, v33 clamp
  v_max_f32 v97, s76, v97
  v_exp_f32_e64 v34, v34 clamp
  v_max_f32 v98, s76, v98
  v_exp_f32_e64 v35, v35 clamp
  v_max_f32 v99, s76, v99
  v_exp_f32_e64 v36, v36 clamp
  v_max_f32 v100, s76, v100
  v_exp_f32_e64 v37, v37 clamp
  v_max_f32 v101, s76, v101
  v_exp_f32_e64 v38, v38 clamp
  v_max_f32 v102, s76, v102
  v_exp_f32_e64 v39, v39 clamp
  v_max_f32 v103, s76, v103
  v_pk_add_f32 v[88:89], v[88:89], v[24:25]
  v_pk_add_f32 v[90:91], v[90:91], v[26:27]
  v_pk_add_f32 v[92:93], v[92:93], v[28:29]
  v_pk_add_f32 v[94:95], v[94:95], v[30:31]
  v_pk_add_f32 v[96:97], v[96:97], v[32:33]
  v_pk_add_f32 v[98:99], v[98:99], v[34:35]
  v_pk_add_f32 v[100:101], v[100:101], v[36:37]
  v_pk_add_f32 v[102:103], v[102:103], v[38:39]
  v_cvt_pk_bf16_f32 v40, v88, v89
  v_cvt_pk_bf16_f32 v41, v90, v91
  v_cvt_pk_bf16_f32 v42, v92, v93
  v_cvt_pk_bf16_f32 v43, v94, v95
  buffer_store_dwordx2 v[40:41], v15, s[24:27], s82 offen offset:0 sc1
  buffer_store_dwordx2 v[42:43], v15, s[24:27], s82 offen offset:32 sc1
  v_cvt_pk_bf16_f32 v44, v96, v97
  v_cvt_pk_bf16_f32 v45, v98, v99
  v_cvt_pk_bf16_f32 v46, v100, v101
  v_cvt_pk_bf16_f32 v47, v102, v103
  buffer_store_dwordx2 v[44:45], v15, s[24:27], s82 offen offset:256 sc1
  buffer_store_dwordx2 v[46:47], v15, s[24:27], s82 offen offset:288 sc1
  v_pk_fma_f32 v[24:25], v[104:105], s[74:75], v[22:23]
  v_pk_fma_f32 v[26:27], v[106:107], s[74:75], v[22:23]
  v_pk_fma_f32 v[28:29], v[108:109], s[74:75], v[22:23]
  v_pk_fma_f32 v[30:31], v[110:111], s[74:75], v[22:23]
  v_pk_fma_f32 v[32:33], v[112:113], s[74:75], v[22:23]
  v_pk_fma_f32 v[34:35], v[114:115], s[74:75], v[22:23]
  v_pk_fma_f32 v[36:37], v[116:117], s[74:75], v[22:23]
  v_pk_fma_f32 v[38:39], v[118:119], s[74:75], v[22:23]
  v_exp_f32_e64 v24, v24 clamp
  v_max_f32 v104, s76, v104
  v_exp_f32_e64 v25, v25 clamp
  v_max_f32 v105, s76, v105
  v_exp_f32_e64 v26, v26 clamp
  v_max_f32 v106, s76, v106
  v_exp_f32_e64 v27, v27 clamp
  v_max_f32 v107, s76, v107
  v_exp_f32_e64 v28, v28 clamp
  v_max_f32 v108, s76, v108
  v_exp_f32_e64 v29, v29 clamp
  v_max_f32 v109, s76, v109
  v_exp_f32_e64 v30, v30 clamp
  v_max_f32 v110, s76, v110
  v_exp_f32_e64 v31, v31 clamp
  v_max_f32 v111, s76, v111
  v_exp_f32_e64 v32, v32 clamp
  v_max_f32 v112, s76, v112
  v_exp_f32_e64 v33, v33 clamp
  v_max_f32 v113, s76, v113
  v_exp_f32_e64 v34, v34 clamp
  v_max_f32 v114, s76, v114
  v_exp_f32_e64 v35, v35 clamp
  v_max_f32 v115, s76, v115
  v_exp_f32_e64 v36, v36 clamp
  v_max_f32 v116, s76, v116
  v_exp_f32_e64 v37, v37 clamp
  v_max_f32 v117, s76, v117
  v_exp_f32_e64 v38, v38 clamp
  v_max_f32 v118, s76, v118
  v_exp_f32_e64 v39, v39 clamp
  v_max_f32 v119, s76, v119
  v_pk_add_f32 v[104:105], v[104:105], v[24:25]
  v_pk_add_f32 v[106:107], v[106:107], v[26:27]
  v_pk_add_f32 v[108:109], v[108:109], v[28:29]
  v_pk_add_f32 v[110:111], v[110:111], v[30:31]
  v_pk_add_f32 v[112:113], v[112:113], v[32:33]
  v_pk_add_f32 v[114:115], v[114:115], v[34:35]
  v_pk_add_f32 v[116:117], v[116:117], v[36:37]
  v_pk_add_f32 v[118:119], v[118:119], v[38:39]
  v_cvt_pk_bf16_f32 v48, v104, v105
  v_cvt_pk_bf16_f32 v49, v106, v107
  v_cvt_pk_bf16_f32 v50, v108, v109
  v_cvt_pk_bf16_f32 v51, v110, v111
  s_add_u32 s58, s81, 0
  v_permlane16_swap_b32 v48, v50
  v_permlane16_swap_b32 v49, v51
  buffer_store_dwordx4 v[48:51], v14, s[24:27], s58 offen sc1
  v_cvt_pk_bf16_f32 v52, v112, v113
  v_cvt_pk_bf16_f32 v53, v114, v115
  v_cvt_pk_bf16_f32 v54, v116, v117
  v_cvt_pk_bf16_f32 v55, v118, v119
  s_add_u32 s58, s81, 1024
  v_permlane16_swap_b32 v52, v54
  v_permlane16_swap_b32 v53, v55
  buffer_store_dwordx4 v[52:55], v14, s[24:27], s58 offen sc1
  v_pk_fma_f32 v[24:25], v[120:121], s[74:75], v[22:23]
  v_pk_fma_f32 v[26:27], v[122:123], s[74:75], v[22:23]
  v_pk_fma_f32 v[28:29], v[124:125], s[74:75], v[22:23]
  v_pk_fma_f32 v[30:31], v[126:127], s[74:75], v[22:23]
  v_pk_fma_f32 v[32:33], v[128:129], s[74:75], v[22:23]
  v_pk_fma_f32 v[34:35], v[130:131], s[74:75], v[22:23]
  v_pk_fma_f32 v[36:37], v[132:133], s[74:75], v[22:23]
  v_pk_fma_f32 v[38:39], v[134:135], s[74:75], v[22:23]
  v_exp_f32_e64 v24, v24 clamp
  v_max_f32 v120, s76, v120
  v_exp_f32_e64 v25, v25 clamp
  v_max_f32 v121, s76, v121
  v_exp_f32_e64 v26, v26 clamp
  v_max_f32 v122, s76, v122
  v_exp_f32_e64 v27, v27 clamp
  v_max_f32 v123, s76, v123
  v_exp_f32_e64 v28, v28 clamp
  v_max_f32 v124, s76, v124
  v_exp_f32_e64 v29, v29 clamp
  v_max_f32 v125, s76, v125
  v_exp_f32_e64 v30, v30 clamp
  v_max_f32 v126, s76, v126
  v_exp_f32_e64 v31, v31 clamp
  v_max_f32 v127, s76, v127
  v_exp_f32_e64 v32, v32 clamp
  v_max_f32 v128, s76, v128
  v_exp_f32_e64 v33, v33 clamp
  v_max_f32 v129, s76, v129
  v_exp_f32_e64 v34, v34 clamp
  v_max_f32 v130, s76, v130
  v_exp_f32_e64 v35, v35 clamp
  v_max_f32 v131, s76, v131
  v_exp_f32_e64 v36, v36 clamp
  v_max_f32 v132, s76, v132
  v_exp_f32_e64 v37, v37 clamp
  v_max_f32 v133, s76, v133
  v_exp_f32_e64 v38, v38 clamp
  v_max_f32 v134, s76, v134
  v_exp_f32_e64 v39, v39 clamp
  v_max_f32 v135, s76, v135
  v_pk_add_f32 v[120:121], v[120:121], v[24:25]
  v_pk_add_f32 v[122:123], v[122:123], v[26:27]
  v_pk_add_f32 v[124:125], v[124:125], v[28:29]
  v_pk_add_f32 v[126:127], v[126:127], v[30:31]
  v_pk_add_f32 v[128:129], v[128:129], v[32:33]
  v_pk_add_f32 v[130:131], v[130:131], v[34:35]
  v_pk_add_f32 v[132:133], v[132:133], v[36:37]
  v_pk_add_f32 v[134:135], v[134:135], v[38:39]
  v_cvt_pk_bf16_f32 v40, v120, v121
  v_cvt_pk_bf16_f32 v41, v122, v123
  v_cvt_pk_bf16_f32 v42, v124, v125
  v_cvt_pk_bf16_f32 v43, v126, v127
  s_add_u32 s58, s81, 65536
  v_permlane16_swap_b32 v40, v42
  v_permlane16_swap_b32 v41, v43
  buffer_store_dwordx4 v[40:43], v14, s[24:27], s58 offen sc1
  v_cvt_pk_bf16_f32 v44, v128, v129
  v_cvt_pk_bf16_f32 v45, v130, v131
  v_cvt_pk_bf16_f32 v46, v132, v133
  v_cvt_pk_bf16_f32 v47, v134, v135
  s_add_u32 s58, s81, 66560
  v_permlane16_swap_b32 v44, v46
  v_permlane16_swap_b32 v45, v47
  buffer_store_dwordx4 v[44:47], v14, s[24:27], s58 offen sc1
  v_pk_fma_f32 v[24:25], v[136:137], s[74:75], v[22:23]
  v_pk_fma_f32 v[26:27], v[138:139], s[74:75], v[22:23]
  v_pk_fma_f32 v[28:29], v[140:141], s[74:75], v[22:23]
  v_pk_fma_f32 v[30:31], v[142:143], s[74:75], v[22:23]
  v_pk_fma_f32 v[32:33], v[144:145], s[74:75], v[22:23]
  v_pk_fma_f32 v[34:35], v[146:147], s[74:75], v[22:23]
  v_pk_fma_f32 v[36:37], v[148:149], s[74:75], v[22:23]
  v_pk_fma_f32 v[38:39], v[150:151], s[74:75], v[22:23]
  v_exp_f32_e64 v24, v24 clamp
  v_max_f32 v136, s76, v136
  v_exp_f32_e64 v25, v25 clamp
  v_max_f32 v137, s76, v137
  v_exp_f32_e64 v26, v26 clamp
  v_max_f32 v138, s76, v138
  v_exp_f32_e64 v27, v27 clamp
  v_max_f32 v139, s76, v139
  v_exp_f32_e64 v28, v28 clamp
  v_max_f32 v140, s76, v140
  v_exp_f32_e64 v29, v29 clamp
  v_max_f32 v141, s76, v141
  v_exp_f32_e64 v30, v30 clamp
  v_max_f32 v142, s76, v142
  v_exp_f32_e64 v31, v31 clamp
  v_max_f32 v143, s76, v143
  v_exp_f32_e64 v32, v32 clamp
  v_max_f32 v144, s76, v144
  v_exp_f32_e64 v33, v33 clamp
  v_max_f32 v145, s76, v145
  v_exp_f32_e64 v34, v34 clamp
  v_max_f32 v146, s76, v146
  v_exp_f32_e64 v35, v35 clamp
  v_max_f32 v147, s76, v147
  v_exp_f32_e64 v36, v36 clamp
  v_max_f32 v148, s76, v148
  v_exp_f32_e64 v37, v37 clamp
  v_max_f32 v149, s76, v149
  v_exp_f32_e64 v38, v38 clamp
  v_max_f32 v150, s76, v150
  v_exp_f32_e64 v39, v39 clamp
  v_max_f32 v151, s76, v151
  v_pk_add_f32 v[136:137], v[136:137], v[24:25]
  v_pk_add_f32 v[138:139], v[138:139], v[26:27]
  v_pk_add_f32 v[140:141], v[140:141], v[28:29]
  v_pk_add_f32 v[142:143], v[142:143], v[30:31]
  v_pk_add_f32 v[144:145], v[144:145], v[32:33]
  v_pk_add_f32 v[146:147], v[146:147], v[34:35]
  v_pk_add_f32 v[148:149], v[148:149], v[36:37]
  v_pk_add_f32 v[150:151], v[150:151], v[38:39]
  v_cvt_pk_bf16_f32 v48, v136, v137
  v_cvt_pk_bf16_f32 v49, v138, v139
  v_cvt_pk_bf16_f32 v50, v140, v141
  v_cvt_pk_bf16_f32 v51, v142, v143
  s_add_u32 s58, s81, 131072
  v_permlane16_swap_b32 v48, v50
  v_permlane16_swap_b32 v49, v51
  buffer_store_dwordx4 v[48:51], v14, s[24:27], s58 offen sc1
  v_cvt_pk_bf16_f32 v52, v144, v145
  v_cvt_pk_bf16_f32 v53, v146, v147
  v_cvt_pk_bf16_f32 v54, v148, v149
  v_cvt_pk_bf16_f32 v55, v150, v151
  s_add_u32 s58, s81, 132096
  v_permlane16_swap_b32 v52, v54
  v_permlane16_swap_b32 v53, v55
  buffer_store_dwordx4 v[52:55], v14, s[24:27], s58 offen sc1
  v_pk_fma_f32 v[24:25], v[152:153], s[74:75], v[22:23]
  v_pk_fma_f32 v[26:27], v[154:155], s[74:75], v[22:23]
  v_pk_fma_f32 v[28:29], v[156:157], s[74:75], v[22:23]
  v_pk_fma_f32 v[30:31], v[158:159], s[74:75], v[22:23]
  v_pk_fma_f32 v[32:33], v[160:161], s[74:75], v[22:23]
  v_pk_fma_f32 v[34:35], v[162:163], s[74:75], v[22:23]
  v_pk_fma_f32 v[36:37], v[164:165], s[74:75], v[22:23]
  v_pk_fma_f32 v[38:39], v[166:167], s[74:75], v[22:23]
  v_exp_f32_e64 v24, v24 clamp
  v_max_f32 v152, s76, v152
  v_exp_f32_e64 v25, v25 clamp
  v_max_f32 v153, s76, v153
  v_exp_f32_e64 v26, v26 clamp
  v_max_f32 v154, s76, v154
  v_exp_f32_e64 v27, v27 clamp
  v_max_f32 v155, s76, v155
  v_exp_f32_e64 v28, v28 clamp
  v_max_f32 v156, s76, v156
  v_exp_f32_e64 v29, v29 clamp
  v_max_f32 v157, s76, v157
  v_exp_f32_e64 v30, v30 clamp
  v_max_f32 v158, s76, v158
  v_exp_f32_e64 v31, v31 clamp
  v_max_f32 v159, s76, v159
  v_exp_f32_e64 v32, v32 clamp
  v_max_f32 v160, s76, v160
  v_exp_f32_e64 v33, v33 clamp
  v_max_f32 v161, s76, v161
  v_exp_f32_e64 v34, v34 clamp
  v_max_f32 v162, s76, v162
  v_exp_f32_e64 v35, v35 clamp
  v_max_f32 v163, s76, v163
  v_exp_f32_e64 v36, v36 clamp
  v_max_f32 v164, s76, v164
  v_exp_f32_e64 v37, v37 clamp
  v_max_f32 v165, s76, v165
  v_exp_f32_e64 v38, v38 clamp
  v_max_f32 v166, s76, v166
  v_exp_f32_e64 v39, v39 clamp
  v_max_f32 v167, s76, v167
  v_pk_add_f32 v[152:153], v[152:153], v[24:25]
  v_pk_add_f32 v[154:155], v[154:155], v[26:27]
  v_pk_add_f32 v[156:157], v[156:157], v[28:29]
  v_pk_add_f32 v[158:159], v[158:159], v[30:31]
  v_pk_add_f32 v[160:161], v[160:161], v[32:33]
  v_pk_add_f32 v[162:163], v[162:163], v[34:35]
  v_pk_add_f32 v[164:165], v[164:165], v[36:37]
  v_pk_add_f32 v[166:167], v[166:167], v[38:39]
  v_cvt_pk_bf16_f32 v40, v152, v153
  v_cvt_pk_bf16_f32 v41, v154, v155
  v_cvt_pk_bf16_f32 v42, v156, v157
  v_cvt_pk_bf16_f32 v43, v158, v159
  s_add_u32 s58, s81, 196608
  v_permlane16_swap_b32 v40, v42
  v_permlane16_swap_b32 v41, v43
  buffer_store_dwordx4 v[40:43], v14, s[24:27], s58 offen sc1
  v_cvt_pk_bf16_f32 v44, v160, v161
  v_cvt_pk_bf16_f32 v45, v162, v163
  v_cvt_pk_bf16_f32 v46, v164, v165
  v_cvt_pk_bf16_f32 v47, v166, v167
  s_add_u32 s58, s81, 197632
  v_permlane16_swap_b32 v44, v46
  v_permlane16_swap_b32 v45, v47
  buffer_store_dwordx4 v[44:47], v14, s[24:27], s58 offen sc1
  s_branch K1_TT_b_done
K1_TT_b_nophi:
  v_pk_mul_f32 v[88:89], v[88:89], s[14:15]
  v_pk_mul_f32 v[90:91], v[90:91], s[14:15]
  v_pk_mul_f32 v[92:93], v[92:93], s[14:15]
  v_pk_mul_f32 v[94:95], v[94:95], s[14:15]
  v_pk_mul_f32 v[96:97], v[96:97], s[14:15]
  v_pk_mul_f32 v[98:99], v[98:99], s[14:15]
  v_pk_mul_f32 v[100:101], v[100:101], s[14:15]
  v_pk_mul_f32 v[102:103], v[102:103], s[14:15]
  v_cvt_pk_bf16_f32 v40, v88, v89
  v_cvt_pk_bf16_f32 v41, v90, v91
  v_cvt_pk_bf16_f32 v42, v92, v93
  v_cvt_pk_bf16_f32 v43, v94, v95
  buffer_store_dwordx2 v[40:41], v15, s[24:27], s82 offen offset:0 sc1
  buffer_store_dwordx2 v[42:43], v15, s[24:27], s82 offen offset:32 sc1
  v_cvt_pk_bf16_f32 v44, v96, v97
  v_cvt_pk_bf16_f32 v45, v98, v99
  v_cvt_pk_bf16_f32 v46, v100, v101
  v_cvt_pk_bf16_f32 v47, v102, v103
  buffer_store_dwordx2 v[44:45], v15, s[24:27], s82 offen offset:256 sc1
  buffer_store_dwordx2 v[46:47], v15, s[24:27], s82 offen offset:288 sc1
  v_pk_mul_f32 v[104:105], v[104:105], s[14:15]
  v_pk_mul_f32 v[106:107], v[106:107], s[14:15]
  v_pk_mul_f32 v[108:109], v[108:109], s[14:15]
  v_pk_mul_f32 v[110:111], v[110:111], s[14:15]
  v_pk_mul_f32 v[112:113], v[112:113], s[14:15]
  v_pk_mul_f32 v[114:115], v[114:115], s[14:15]
  v_pk_mul_f32 v[116:117], v[116:117], s[14:15]
  v_pk_mul_f32 v[118:119], v[118:119], s[14:15]
  v_cvt_pk_bf16_f32 v48, v104, v105
  v_cvt_pk_bf16_f32 v49, v106, v107
  v_cvt_pk_bf16_f32 v50, v108, v109
  v_cvt_pk_bf16_f32 v51, v110, v111
  s_add_u32 s58, s81, 0
  v_permlane16_swap_b32 v48, v50
  v_permlane16_swap_b32 v49, v51
  buffer_store_dwordx4 v[48:51], v14, s[24:27], s58 offen sc1
  v_cvt_pk_bf16_f32 v52, v112, v113
  v_cvt_pk_bf16_f32 v53, v114, v115
  v_cvt_pk_bf16_f32 v54, v116, v117
  v_cvt_pk_bf16_f32 v55, v118, v119
  s_add_u32 s58, s81, 1024
  v_permlane16_swap_b32 v52, v54
  v_permlane16_swap_b32 v53, v55
  buffer_store_dwordx4 v[52:55], v14, s[24:27], s58 offen sc1
  v_pk_mul_f32 v[120:121], v[120:121], s[14:15]
  v_pk_mul_f32 v[122:123], v[122:123], s[14:15]
  v_pk_mul_f32 v[124:125], v[124:125], s[14:15]
  v_pk_mul_f32 v[126:127], v[126:127], s[14:15]
  v_pk_mul_f32 v[128:129], v[128:129], s[14:15]
  v_pk_mul_f32 v[130:131], v[130:131], s[14:15]
  v_pk_mul_f32 v[132:133], v[132:133], s[14:15]
  v_pk_mul_f32 v[134:135], v[134:135], s[14:15]
  v_cvt_pk_bf16_f32 v40, v120, v121
  v_cvt_pk_bf16_f32 v41, v122, v123
  v_cvt_pk_bf16_f32 v42, v124, v125
  v_cvt_pk_bf16_f32 v43, v126, v127
  s_add_u32 s58, s81, 65536
  v_permlane16_swap_b32 v40, v42
  v_permlane16_swap_b32 v41, v43
  buffer_store_dwordx4 v[40:43], v14, s[24:27], s58 offen sc1
  v_cvt_pk_bf16_f32 v44, v128, v129
  v_cvt_pk_bf16_f32 v45, v130, v131
  v_cvt_pk_bf16_f32 v46, v132, v133
  v_cvt_pk_bf16_f32 v47, v134, v135
  s_add_u32 s58, s81, 66560
  v_permlane16_swap_b32 v44, v46
  v_permlane16_swap_b32 v45, v47
  buffer_store_dwordx4 v[44:47], v14, s[24:27], s58 offen sc1
  v_pk_mul_f32 v[136:137], v[136:137], s[14:15]
  v_pk_mul_f32 v[138:139], v[138:139], s[14:15]
  v_pk_mul_f32 v[140:141], v[140:141], s[14:15]
  v_pk_mul_f32 v[142:143], v[142:143], s[14:15]
  v_pk_mul_f32 v[144:145], v[144:145], s[14:15]
  v_pk_mul_f32 v[146:147], v[146:147], s[14:15]
  v_pk_mul_f32 v[148:149], v[148:149], s[14:15]
  v_pk_mul_f32 v[150:151], v[150:151], s[14:15]
  v_cvt_pk_bf16_f32 v48, v136, v137
  v_cvt_pk_bf16_f32 v49, v138, v139
  v_cvt_pk_bf16_f32 v50, v140, v141
  v_cvt_pk_bf16_f32 v51, v142, v143
  s_add_u32 s58, s81, 131072
  v_permlane16_swap_b32 v48, v50
  v_permlane16_swap_b32 v49, v51
  buffer_store_dwordx4 v[48:51], v14, s[24:27], s58 offen sc1
  v_cvt_pk_bf16_f32 v52, v144, v145
  v_cvt_pk_bf16_f32 v53, v146, v147
  v_cvt_pk_bf16_f32 v54, v148, v149
  v_cvt_pk_bf16_f32 v55, v150, v151
  s_add_u32 s58, s81, 132096
  v_permlane16_swap_b32 v52, v54
  v_permlane16_swap_b32 v53, v55
  buffer_store_dwordx4 v[52:55], v14, s[24:27], s58 offen sc1
  v_pk_mul_f32 v[152:153], v[152:153], s[14:15]
  v_pk_mul_f32 v[154:155], v[154:155], s[14:15]
  v_pk_mul_f32 v[156:157], v[156:157], s[14:15]
  v_pk_mul_f32 v[158:159], v[158:159], s[14:15]
  v_pk_mul_f32 v[160:161], v[160:161], s[14:15]
  v_pk_mul_f32 v[162:163], v[162:163], s[14:15]
  v_pk_mul_f32 v[164:165], v[164:165], s[14:15]
  v_pk_mul_f32 v[166:167], v[166:167], s[14:15]
  v_cvt_pk_bf16_f32 v40, v152, v153
  v_cvt_pk_bf16_f32 v41, v154, v155
  v_cvt_pk_bf16_f32 v42, v156, v157
  v_cvt_pk_bf16_f32 v43, v158, v159
  s_add_u32 s58, s81, 196608
  v_permlane16_swap_b32 v40, v42
  v_permlane16_swap_b32 v41, v43
  buffer_store_dwordx4 v[40:43], v14, s[24:27], s58 offen sc1
  v_cvt_pk_bf16_f32 v44, v160, v161
  v_cvt_pk_bf16_f32 v45, v162, v163
  v_cvt_pk_bf16_f32 v46, v164, v165
  v_cvt_pk_bf16_f32 v47, v166, v167
  s_add_u32 s58, s81, 197632
  v_permlane16_swap_b32 v44, v46
  v_permlane16_swap_b32 v45, v47
  buffer_store_dwordx4 v[44:47], v14, s[24:27], s58 offen sc1
K1_TT_b_done:
  s_nop 1
  s_branch K1_FIN
K1_TN:
  s_cmp_eq_u32 s56, 3
  s_cselect_b32 s58, 2, s56
  s_lshl_b32 s58, s58, 21
  s_lshl_b32 s59, s53, 17
  s_add_u32 s80, s58, s59
  s_sub_u32 s58, s57, 3
  s_cmp_eq_u32 s57, 2
  s_cselect_b32 s58, 0, s58
  s_mul_i32 s58, s58, 2359296
  s_mul_i32 s59, s54, 147456
  s_add_u32 s81, s58, s59
  s_add_u32 s81, s81, 7340032
  s_sub_u32 s58, s57, 3
  s_cmp_eq_u32 s57, 2
  s_cselect_b32 s58, 0, s58
  s_mul_i32 s58, s58, 2359296
  s_mul_i32 s59, s55, 147456
  s_add_u32 s82, s58, s59
  s_add_u32 s82, s82, 7340032
  s_cmp_eq_u32 s56, 0
  s_cselect_b32 s30, 1051597459, 1.0
  s_mov_b32 s31, s30
  s_cmp_eq_u32 s57, 0
  s_cselect_b32 s14, 1051597459, 1.0
  s_mov_b32 s15, s14
  s_mov_b32 s74, 1069066811
  s_mov_b32 s75, 1069066811
  s_mov_b32 s76, 897988541
  s_barrier
  ds_read_b64_tr_b16 v[12:13], v3 offset:0
  ds_read_b64_tr_b16 v[14:15], v3 offset:1792
  ds_read_b128 v[24:27], v9 offset:0
  ds_read_b128 v[28:31], v9 offset:512
  ds_read_b128 v[32:35], v9 offset:4096
  ds_read_b128 v[36:39], v9 offset:4608
  ds_read_b64_tr_b16 v[16:17], v3 offset:40
  ds_read_b64_tr_b16 v[18:19], v3 offset:1832
  ds_read_b64_tr_b16 v[20:21], v4 offset:0
  ds_read_b64_tr_b16 v[22:23], v4 offset:1792
  s_waitcnt lgkmcnt(10)
K1_TN_LOOP:
  s_waitcnt lgkmcnt(7)
  v_mfma_f32_16x16x32_bf16 v[56:59], v[12:15], v[24:27], v[56:59]
  s_waitcnt lgkmcnt(6)
  v_mfma_f32_16x16x32_bf16 v[60:63], v[12:15], v[28:31], v[60:63]
  s_waitcnt lgkmcnt(5)
  v_mfma_f32_16x16x32_bf16 v[64:67], v[12:15], v[32:35], v[64:67]
  s_waitcnt lgkmcnt(4)
  v_mfma_f32_16x16x32_bf16 v[68:71], v[12:15], v[36:39], v[68:71]
  ds_read_b64_tr_b16 v[12:13], v5 offset:0
  ds_read_b64_tr_b16 v[14:15], v5 offset:1792
  s_waitcnt lgkmcnt(4)
  v_mfma_f32_16x16x32_bf16 v[72:75], v[16:19], v[24:27], v[72:75]
  v_mfma_f32_16x16x32_bf16 v[76:79], v[16:19], v[28:31], v[76:79]
  v_mfma_f32_16x16x32_bf16 v[80:83], v[16:19], v[32:35], v[80:83]
  v_mfma_f32_16x16x32_bf16 v[84:87], v[16:19], v[36:39], v[84:87]
  ds_read_b64_tr_b16 v[16:17], v5 offset:40
  ds_read_b64_tr_b16 v[18:19], v5 offset:1832
  s_waitcnt lgkmcnt(4)
  v_mfma_f32_16x16x32_bf16 v[88:91], v[24:27], v[20:23], v[88:91]
  v_mfma_f32_16x16x32_bf16 v[92:95], v[28:31], v[20:23], v[92:95]
  v_mfma_f32_16x16x32_bf16 v[96:99], v[32:35], v[20:23], v[96:99]
  v_mfma_f32_16x16x32_bf16 v[100:103], v[36:39], v[20:23], v[100:103]
  ds_read_b64_tr_b16 v[20:21], v5 offset:72
  ds_read_b64_tr_b16 v[22:23], v5 offset:1864
  s_waitcnt lgkmcnt(4)
  v_mfma_f32_16x16x32_bf16 v[104:107], v[24:27], v[12:15], v[104:107]
  v_mfma_f32_16x16x32_bf16 v[108:111], v[28:31], v[12:15], v[108:111]
  v_mfma_f32_16x16x32_bf16 v[112:115], v[32:35], v[12:15], v[112:115]
  v_mfma_f32_16x16x32_bf16 v[116:119], v[36:39], v[12:15], v[116:119]
  ds_read_b64_tr_b16 v[12:13], v5 offset:112
  ds_read_b64_tr_b16 v[14:15], v5 offset:1904
  s_waitcnt lgkmcnt(4)
  v_mfma_f32_16x16x32_bf16 v[120:123], v[24:27], v[16:19], v[120:123]
  v_mfma_f32_16x16x32_bf16 v[124:127], v[28:31], v[16:19], v[124:127]
  v_mfma_f32_16x16x32_bf16 v[128:131], v[32:35], v[16:19], v[128:131]
  v_mfma_f32_16x16x32_bf16 v[132:135], v[36:39], v[16:19], v[132:135]
  s_waitcnt lgkmcnt(0)
  s_barrier
  ds_read_b64_tr_b16 v[16:17], v3 offset:14400
  ds_read_b64_tr_b16 v[18:19], v3 offset:16192
  v_mfma_f32_16x16x32_bf16 v[136:139], v[24:27], v[20:23], v[136:139]
  ds_read_b128 v[40:43], v10 offset:0
  v_mfma_f32_16x16x32_bf16 v[140:143], v[28:31], v[20:23], v[140:143]
  ds_read_b128 v[44:47], v10 offset:512
  v_mfma_f32_16x16x32_bf16 v[144:147], v[32:35], v[20:23], v[144:147]
  ds_read_b128 v[48:51], v10 offset:4096
  v_mfma_f32_16x16x32_bf16 v[148:151], v[36:39], v[20:23], v[148:151]
  ds_read_b128 v[52:55], v10 offset:4608
  ds_read_b64_tr_b16 v[20:21], v3 offset:14440
  ds_read_b64_tr_b16 v[22:23], v3 offset:16232
  v_mfma_f32_16x16x32_bf16 v[152:155], v[24:27], v[12:15], v[152:155]
  v_mfma_f32_16x16x32_bf16 v[156:159], v[28:31], v[12:15], v[156:159]
  s_add_u32 s79, s79, 16384
  s_and_b32 s79, s79, 65535
  v_add_u32 v9, s79, v11
  v_xor_b32 v10, 64, v9
  v_mfma_f32_16x16x32_bf16 v[160:163], v[32:35], v[12:15], v[160:163]
  v_mfma_f32_16x16x32_bf16 v[164:167], v[36:39], v[12:15], v[164:167]
  ds_read_b64_tr_b16 v[12:13], v4 offset:14400
  ds_read_b64_tr_b16 v[14:15], v4 offset:16192
  s_waitcnt lgkmcnt(7)
  v_mfma_f32_16x16x32_bf16 v[56:59], v[16:19], v[40:43], v[56:59]
  s_waitcnt lgkmcnt(6)
  v_mfma_f32_16x16x32_bf16 v[60:63], v[16:19], v[44:47], v[60:63]
  s_waitcnt lgkmcnt(5)
  v_mfma_f32_16x16x32_bf16 v[64:67], v[16:19], v[48:51], v[64:67]
  s_waitcnt lgkmcnt(4)
  v_mfma_f32_16x16x32_bf16 v[68:71], v[16:19], v[52:55], v[68:71]
  ds_read_b64_tr_b16 v[16:17], v5 offset:14400
  ds_read_b64_tr_b16 v[18:19], v5 offset:16192
  s_waitcnt lgkmcnt(4)
  v_mfma_f32_16x16x32_bf16 v[72:75], v[20:23], v[40:43], v[72:75]
  v_mfma_f32_16x16x32_bf16 v[76:79], v[20:23], v[44:47], v[76:79]
  v_mfma_f32_16x16x32_bf16 v[80:83], v[20:23], v[48:51], v[80:83]
  v_mfma_f32_16x16x32_bf16 v[84:87], v[20:23], v[52:55], v[84:87]
  ds_read_b64_tr_b16 v[20:21], v5 offset:14440
  ds_read_b64_tr_b16 v[22:23], v5 offset:16232
  s_waitcnt lgkmcnt(4)
  v_mfma_f32_16x16x32_bf16 v[88:91], v[40:43], v[12:15], v[88:91]
  v_mfma_f32_16x16x32_bf16 v[92:95], v[44:47], v[12:15], v[92:95]
  v_mfma_f32_16x16x32_bf16 v[96:99], v[48:51], v[12:15], v[96:99]
  v_mfma_f32_16x16x32_bf16 v[100:103], v[52:55], v[12:15], v[100:103]
  ds_read_b64_tr_b16 v[12:13], v5 offset:14472
  ds_read_b64_tr_b16 v[14:15], v5 offset:16264
  s_waitcnt lgkmcnt(4)
  v_mfma_f32_16x16x32_bf16 v[104:107], v[40:43], v[16:19], v[104:107]
  v_mfma_f32_16x16x32_bf16 v[108:111], v[44:47], v[16:19], v[108:111]
  v_mfma_f32_16x16x32_bf16 v[112:115], v[48:51], v[16:19], v[112:115]
  v_mfma_f32_16x16x32_bf16 v[116:119], v[52:55], v[16:19], v[116:119]
  ds_read_b64_tr_b16 v[16:17], v5 offset:14512
  ds_read_b64_tr_b16 v[18:19], v5 offset:16304
  s_waitcnt lgkmcnt(4)
  v_mfma_f32_16x16x32_bf16 v[120:123], v[40:43], v[20:23], v[120:123]
  v_mfma_f32_16x16x32_bf16 v[124:127], v[44:47], v[20:23], v[124:127]
  v_mfma_f32_16x16x32_bf16 v[128:131], v[48:51], v[20:23], v[128:131]
  v_mfma_f32_16x16x32_bf16 v[132:135], v[52:55], v[20:23], v[132:135]
  s_waitcnt lgkmcnt(0)
  s_barrier
  ds_read_b64_tr_b16 v[20:21], v3 offset:28800
  ds_read_b64_tr_b16 v[22:23], v3 offset:30592
  v_mfma_f32_16x16x32_bf16 v[136:139], v[40:43], v[12:15], v[136:139]
  ds_read_b128 v[24:27], v9 offset:0
  v_mfma_f32_16x16x32_bf16 v[140:143], v[44:47], v[12:15], v[140:143]
  ds_read_b128 v[28:31], v9 offset:512
  v_mfma_f32_16x16x32_bf16 v[144:147], v[48:51], v[12:15], v[144:147]
  ds_read_b128 v[32:35], v9 offset:4096
  v_mfma_f32_16x16x32_bf16 v[148:151], v[52:55], v[12:15], v[148:151]
  ds_read_b128 v[36:39], v9 offset:4608
  ds_read_b64_tr_b16 v[12:13], v3 offset:28840
  ds_read_b64_tr_b16 v[14:15], v3 offset:30632
  v_mfma_f32_16x16x32_bf16 v[152:155], v[40:43], v[16:19], v[152:155]
  v_mfma_f32_16x16x32_bf16 v[156:159], v[44:47], v[16:19], v[156:159]
  v_mfma_f32_16x16x32_bf16 v[160:163], v[48:51], v[16:19], v[160:163]
  v_mfma_f32_16x16x32_bf16 v[164:167], v[52:55], v[16:19], v[164:167]
  ds_read_b64_tr_b16 v[16:17], v4 offset:28800
  ds_read_b64_tr_b16 v[18:19], v4 offset:30592
  s_waitcnt lgkmcnt(7)
  v_mfma_f32_16x16x32_bf16 v[56:59], v[20:23], v[24:27], v[56:59]
  s_waitcnt lgkmcnt(6)
  v_mfma_f32_16x16x32_bf16 v[60:63], v[20:23], v[28:31], v[60:63]
  s_waitcnt lgkmcnt(5)
  v_mfma_f32_16x16x32_bf16 v[64:67], v[20:23], v[32:35], v[64:67]
  s_waitcnt lgkmcnt(4)
  v_mfma_f32_16x16x32_bf16 v[68:71], v[20:23], v[36:39], v[68:71]
  ds_read_b64_tr_b16 v[20:21], v5 offset:28800
  ds_read_b64_tr_b16 v[22:23], v5 offset:30592
  s_waitcnt lgkmcnt(4)
  v_mfma_f32_16x16x32_bf16 v[72:75], v[12:15], v[24:27], v[72:75]
  v_mfma_f32_16x16x32_bf16 v[76:79], v[12:15], v[28:31], v[76:79]
  v_mfma_f32_16x16x32_bf16 v[80:83], v[12:15], v[32:35], v[80:83]
  v_mfma_f32_16x16x32_bf16 v[84:87], v[12:15], v[36:39], v[84:87]
  ds_read_b64_tr_b16 v[12:13], v5 offset:28840
  ds_read_b64_tr_b16 v[14:15], v5 offset:30632
  s_waitcnt lgkmcnt(4)
  v_mfma_f32_16x16x32_bf16 v[88:91], v[24:27], v[16:19], v[88:91]
  v_mfma_f32_16x16x32_bf16 v[92:95], v[28:31], v[16:19], v[92:95]
  v_mfma_f32_16x16x32_bf16 v[96:99], v[32:35], v[16:19], v[96:99]
  v_mfma_f32_16x16x32_bf16 v[100:103], v[36:39], v[16:19], v[100:103]
  ds_read_b64_tr_b16 v[16:17], v5 offset:28872
  ds_read_b64_tr_b16 v[18:19], v5 offset:30664
  s_waitcnt lgkmcnt(4)
  v_mfma_f32_16x16x32_bf16 v[104:107], v[24:27], v[20:23], v[104:107]
  v_mfma_f32_16x16x32_bf16 v[108:111], v[28:31], v[20:23], v[108:111]
  v_mfma_f32_16x16x32_bf16 v[112:115], v[32:35], v[20:23], v[112:115]
  v_mfma_f32_16x16x32_bf16 v[116:119], v[36:39], v[20:23], v[116:119]
  ds_read_b64_tr_b16 v[20:21], v5 offset:28912
  ds_read_b64_tr_b16 v[22:23], v5 offset:30704
  s_waitcnt lgkmcnt(4)
  v_mfma_f32_16x16x32_bf16 v[120:123], v[24:27], v[12:15], v[120:123]
  v_mfma_f32_16x16x32_bf16 v[124:127], v[28:31], v[12:15], v[124:127]
  v_mfma_f32_16x16x32_bf16 v[128:131], v[32:35], v[12:15], v[128:131]
  v_mfma_f32_16x16x32_bf16 v[132:135], v[36:39], v[12:15], v[132:135]
  s_waitcnt lgkmcnt(0)
  s_barrier
  ds_read_b64_tr_b16 v[12:13], v6 offset:0
  ds_read_b64_tr_b16 v[14:15], v6 offset:1792
  v_mfma_f32_16x16x32_bf16 v[136:139], v[24:27], v[16:19], v[136:139]
  ds_read_b128 v[40:43], v10 offset:0
  v_mfma_f32_16x16x32_bf16 v[140:143], v[28:31], v[16:19], v[140:143]
  ds_read_b128 v[44:47], v10 offset:512
  v_mfma_f32_16x16x32_bf16 v[144:147], v[32:35], v[16:19], v[144:147]
  ds_read_b128 v[48:51], v10 offset:4096
  v_mfma_f32_16x16x32_bf16 v[148:151], v[36:39], v[16:19], v[148:151]
  ds_read_b128 v[52:55], v10 offset:4608
  ds_read_b64_tr_b16 v[16:17], v6 offset:40
  ds_read_b64_tr_b16 v[18:19], v6 offset:1832
  v_mfma_f32_16x16x32_bf16 v[152:155], v[24:27], v[20:23], v[152:155]
  v_mfma_f32_16x16x32_bf16 v[156:159], v[28:31], v[20:23], v[156:159]
  s_add_u32 s79, s79, 16384
  s_and_b32 s79, s79, 65535
  v_add_u32 v9, s79, v11
  v_xor_b32 v10, 64, v9
  v_mfma_f32_16x16x32_bf16 v[160:163], v[32:35], v[20:23], v[160:163]
  v_mfma_f32_16x16x32_bf16 v[164:167], v[36:39], v[20:23], v[164:167]
  ds_read_b64_tr_b16 v[20:21], v7 offset:0
  ds_read_b64_tr_b16 v[22:23], v7 offset:1792
  s_waitcnt lgkmcnt(7)
  v_mfma_f32_16x16x32_bf16 v[56:59], v[12:15], v[40:43], v[56:59]
  s_waitcnt lgkmcnt(6)
  v_mfma_f32_16x16x32_bf16 v[60:63], v[12:15], v[44:47], v[60:63]
  s_waitcnt lgkmcnt(5)
  v_mfma_f32_16x16x32_bf16 v[64:67], v[12:15], v[48:51], v[64:67]
  s_waitcnt lgkmcnt(4)
  v_mfma_f32_16x16x32_bf16 v[68:71], v[12:15], v[52:55], v[68:71]
  ds_read_b64_tr_b16 v[12:13], v8 offset:0
  ds_read_b64_tr_b16 v[14:15], v8 offset:1792
  s_waitcnt lgkmcnt(4)
  v_mfma_f32_16x16x32_bf16 v[72:75], v[16:19], v[40:43], v[72:75]
  v_mfma_f32_16x16x32_bf16 v[76:79], v[16:19], v[44:47], v[76:79]
  v_mfma_f32_16x16x32_bf16 v[80:83], v[16:19], v[48:51], v[80:83]
  v_mfma_f32_16x16x32_bf16 v[84:87], v[16:19], v[52:55], v[84:87]
  ds_read_b64_tr_b16 v[16:17], v8 offset:40
  ds_read_b64_tr_b16 v[18:19], v8 offset:1832
  s_waitcnt lgkmcnt(4)
  v_mfma_f32_16x16x32_bf16 v[88:91], v[40:43], v[20:23], v[88:91]
  v_mfma_f32_16x16x32_bf16 v[92:95], v[44:47], v[20:23], v[92:95]
  v_mfma_f32_16x16x32_bf16 v[96:99], v[48:51], v[20:23], v[96:99]
  v_mfma_f32_16x16x32_bf16 v[100:103], v[52:55], v[20:23], v[100:103]
  ds_read_b64_tr_b16 v[20:21], v8 offset:72
  ds_read_b64_tr_b16 v[22:23], v8 offset:1864
  s_waitcnt lgkmcnt(4)
  v_mfma_f32_16x16x32_bf16 v[104:107], v[40:43], v[12:15], v[104:107]
  v_mfma_f32_16x16x32_bf16 v[108:111], v[44:47], v[12:15], v[108:111]
  v_mfma_f32_16x16x32_bf16 v[112:115], v[48:51], v[12:15], v[112:115]
  v_mfma_f32_16x16x32_bf16 v[116:119], v[52:55], v[12:15], v[116:119]
  ds_read_b64_tr_b16 v[12:13], v8 offset:112
  ds_read_b64_tr_b16 v[14:15], v8 offset:1904
  s_waitcnt lgkmcnt(4)
  v_mfma_f32_16x16x32_bf16 v[120:123], v[40:43], v[16:19], v[120:123]
  v_mfma_f32_16x16x32_bf16 v[124:127], v[44:47], v[16:19], v[124:127]
  v_mfma_f32_16x16x32_bf16 v[128:131], v[48:51], v[16:19], v[128:131]
  v_mfma_f32_16x16x32_bf16 v[132:135], v[52:55], v[16:19], v[132:135]
  s_waitcnt lgkmcnt(0)
  s_barrier
  ds_read_b64_tr_b16 v[16:17], v6 offset:14400
  ds_read_b64_tr_b16 v[18:19], v6 offset:16192
  v_mfma_f32_16x16x32_bf16 v[136:139], v[40:43], v[20:23], v[136:139]
  ds_read_b128 v[24:27], v9 offset:0
  v_mfma_f32_16x16x32_bf16 v[140:143], v[44:47], v[20:23], v[140:143]
  ds_read_b128 v[28:31], v9 offset:512
  v_mfma_f32_16x16x32_bf16 v[144:147], v[48:51], v[20:23], v[144:147]
  ds_read_b128 v[32:35], v9 offset:4096
  v_mfma_f32_16x16x32_bf16 v[148:151], v[52:55], v[20:23], v[148:151]
  ds_read_b128 v[36:39], v9 offset:4608
  ds_read_b64_tr_b16 v[20:21], v6 offset:14440
  ds_read_b64_tr_b16 v[22:23], v6 offset:16232
  v_mfma_f32_16x16x32_bf16 v[152:155], v[40:43], v[12:15], v[152:155]
  v_mfma_f32_16x16x32_bf16 v[156:159], v[44:47], v[12:15], v[156:159]
  v_mfma_f32_16x16x32_bf16 v[160:163], v[48:51], v[12:15], v[160:163]
  v_mfma_f32_16x16x32_bf16 v[164:167], v[52:55], v[12:15], v[164:167]
  ds_read_b64_tr_b16 v[12:13], v7 offset:14400
  ds_read_b64_tr_b16 v[14:15], v7 offset:16192
  s_waitcnt lgkmcnt(7)
  v_mfma_f32_16x16x32_bf16 v[56:59], v[16:19], v[24:27], v[56:59]
  s_waitcnt lgkmcnt(6)
  v_mfma_f32_16x16x32_bf16 v[60:63], v[16:19], v[28:31], v[60:63]
  s_waitcnt lgkmcnt(5)
  v_mfma_f32_16x16x32_bf16 v[64:67], v[16:19], v[32:35], v[64:67]
  s_waitcnt lgkmcnt(4)
  v_mfma_f32_16x16x32_bf16 v[68:71], v[16:19], v[36:39], v[68:71]
  ds_read_b64_tr_b16 v[16:17], v8 offset:14400
  ds_read_b64_tr_b16 v[18:19], v8 offset:16192
  s_waitcnt lgkmcnt(4)
  v_mfma_f32_16x16x32_bf16 v[72:75], v[20:23], v[24:27], v[72:75]
  v_mfma_f32_16x16x32_bf16 v[76:79], v[20:23], v[28:31], v[76:79]
  v_mfma_f32_16x16x32_bf16 v[80:83], v[20:23], v[32:35], v[80:83]
  v_mfma_f32_16x16x32_bf16 v[84:87], v[20:23], v[36:39], v[84:87]
  ds_read_b64_tr_b16 v[20:21], v8 offset:14440
  ds_read_b64_tr_b16 v[22:23], v8 offset:16232
  s_waitcnt lgkmcnt(4)
  v_mfma_f32_16x16x32_bf16 v[88:91], v[24:27], v[12:15], v[88:91]
  v_mfma_f32_16x16x32_bf16 v[92:95], v[28:31], v[12:15], v[92:95]
  v_mfma_f32_16x16x32_bf16 v[96:99], v[32:35], v[12:15], v[96:99]
  v_mfma_f32_16x16x32_bf16 v[100:103], v[36:39], v[12:15], v[100:103]
  ds_read_b64_tr_b16 v[12:13], v8 offset:14472
  ds_read_b64_tr_b16 v[14:15], v8 offset:16264
  s_waitcnt lgkmcnt(4)
  v_mfma_f32_16x16x32_bf16 v[104:107], v[24:27], v[16:19], v[104:107]
  v_mfma_f32_16x16x32_bf16 v[108:111], v[28:31], v[16:19], v[108:111]
  v_mfma_f32_16x16x32_bf16 v[112:115], v[32:35], v[16:19], v[112:115]
  v_mfma_f32_16x16x32_bf16 v[116:119], v[36:39], v[16:19], v[116:119]
  ds_read_b64_tr_b16 v[16:17], v8 offset:14512
  ds_read_b64_tr_b16 v[18:19], v8 offset:16304
  s_waitcnt lgkmcnt(4)
  v_mfma_f32_16x16x32_bf16 v[120:123], v[24:27], v[20:23], v[120:123]
  v_mfma_f32_16x16x32_bf16 v[124:127], v[28:31], v[20:23], v[124:127]
  v_mfma_f32_16x16x32_bf16 v[128:131], v[32:35], v[20:23], v[128:131]
  v_mfma_f32_16x16x32_bf16 v[132:135], v[36:39], v[20:23], v[132:135]
  s_waitcnt lgkmcnt(0)
  s_barrier
  ds_read_b64_tr_b16 v[20:21], v6 offset:28800
  ds_read_b64_tr_b16 v[22:23], v6 offset:30592
  v_mfma_f32_16x16x32_bf16 v[136:139], v[24:27], v[12:15], v[136:139]
  ds_read_b128 v[40:43], v10 offset:0
  v_mfma_f32_16x16x32_bf16 v[140:143], v[28:31], v[12:15], v[140:143]
  ds_read_b128 v[44:47], v10 offset:512
  v_mfma_f32_16x16x32_bf16 v[144:147], v[32:35], v[12:15], v[144:147]
  ds_read_b128 v[48:51], v10 offset:4096
  v_mfma_f32_16x16x32_bf16 v[148:151], v[36:39], v[12:15], v[148:151]
  ds_read_b128 v[52:55], v10 offset:4608
  ds_read_b64_tr_b16 v[12:13], v6 offset:28840
  ds_read_b64_tr_b16 v[14:15], v6 offset:30632
  v_mfma_f32_16x16x32_bf16 v[152:155], v[24:27], v[16:19], v[152:155]
  v_mfma_f32_16x16x32_bf16 v[156:159], v[28:31], v[16:19], v[156:159]
  s_add_u32 s79, s79, 16384
  s_and_b32 s79, s79, 65535
  v_add_u32 v9, s79, v11
  v_xor_b32 v10, 64, v9
  v_mfma_f32_16x16x32_bf16 v[160:163], v[32:35], v[16:19], v[160:163]
  v_mfma_f32_16x16x32_bf16 v[164:167], v[36:39], v[16:19], v[164:167]
  ds_read_b64_tr_b16 v[16:17], v7 offset:28800
  ds_read_b64_tr_b16 v[18:19], v7 offset:30592
  s_waitcnt lgkmcnt(7)
  v_mfma_f32_16x16x32_bf16 v[56:59], v[20:23], v[40:43], v[56:59]
  s_waitcnt lgkmcnt(6)
  v_mfma_f32_16x16x32_bf16 v[60:63], v[20:23], v[44:47], v[60:63]
  s_waitcnt lgkmcnt(5)
  v_mfma_f32_16x16x32_bf16 v[64:67], v[20:23], v[48:51], v[64:67]
  s_waitcnt lgkmcnt(4)
  v_mfma_f32_16x16x32_bf16 v[68:71], v[20:23], v[52:55], v[68:71]
  ds_read_b64_tr_b16 v[20:21], v8 offset:28800
  ds_read_b64_tr_b16 v[22:23], v8 offset:30592
  s_waitcnt lgkmcnt(4)
  v_mfma_f32_16x16x32_bf16 v[72:75], v[12:15], v[40:43], v[72:75]
  v_mfma_f32_16x16x32_bf16 v[76:79], v[12:15], v[44:47], v[76:79]
  v_mfma_f32_16x16x32_bf16 v[80:83], v[12:15], v[48:51], v[80:83]
  v_mfma_f32_16x16x32_bf16 v[84:87], v[12:15], v[52:55], v[84:87]
  ds_read_b64_tr_b16 v[12:13], v8 offset:28840
  ds_read_b64_tr_b16 v[14:15], v8 offset:30632
  s_waitcnt lgkmcnt(4)
  v_mfma_f32_16x16x32_bf16 v[88:91], v[40:43], v[16:19], v[88:91]
  v_mfma_f32_16x16x32_bf16 v[92:95], v[44:47], v[16:19], v[92:95]
  v_mfma_f32_16x16x32_bf16 v[96:99], v[48:51], v[16:19], v[96:99]
  v_mfma_f32_16x16x32_bf16 v[100:103], v[52:55], v[16:19], v[100:103]
  ds_read_b64_tr_b16 v[16:17], v8 offset:28872
  ds_read_b64_tr_b16 v[18:19], v8 offset:30664
  s_waitcnt lgkmcnt(4)
  v_mfma_f32_16x16x32_bf16 v[104:107], v[40:43], v[20:23], v[104:107]
  v_mfma_f32_16x16x32_bf16 v[108:111], v[44:47], v[20:23], v[108:111]
  v_mfma_f32_16x16x32_bf16 v[112:115], v[48:51], v[20:23], v[112:115]
  v_mfma_f32_16x16x32_bf16 v[116:119], v[52:55], v[20:23], v[116:119]
  ds_read_b64_tr_b16 v[20:21], v8 offset:28912
  ds_read_b64_tr_b16 v[22:23], v8 offset:30704
  s_waitcnt lgkmcnt(4)
  v_mfma_f32_16x16x32_bf16 v[120:123], v[40:43], v[12:15], v[120:123]
  v_mfma_f32_16x16x32_bf16 v[124:127], v[44:47], v[12:15], v[124:127]
  v_mfma_f32_16x16x32_bf16 v[128:131], v[48:51], v[12:15], v[128:131]
  v_mfma_f32_16x16x32_bf16 v[132:135], v[52:55], v[12:15], v[132:135]
  s_waitcnt lgkmcnt(0)
  s_barrier
  ds_read_b64_tr_b16 v[12:13], v3 offset:0
  ds_read_b64_tr_b16 v[14:15], v3 offset:1792
  v_mfma_f32_16x16x32_bf16 v[136:139], v[40:43], v[16:19], v[136:139]
  ds_read_b128 v[24:27], v9 offset:0
  v_mfma_f32_16x16x32_bf16 v[140:143], v[44:47], v[16:19], v[140:143]
  ds_read_b128 v[28:31], v9 offset:512
  v_mfma_f32_16x16x32_bf16 v[144:147], v[48:51], v[16:19], v[144:147]
  ds_read_b128 v[32:35], v9 offset:4096
  v_mfma_f32_16x16x32_bf16 v[148:151], v[52:55], v[16:19], v[148:151]
  ds_read_b128 v[36:39], v9 offset:4608
  ds_read_b64_tr_b16 v[16:17], v3 offset:40
  ds_read_b64_tr_b16 v[18:19], v3 offset:1832
  v_mfma_f32_16x16x32_bf16 v[152:155], v[40:43], v[20:23], v[152:155]
  v_mfma_f32_16x16x32_bf16 v[156:159], v[44:47], v[20:23], v[156:159]
  v_mfma_f32_16x16x32_bf16 v[160:163], v[48:51], v[20:23], v[160:163]
  v_mfma_f32_16x16x32_bf16 v[164:167], v[52:55], v[20:23], v[164:167]
  ds_read_b64_tr_b16 v[20:21], v4 offset:0
  ds_read_b64_tr_b16 v[22:23], v4 offset:1792
  s_sub_u32 s73, s73, 1
  s_cmp_lg_u32 s73, 0
  s_cbranch_scc1 K1_TN_LOOP
  s_waitcnt lgkmcnt(0)
  v_and_b32 v19, 15, v2
  v_lshrrev_b32 v20, 2, v19
  v_and_b32 v19, 3, v19
  v_lshl_add_u32 v12, v20, 3, v19
  v_lshrrev_b32 v13, 4, v2
  v_mov_b32 v22, 3049366176
  v_mov_b32 v23, 3049366176
  v_and_b32 v19, 1, v13
  v_lshl_add_u32 v19, v19, 2, v12
  v_lshlrev_b32 v19, 4, v19
  v_lshrrev_b32 v20, 1, v13
  v_lshl_add_u32 v14, v20, 9, v19
  s_lshl_b32 s58, s77, 5
  v_add_u32 v14, s58, v14
  s_lshr_b32 s58, s77, 3
  v_add_u32 v19, s58, v13
  v_mul_u32_u24 v19, 18, v19
  v_and_b32 v20, 15, v2
  v_add_u32 v16, v19, v20
  v_lshlrev_b32 v16, 4, v16
  v_and_b32 v21, 1, v20
  v_add3_u32 v21, v19, v21, 16
  v_lshlrev_b32 v21, 4, v21
  v_lshrrev_b32 v1, 1, v20
  s_mov_b32 s58, 73728
  v_mul_lo_u32 v1, v1, s58
  v_add_u32 v17, v21, v1
  v_mov_b32 v21, 0x7FF00000
  v_lshrrev_b32 v1, 2, v20
  v_cmp_gt_u32 vcc, s50, v1
  s_nop 1
  v_cndmask_b32 v17, v21, v17, vcc
  s_cmp_eq_u32 s66, 0
  s_cbranch_scc1 K1_TN_a_nophi
  v_pk_fma_f32 v[24:25], v[56:57], s[74:75], v[22:23]
  v_pk_fma_f32 v[26:27], v[58:59], s[74:75], v[22:23]
  v_pk_fma_f32 v[28:29], v[60:61], s[74:75], v[22:23]
  v_pk_fma_f32 v[30:31], v[62:63], s[74:75], v[22:23]
  v_pk_fma_f32 v[32:33], v[64:65], s[74:75], v[22:23]
  v_pk_fma_f32 v[34:35], v[66:67], s[74:75], v[22:23]
  v_pk_fma_f32 v[36:37], v[68:69], s[74:75], v[22:23]
  v_pk_fma_f32 v[38:39], v[70:71], s[74:75], v[22:23]
  v_exp_f32_e64 v24, v24 clamp
  v_max_f32 v56, s76, v56
  v_exp_f32_e64 v25, v25 clamp
  v_max_f32 v57, s76, v57
  v_exp_f32_e64 v26, v26 clamp
  v_max_f32 v58, s76, v58
  v_exp_f32_e64 v27, v27 clamp
  v_max_f32 v59, s76, v59
  v_exp_f32_e64 v28, v28 clamp
  v_max_f32 v60, s76, v60
  v_exp_f32_e64 v29, v29 clamp
  v_max_f32 v61, s76, v61
  v_exp_f32_e64 v30, v30 clamp
  v_max_f32 v62, s76, v62
  v_exp_f32_e64 v31, v31 clamp
  v_max_f32 v63, s76, v63
  v_exp_f32_e64 v32, v32 clamp
  v_max_f32 v64, s76, v64
  v_exp_f32_e64 v33, v33 clamp
  v_max_f32 v65, s76, v65
  v_exp_f32_e64 v34, v34 clamp
  v_max_f32 v66, s76, v66
  v_exp_f32_e64 v35, v35 clamp
  v_max_f32 v67, s76, v67
  v_exp_f32_e64 v36, v36 clamp
  v_max_f32 v68, s76, v68
  v_exp_f32_e64 v37, v37 clamp
  v_max_f32 v69, s76, v69
  v_exp_f32_e64 v38, v38 clamp
  v_max_f32 v70, s76, v70
  v_exp_f32_e64 v39, v39 clamp
  v_max_f32 v71, s76, v71
  v_pk_add_f32 v[56:57], v[56:57], v[24:25]
  v_pk_add_f32 v[58:59], v[58:59], v[26:27]
  v_pk_add_f32 v[60:61], v[60:61], v[28:29]
  v_pk_add_f32 v[62:63], v[62:63], v[30:31]
  v_pk_add_f32 v[64:65], v[64:65], v[32:33]
  v_pk_add_f32 v[66:67], v[66:67], v[34:35]
  v_pk_add_f32 v[68:69], v[68:69], v[36:37]
  v_pk_add_f32 v[70:71], v[70:71], v[38:39]
  v_cvt_pk_bf16_f32 v40, v56, v57
  v_cvt_pk_bf16_f32 v41, v58, v59
  v_cvt_pk_bf16_f32 v42, v60, v61
  v_cvt_pk_bf16_f32 v43, v62, v63
  s_add_u32 s58, s80, 0
  v_permlane16_swap_b32 v40, v42
  v_permlane16_swap_b32 v41, v43
  buffer_store_dwordx4 v[40:43], v14, s[24:27], s58 offen sc1
  v_cvt_pk_bf16_f32 v44, v64, v65
  v_cvt_pk_bf16_f32 v45, v66, v67
  v_cvt_pk_bf16_f32 v46, v68, v69
  v_cvt_pk_bf16_f32 v47, v70, v71
  s_add_u32 s58, s80, 1024
  v_permlane16_swap_b32 v44, v46
  v_permlane16_swap_b32 v45, v47
  buffer_store_dwordx4 v[44:47], v14, s[24:27], s58 offen sc1
  v_pk_fma_f32 v[24:25], v[72:73], s[74:75], v[22:23]
  v_pk_fma_f32 v[26:27], v[74:75], s[74:75], v[22:23]
  v_pk_fma_f32 v[28:29], v[76:77], s[74:75], v[22:23]
  v_pk_fma_f32 v[30:31], v[78:79], s[74:75], v[22:23]
  v_pk_fma_f32 v[32:33], v[80:81], s[74:75], v[22:23]
  v_pk_fma_f32 v[34:35], v[82:83], s[74:75], v[22:23]
  v_pk_fma_f32 v[36:37], v[84:85], s[74:75], v[22:23]
  v_pk_fma_f32 v[38:39], v[86:87], s[74:75], v[22:23]
  v_exp_f32_e64 v24, v24 clamp
  v_max_f32 v72, s76, v72
  v_exp_f32_e64 v25, v25 clamp
  v_max_f32 v73, s76, v73
  v_exp_f32_e64 v26, v26 clamp
  v_max_f32 v74, s76, v74
  v_exp_f32_e64 v27, v27 clamp
  v_max_f32 v75, s76, v75
  v_exp_f32_e64 v28, v28 clamp
  v_max_f32 v76, s76, v76
  v_exp_f32_e64 v29, v29 clamp
  v_max_f32 v77, s76, v77
  v_exp_f32_e64 v30, v30 clamp
  v_max_f32 v78, s76, v78
  v_exp_f32_e64 v31, v31 clamp
  v_max_f32 v79, s76, v79
  v_exp_f32_e64 v32, v32 clamp
  v_max_f32 v80, s76, v80
  v_exp_f32_e64 v33, v33 clamp
  v_max_f32 v81, s76, v81
  v_exp_f32_e64 v34, v34 clamp
  v_max_f32 v82, s76, v82
  v_exp_f32_e64 v35, v35 clamp
  v_max_f32 v83, s76, v83
  v_exp_f32_e64 v36, v36 clamp
  v_max_f32 v84, s76, v84
  v_exp_f32_e64 v37, v37 clamp
  v_max_f32 v85, s76, v85
  v_exp_f32_e64 v38, v38 clamp
  v_max_f32 v86, s76, v86
  v_exp_f32_e64 v39, v39 clamp
  v_max_f32 v87, s76, v87
  v_pk_add_f32 v[72:73], v[72:73], v[24:25]
  v_pk_add_f32 v[74:75], v[74:75], v[26:27]
  v_pk_add_f32 v[76:77], v[76:77], v[28:29]
  v_pk_add_f32 v[78:79], v[78:79], v[30:31]
  v_pk_add_f32 v[80:81], v[80:81], v[32:33]
  v_pk_add_f32 v[82:83], v[82:83], v[34:35]
  v_pk_add_f32 v[84:85], v[84:85], v[36:37]
  v_pk_add_f32 v[86:87], v[86:87], v[38:39]
  v_cvt_pk_bf16_f32 v48, v72, v73
  v_cvt_pk_bf16_f32 v49, v74, v75
  v_cvt_pk_bf16_f32 v50, v76, v77
  v_cvt_pk_bf16_f32 v51, v78, v79
  s_add_u32 s58, s80, 65536
  v_permlane16_swap_b32 v48, v50
  v_permlane16_swap_b32 v49, v51
  buffer_store_dwordx4 v[48:51], v14, s[24:27], s58 offen sc1
  v_cvt_pk_bf16_f32 v52, v80, v81
  v_cvt_pk_bf16_f32 v53, v82, v83
  v_cvt_pk_bf16_f32 v54, v84, v85
  v_cvt_pk_bf16_f32 v55, v86, v87
  s_add_u32 s58, s80, 66560
  v_permlane16_swap_b32 v52, v54
  v_permlane16_swap_b32 v53, v55
  buffer_store_dwordx4 v[52:55], v14, s[24:27], s58 offen sc1
  s_branch K1_TN_a_done
K1_TN_a_nophi:
  v_pk_mul_f32 v[56:57], v[56:57], s[30:31]
  v_pk_mul_f32 v[58:59], v[58:59], s[30:31]
  v_pk_mul_f32 v[60:61], v[60:61], s[30:31]
  v_pk_mul_f32 v[62:63], v[62:63], s[30:31]
  v_pk_mul_f32 v[64:65], v[64:65], s[30:31]
  v_pk_mul_f32 v[66:67], v[66:67], s[30:31]
  v_pk_mul_f32 v[68:69], v[68:69], s[30:31]
  v_pk_mul_f32 v[70:71], v[70:71], s[30:31]
  v_cvt_pk_bf16_f32 v40, v56, v57
  v_cvt_pk_bf16_f32 v41, v58, v59
  v_cvt_pk_bf16_f32 v42, v60, v61
  v_cvt_pk_bf16_f32 v43, v62, v63
  s_add_u32 s58, s80, 0
  v_permlane16_swap_b32 v40, v42
  v_permlane16_swap_b32 v41, v43
  buffer_store_dwordx4 v[40:43], v14, s[24:27], s58 offen sc1
  v_cvt_pk_bf16_f32 v44, v64, v65
  v_cvt_pk_bf16_f32 v45, v66, v67
  v_cvt_pk_bf16_f32 v46, v68, v69
  v_cvt_pk_bf16_f32 v47, v70, v71
  s_add_u32 s58, s80, 1024
  v_permlane16_swap_b32 v44, v46
  v_permlane16_swap_b32 v45, v47
  buffer_store_dwordx4 v[44:47], v14, s[24:27], s58 offen sc1
  v_pk_mul_f32 v[72:73], v[72:73], s[30:31]
  v_pk_mul_f32 v[74:75], v[74:75], s[30:31]
  v_pk_mul_f32 v[76:77], v[76:77], s[30:31]
  v_pk_mul_f32 v[78:79], v[78:79], s[30:31]
  v_pk_mul_f32 v[80:81], v[80:81], s[30:31]
  v_pk_mul_f32 v[82:83], v[82:83], s[30:31]
  v_pk_mul_f32 v[84:85], v[84:85], s[30:31]
  v_pk_mul_f32 v[86:87], v[86:87], s[30:31]
  v_cvt_pk_bf16_f32 v48, v72, v73
  v_cvt_pk_bf16_f32 v49, v74, v75
  v_cvt_pk_bf16_f32 v50, v76, v77
  v_cvt_pk_bf16_f32 v51, v78, v79
  s_add_u32 s58, s80, 65536
  v_permlane16_swap_b32 v48, v50
  v_permlane16_swap_b32 v49, v51
  buffer_store_dwordx4 v[48:51], v14, s[24:27], s58 offen sc1
  v_cvt_pk_bf16_f32 v52, v80, v81
  v_cvt_pk_bf16_f32 v53, v82, v83
  v_cvt_pk_bf16_f32 v54, v84, v85
  v_cvt_pk_bf16_f32 v55, v86, v87
  s_add_u32 s58, s80, 66560
  v_permlane16_swap_b32 v52, v54
  v_permlane16_swap_b32 v53, v55
  buffer_store_dwordx4 v[52:55], v14, s[24:27], s58 offen sc1
K1_TN_a_done:
  s_nop 1
  s_cmp_eq_u32 s67, 0
  s_cbranch_scc1 K1_TN_b_nophi
  v_pk_fma_f32 v[24:25], v[88:89], s[74:75], v[22:23]
  v_pk_fma_f32 v[26:27], v[90:91], s[74:75], v[22:23]
  v_pk_fma_f32 v[28:29], v[92:93], s[74:75], v[22:23]
  v_pk_fma_f32 v[30:31], v[94:95], s[74:75], v[22:23]
  v_pk_fma_f32 v[32:33], v[96:97], s[74:75], v[22:23]
  v_pk_fma_f32 v[34:35], v[98:99], s[74:75], v[22:23]
  v_pk_fma_f32 v[36:37], v[100:101], s[74:75], v[22:23]
  v_pk_fma_f32 v[38:39], v[102:103], s[74:75], v[22:23]
  v_exp_f32_e64 v24, v24 clamp
  v_max_f32 v88, s76, v88
  v_exp_f32_e64 v25, v25 clamp
  v_max_f32 v89, s76, v89
  v_exp_f32_e64 v26, v26 clamp
  v_max_f32 v90, s76, v90
  v_exp_f32_e64 v27, v27 clamp
  v_max_f32 v91, s76, v91
  v_exp_f32_e64 v28, v28 clamp
  v_max_f32 v92, s76, v92
  v_exp_f32_e64 v29, v29 clamp
  v_max_f32 v93, s76, v93
  v_exp_f32_e64 v30, v30 clamp
  v_max_f32 v94, s76, v94
  v_exp_f32_e64 v31, v31 clamp
  v_max_f32 v95, s76, v95
  v_exp_f32_e64 v32, v32 clamp
  v_max_f32 v96, s76, v96
  v_exp_f32_e64 v33, v33 clamp
  v_max_f32 v97, s76, v97
  v_exp_f32_e64 v34, v34 clamp
  v_max_f32 v98, s76, v98
  v_exp_f32_e64 v35, v35 clamp
  v_max_f32 v99, s76, v99
  v_exp_f32_e64 v36, v36 clamp
  v_max_f32 v100, s76, v100
  v_exp_f32_e64 v37, v37 clamp
  v_max_f32 v101, s76, v101
  v_exp_f32_e64 v38, v38 clamp
  v_max_f32 v102, s76, v102
  v_exp_f32_e64 v39, v39 clamp
  v_max_f32 v103, s76, v103
  v_pk_add_f32 v[88:89], v[88:89], v[24:25]
  v_pk_add_f32 v[90:91], v[90:91], v[26:27]
  v_pk_add_f32 v[92:93], v[92:93], v[28:29]
  v_pk_add_f32 v[94:95], v[94:95], v[30:31]
  v_pk_add_f32 v[96:97], v[96:97], v[32:33]
  v_pk_add_f32 v[98:99], v[98:99], v[34:35]
  v_pk_add_f32 v[100:101], v[100:101], v[36:37]
  v_pk_add_f32 v[102:103], v[102:103], v[38:39]
  v_cvt_pk_bf16_f32 v40, v88, v89
  v_cvt_pk_bf16_f32 v41, v90, v91
  v_cvt_pk_bf16_f32 v42, v92, v93
  v_cvt_pk_bf16_f32 v43, v94, v95
  s_add_u32 s58, s82, 0
  buffer_store_dwordx4 v[40:43], v17, s[24:27], s58 offen sc1
  v_cvt_pk_bf16_f32 v44, v96, v97
  v_cvt_pk_bf16_f32 v45, v98, v99
  v_cvt_pk_bf16_f32 v46, v100, v101
  v_cvt_pk_bf16_f32 v47, v102, v103
  s_add_u32 s58, s82, 1152
  buffer_store_dwordx4 v[44:47], v17, s[24:27], s58 offen sc1
  v_pk_fma_f32 v[24:25], v[104:105], s[74:75], v[22:23]
  v_pk_fma_f32 v[26:27], v[106:107], s[74:75], v[22:23]
  v_pk_fma_f32 v[28:29], v[108:109], s[74:75], v[22:23]
  v_pk_fma_f32 v[30:31], v[110:111], s[74:75], v[22:23]
  v_pk_fma_f32 v[32:33], v[112:113], s[74:75], v[22:23]
  v_pk_fma_f32 v[34:35], v[114:115], s[74:75], v[22:23]
  v_pk_fma_f32 v[36:37], v[116:117], s[74:75], v[22:23]
  v_pk_fma_f32 v[38:39], v[118:119], s[74:75], v[22:23]
  v_exp_f32_e64 v24, v24 clamp
  v_max_f32 v104, s76, v104
  v_exp_f32_e64 v25, v25 clamp
  v_max_f32 v105, s76, v105
  v_exp_f32_e64 v26, v26 clamp
  v_max_f32 v106, s76, v106
  v_exp_f32_e64 v27, v27 clamp
  v_max_f32 v107, s76, v107
  v_exp_f32_e64 v28, v28 clamp
  v_max_f32 v108, s76, v108
  v_exp_f32_e64 v29, v29 clamp
  v_max_f32 v109, s76, v109
  v_exp_f32_e64 v30, v30 clamp
  v_max_f32 v110, s76, v110
  v_exp_f32_e64 v31, v31 clamp
  v_max_f32 v111, s76, v111
  v_exp_f32_e64 v32, v32 clamp
  v_max_f32 v112, s76, v112
  v_exp_f32_e64 v33, v33 clamp
  v_max_f32 v113, s76, v113
  v_exp_f32_e64 v34, v34 clamp
  v_max_f32 v114, s76, v114
  v_exp_f32_e64 v35, v35 clamp
  v_max_f32 v115, s76, v115
  v_exp_f32_e64 v36, v36 clamp
  v_max_f32 v116, s76, v116
  v_exp_f32_e64 v37, v37 clamp
  v_max_f32 v117, s76, v117
  v_exp_f32_e64 v38, v38 clamp
  v_max_f32 v118, s76, v118
  v_exp_f32_e64 v39, v39 clamp
  v_max_f32 v119, s76, v119
  v_pk_add_f32 v[104:105], v[104:105], v[24:25]
  v_pk_add_f32 v[106:107], v[106:107], v[26:27]
  v_pk_add_f32 v[108:109], v[108:109], v[28:29]
  v_pk_add_f32 v[110:111], v[110:111], v[30:31]
  v_pk_add_f32 v[112:113], v[112:113], v[32:33]
  v_pk_add_f32 v[114:115], v[114:115], v[34:35]
  v_pk_add_f32 v[116:117], v[116:117], v[36:37]
  v_pk_add_f32 v[118:119], v[118:119], v[38:39]
  v_cvt_pk_bf16_f32 v48, v104, v105
  v_cvt_pk_bf16_f32 v49, v106, v107
  v_cvt_pk_bf16_f32 v50, v108, v109
  v_cvt_pk_bf16_f32 v51, v110, v111
  s_add_u32 s58, s81, 0
  buffer_store_dwordx4 v[48:51], v16, s[24:27], s58 offen sc1
  v_cvt_pk_bf16_f32 v52, v112, v113
  v_cvt_pk_bf16_f32 v53, v114, v115
  v_cvt_pk_bf16_f32 v54, v116, v117
  v_cvt_pk_bf16_f32 v55, v118, v119
  s_add_u32 s58, s81, 1152
  buffer_store_dwordx4 v[52:55], v16, s[24:27], s58 offen sc1
  v_pk_fma_f32 v[24:25], v[120:121], s[74:75], v[22:23]
  v_pk_fma_f32 v[26:27], v[122:123], s[74:75], v[22:23]
  v_pk_fma_f32 v[28:29], v[124:125], s[74:75], v[22:23]
  v_pk_fma_f32 v[30:31], v[126:127], s[74:75], v[22:23]
  v_pk_fma_f32 v[32:33], v[128:129], s[74:75], v[22:23]
  v_pk_fma_f32 v[34:35], v[130:131], s[74:75], v[22:23]
  v_pk_fma_f32 v[36:37], v[132:133], s[74:75], v[22:23]
  v_pk_fma_f32 v[38:39], v[134:135], s[74:75], v[22:23]
  v_exp_f32_e64 v24, v24 clamp
  v_max_f32 v120, s76, v120
  v_exp_f32_e64 v25, v25 clamp
  v_max_f32 v121, s76, v121
  v_exp_f32_e64 v26, v26 clamp
  v_max_f32 v122, s76, v122
  v_exp_f32_e64 v27, v27 clamp
  v_max_f32 v123, s76, v123
  v_exp_f32_e64 v28, v28 clamp
  v_max_f32 v124, s76, v124
  v_exp_f32_e64 v29, v29 clamp
  v_max_f32 v125, s76, v125
  v_exp_f32_e64 v30, v30 clamp
  v_max_f32 v126, s76, v126
  v_exp_f32_e64 v31, v31 clamp
  v_max_f32 v127, s76, v127
  v_exp_f32_e64 v32, v32 clamp
  v_max_f32 v128, s76, v128
  v_exp_f32_e64 v33, v33 clamp
  v_max_f32 v129, s76, v129
  v_exp_f32_e64 v34, v34 clamp
  v_max_f32 v130, s76, v130
  v_exp_f32_e64 v35, v35 clamp
  v_max_f32 v131, s76, v131
  v_exp_f32_e64 v36, v36 clamp
  v_max_f32 v132, s76, v132
  v_exp_f32_e64 v37, v37 clamp
  v_max_f32 v133, s76, v133
  v_exp_f32_e64 v38, v38 clamp
  v_max_f32 v134, s76, v134
  v_exp_f32_e64 v39, v39 clamp
  v_max_f32 v135, s76, v135
  v_pk_add_f32 v[120:121], v[120:121], v[24:25]
  v_pk_add_f32 v[122:123], v[122:123], v[26:27]
  v_pk_add_f32 v[124:125], v[124:125], v[28:29]
  v_pk_add_f32 v[126:127], v[126:127], v[30:31]
  v_pk_add_f32 v[128:129], v[128:129], v[32:33]
  v_pk_add_f32 v[130:131], v[130:131], v[34:35]
  v_pk_add_f32 v[132:133], v[132:133], v[36:37]
  v_pk_add_f32 v[134:135], v[134:135], v[38:39]
  v_cvt_pk_bf16_f32 v40, v120, v121
  v_cvt_pk_bf16_f32 v41, v122, v123
  v_cvt_pk_bf16_f32 v42, v124, v125
  v_cvt_pk_bf16_f32 v43, v126, v127
  s_add_u32 s58, s81, 73728
  buffer_store_dwordx4 v[40:43], v16, s[24:27], s58 offen sc1
  v_cvt_pk_bf16_f32 v44, v128, v129
  v_cvt_pk_bf16_f32 v45, v130, v131
  v_cvt_pk_bf16_f32 v46, v132, v133
  v_cvt_pk_bf16_f32 v47, v134, v135
  s_add_u32 s58, s81, 74880
  buffer_store_dwordx4 v[44:47], v16, s[24:27], s58 offen sc1
  v_pk_fma_f32 v[24:25], v[136:137], s[74:75], v[22:23]
  v_pk_fma_f32 v[26:27], v[138:139], s[74:75], v[22:23]
  v_pk_fma_f32 v[28:29], v[140:141], s[74:75], v[22:23]
  v_pk_fma_f32 v[30:31], v[142:143], s[74:75], v[22:23]
  v_pk_fma_f32 v[32:33], v[144:145], s[74:75], v[22:23]
  v_pk_fma_f32 v[34:35], v[146:147], s[74:75], v[22:23]
  v_pk_fma_f32 v[36:37], v[148:149], s[74:75], v[22:23]
  v_pk_fma_f32 v[38:39], v[150:151], s[74:75], v[22:23]
  v_exp_f32_e64 v24, v24 clamp
  v_max_f32 v136, s76, v136
  v_exp_f32_e64 v25, v25 clamp
  v_max_f32 v137, s76, v137
  v_exp_f32_e64 v26, v26 clamp
  v_max_f32 v138, s76, v138
  v_exp_f32_e64 v27, v27 clamp
  v_max_f32 v139, s76, v139
  v_exp_f32_e64 v28, v28 clamp
  v_max_f32 v140, s76, v140
  v_exp_f32_e64 v29, v29 clamp
  v_max_f32 v141, s76, v141
  v_exp_f32_e64 v30, v30 clamp
  v_max_f32 v142, s76, v142
  v_exp_f32_e64 v31, v31 clamp
  v_max_f32 v143, s76, v143
  v_exp_f32_e64 v32, v32 clamp
  v_max_f32 v144, s76, v144
  v_exp_f32_e64 v33, v33 clamp
  v_max_f32 v145, s76, v145
  v_exp_f32_e64 v34, v34 clamp
  v_max_f32 v146, s76, v146
  v_exp_f32_e64 v35, v35 clamp
  v_max_f32 v147, s76, v147
  v_exp_f32_e64 v36, v36 clamp
  v_max_f32 v148, s76, v148
  v_exp_f32_e64 v37, v37 clamp
  v_max_f32 v149, s76, v149
  v_exp_f32_e64 v38, v38 clamp
  v_max_f32 v150, s76, v150
  v_exp_f32_e64 v39, v39 clamp
  v_max_f32 v151, s76, v151
  v_pk_add_f32 v[136:137], v[136:137], v[24:25]
  v_pk_add_f32 v[138:139], v[138:139], v[26:27]
  v_pk_add_f32 v[140:141], v[140:141], v[28:29]
  v_pk_add_f32 v[142:143], v[142:143], v[30:31]
  v_pk_add_f32 v[144:145], v[144:145], v[32:33]
  v_pk_add_f32 v[146:147], v[146:147], v[34:35]
  v_pk_add_f32 v[148:149], v[148:149], v[36:37]
  v_pk_add_f32 v[150:151], v[150:151], v[38:39]
  v_cvt_pk_bf16_f32 v48, v136, v137
  v_cvt_pk_bf16_f32 v49, v138, v139
  v_cvt_pk_bf16_f32 v50, v140, v141
  v_cvt_pk_bf16_f32 v51, v142, v143
  s_add_u32 s58, s81, 147456
  buffer_store_dwordx4 v[48:51], v16, s[24:27], s58 offen sc1
  v_cvt_pk_bf16_f32 v52, v144, v145
  v_cvt_pk_bf16_f32 v53, v146, v147
  v_cvt_pk_bf16_f32 v54, v148, v149
  v_cvt_pk_bf16_f32 v55, v150, v151
  s_add_u32 s58, s81, 148608
  buffer_store_dwordx4 v[52:55], v16, s[24:27], s58 offen sc1
  v_pk_fma_f32 v[24:25], v[152:153], s[74:75], v[22:23]
  v_pk_fma_f32 v[26:27], v[154:155], s[74:75], v[22:23]
  v_pk_fma_f32 v[28:29], v[156:157], s[74:75], v[22:23]
  v_pk_fma_f32 v[30:31], v[158:159], s[74:75], v[22:23]
  v_pk_fma_f32 v[32:33], v[160:161], s[74:75], v[22:23]
  v_pk_fma_f32 v[34:35], v[162:163], s[74:75], v[22:23]
  v_pk_fma_f32 v[36:37], v[164:165], s[74:75], v[22:23]
  v_pk_fma_f32 v[38:39], v[166:167], s[74:75], v[22:23]
  v_exp_f32_e64 v24, v24 clamp
  v_max_f32 v152, s76, v152
  v_exp_f32_e64 v25, v25 clamp
  v_max_f32 v153, s76, v153
  v_exp_f32_e64 v26, v26 clamp
  v_max_f32 v154, s76, v154
  v_exp_f32_e64 v27, v27 clamp
  v_max_f32 v155, s76, v155
  v_exp_f32_e64 v28, v28 clamp
  v_max_f32 v156, s76, v156
  v_exp_f32_e64 v29, v29 clamp
  v_max_f32 v157, s76, v157
  v_exp_f32_e64 v30, v30 clamp
  v_max_f32 v158, s76, v158
  v_exp_f32_e64 v31, v31 clamp
  v_max_f32 v159, s76, v159
  v_exp_f32_e64 v32, v32 clamp
  v_max_f32 v160, s76, v160
  v_exp_f32_e64 v33, v33 clamp
  v_max_f32 v161, s76, v161
  v_exp_f32_e64 v34, v34 clamp
  v_max_f32 v162, s76, v162
  v_exp_f32_e64 v35, v35 clamp
  v_max_f32 v163, s76, v163
  v_exp_f32_e64 v36, v36 clamp
  v_max_f32 v164, s76, v164
  v_exp_f32_e64 v37, v37 clamp
  v_max_f32 v165, s76, v165
  v_exp_f32_e64 v38, v38 clamp
  v_max_f32 v166, s76, v166
  v_exp_f32_e64 v39, v39 clamp
  v_max_f32 v167, s76, v167
  v_pk_add_f32 v[152:153], v[152:153], v[24:25]
  v_pk_add_f32 v[154:155], v[154:155], v[26:27]
  v_pk_add_f32 v[156:157], v[156:157], v[28:29]
  v_pk_add_f32 v[158:159], v[158:159], v[30:31]
  v_pk_add_f32 v[160:161], v[160:161], v[32:33]
  v_pk_add_f32 v[162:163], v[162:163], v[34:35]
  v_pk_add_f32 v[164:165], v[164:165], v[36:37]
  v_pk_add_f32 v[166:167], v[166:167], v[38:39]
  v_cvt_pk_bf16_f32 v40, v152, v153
  v_cvt_pk_bf16_f32 v41, v154, v155
  v_cvt_pk_bf16_f32 v42, v156, v157
  v_cvt_pk_bf16_f32 v43, v158, v159
  s_add_u32 s58, s81, 221184
  buffer_store_dwordx4 v[40:43], v16, s[24:27], s58 offen sc1
  v_cvt_pk_bf16_f32 v44, v160, v161
  v_cvt_pk_bf16_f32 v45, v162, v163
  v_cvt_pk_bf16_f32 v46, v164, v165
  v_cvt_pk_bf16_f32 v47, v166, v167
  s_add_u32 s58, s81, 222336
  buffer_store_dwordx4 v[44:47], v16, s[24:27], s58 offen sc1
  s_branch K1_TN_b_done
K1_TN_b_nophi:
  v_cvt_pk_bf16_f32 v40, v88, v89
  v_cvt_pk_bf16_f32 v41, v90, v91
  v_cvt_pk_bf16_f32 v42, v92, v93
  v_cvt_pk_bf16_f32 v43, v94, v95
  s_add_u32 s58, s82, 0
  buffer_store_dwordx4 v[40:43], v17, s[24:27], s58 offen sc1
  v_cvt_pk_bf16_f32 v44, v96, v97
  v_cvt_pk_bf16_f32 v45, v98, v99
  v_cvt_pk_bf16_f32 v46, v100, v101
  v_cvt_pk_bf16_f32 v47, v102, v103
  s_add_u32 s58, s82, 1152
  buffer_store_dwordx4 v[44:47], v17, s[24:27], s58 offen sc1
  v_cvt_pk_bf16_f32 v48, v104, v105
  v_cvt_pk_bf16_f32 v49, v106, v107
  v_cvt_pk_bf16_f32 v50, v108, v109
  v_cvt_pk_bf16_f32 v51, v110, v111
  s_add_u32 s58, s81, 0
  buffer_store_dwordx4 v[48:51], v16, s[24:27], s58 offen sc1
  v_cvt_pk_bf16_f32 v52, v112, v113
  v_cvt_pk_bf16_f32 v53, v114, v115
  v_cvt_pk_bf16_f32 v54, v116, v117
  v_cvt_pk_bf16_f32 v55, v118, v119
  s_add_u32 s58, s81, 1152
  buffer_store_dwordx4 v[52:55], v16, s[24:27], s58 offen sc1
  v_cvt_pk_bf16_f32 v40, v120, v121
  v_cvt_pk_bf16_f32 v41, v122, v123
  v_cvt_pk_bf16_f32 v42, v124, v125
  v_cvt_pk_bf16_f32 v43, v126, v127
  s_add_u32 s58, s81, 73728
  buffer_store_dwordx4 v[40:43], v16, s[24:27], s58 offen sc1
  v_cvt_pk_bf16_f32 v44, v128, v129
  v_cvt_pk_bf16_f32 v45, v130, v131
  v_cvt_pk_bf16_f32 v46, v132, v133
  v_cvt_pk_bf16_f32 v47, v134, v135
  s_add_u32 s58, s81, 74880
  buffer_store_dwordx4 v[44:47], v16, s[24:27], s58 offen sc1
  v_cvt_pk_bf16_f32 v48, v136, v137
  v_cvt_pk_bf16_f32 v49, v138, v139
  v_cvt_pk_bf16_f32 v50, v140, v141
  v_cvt_pk_bf16_f32 v51, v142, v143
  s_add_u32 s58, s81, 147456
  buffer_store_dwordx4 v[48:51], v16, s[24:27], s58 offen sc1
  v_cvt_pk_bf16_f32 v52, v144, v145
  v_cvt_pk_bf16_f32 v53, v146, v147
  v_cvt_pk_bf16_f32 v54, v148, v149
  v_cvt_pk_bf16_f32 v55, v150, v151
  s_add_u32 s58, s81, 148608
  buffer_store_dwordx4 v[52:55], v16, s[24:27], s58 offen sc1
  v_cvt_pk_bf16_f32 v40, v152, v153
  v_cvt_pk_bf16_f32 v41, v154, v155
  v_cvt_pk_bf16_f32 v42, v156, v157
  v_cvt_pk_bf16_f32 v43, v158, v159
  s_add_u32 s58, s81, 221184
  buffer_store_dwordx4 v[40:43], v16, s[24:27], s58 offen sc1
  v_cvt_pk_bf16_f32 v44, v160, v161
  v_cvt_pk_bf16_f32 v45, v162, v163
  v_cvt_pk_bf16_f32 v46, v164, v165
  v_cvt_pk_bf16_f32 v47, v166, v167
  s_add_u32 s58, s81, 222336
  buffer_store_dwordx4 v[44:47], v16, s[24:27], s58 offen sc1
K1_TN_b_done:
  s_nop 1
  s_branch K1_FIN
K1_NT:
  s_sub_u32 s58, s56, 3
  s_cmp_eq_u32 s56, 2
  s_cselect_b32 s58, 0, s58
  s_mul_i32 s58, s58, 2359296
  s_mul_i32 s59, s53, 147456
  s_add_u32 s80, s58, s59
  s_add_u32 s80, s80, 7340032
  s_cmp_eq_u32 s57, 3
  s_cselect_b32 s58, 2, s57
  s_lshl_b32 s58, s58, 21
  s_lshl_b32 s59, s54, 17
  s_add_u32 s81, s58, s59
  s_cmp_eq_u32 s57, 3
  s_cselect_b32 s58, 2, s57
  s_lshl_b32 s58, s58, 18
  s_lshl_b32 s59, s55, 14
  s_add_u32 s82, s58, s59
  s_add_u32 s82, s82, 6291456
  s_cmp_eq_u32 s56, 0
  s_cselect_b32 s30, 1051597459, 1.0
  s_mov_b32 s31, s30
  s_cmp_eq_u32 s57, 0
  s_cselect_b32 s14, 1051597459, 1.0
  s_mov_b32 s15, s14
  s_mov_b32 s74, 1069066811
  s_mov_b32 s75, 1069066811
  s_mov_b32 s76, 897988541
  s_barrier
  ds_read_b64_tr_b16 v[12:13], v3 offset:0
  ds_read_b64_tr_b16 v[14:15], v3 offset:1792
  ds_read_b128 v[24:27], v9 offset:0
  ds_read_b128 v[28:31], v9 offset:512
  ds_read_b128 v[32:35], v9 offset:4096
  ds_read_b128 v[36:39], v9 offset:4608
  ds_read_b64_tr_b16 v[16:17], v3 offset:40
  ds_read_b64_tr_b16 v[18:19], v3 offset:1832
  ds_read_b64_tr_b16 v[20:21], v4 offset:0
  ds_read_b64_tr_b16 v[22:23], v4 offset:1792
  s_waitcnt lgkmcnt(10)
K1_NT_LOOP:
  s_waitcnt lgkmcnt(7)
  v_mfma_f32_16x16x32_bf16 v[56:59], v[24:27], v[12:15], v[56:59]
  s_waitcnt lgkmcnt(6)
  v_mfma_f32_16x16x32_bf16 v[60:63], v[28:31], v[12:15], v[60:63]
  s_waitcnt lgkmcnt(5)
  v_mfma_f32_16x16x32_bf16 v[64:67], v[32:35], v[12:15], v[64:67]
  s_waitcnt lgkmcnt(4)
  v_mfma_f32_16x16x32_bf16 v[68:71], v[36:39], v[12:15], v[68:71]
  ds_read_b64_tr_b16 v[12:13], v5 offset:0
  ds_read_b64_tr_b16 v[14:15], v5 offset:1792
  s_waitcnt lgkmcnt(4)
  v_mfma_f32_16x16x32_bf16 v[72:75], v[24:27], v[16:19], v[72:75]
  v_mfma_f32_16x16x32_bf16 v[76:79], v[28:31], v[16:19], v[76:79]
  v_mfma_f32_16x16x32_bf16 v[80:83], v[32:35], v[16:19], v[80:83]
  v_mfma_f32_16x16x32_bf16 v[84:87], v[36:39], v[16:19], v[84:87]
  ds_read_b64_tr_b16 v[16:17], v5 offset:40
  ds_read_b64_tr_b16 v[18:19], v5 offset:1832
  s_waitcnt lgkmcnt(4)
  v_mfma_f32_16x16x32_bf16 v[88:91], v[20:23], v[24:27], v[88:91]
  v_mfma_f32_16x16x32_bf16 v[92:95], v[20:23], v[28:31], v[92:95]
  v_mfma_f32_16x16x32_bf16 v[96:99], v[20:23], v[32:35], v[96:99]
  v_mfma_f32_16x16x32_bf16 v[100:103], v[20:23], v[36:39], v[100:103]
  ds_read_b64_tr_b16 v[20:21], v5 offset:72
  ds_read_b64_tr_b16 v[22:23], v5 offset:1864
  s_waitcnt lgkmcnt(4)
  v_mfma_f32_16x16x32_bf16 v[104:107], v[12:15], v[24:27], v[104:107]
  v_mfma_f32_16x16x32_bf16 v[108:111], v[12:15], v[28:31], v[108:111]
  v_mfma_f32_16x16x32_bf16 v[112:115], v[12:15], v[32:35], v[112:115]
  v_mfma_f32_16x16x32_bf16 v[116:119], v[12:15], v[36:39], v[116:119]
  ds_read_b64_tr_b16 v[12:13], v5 offset:112
  ds_read_b64_tr_b16 v[14:15], v5 offset:1904
  s_waitcnt lgkmcnt(4)
  v_mfma_f32_16x16x32_bf16 v[120:123], v[16:19], v[24:27], v[120:123]
  v_mfma_f32_16x16x32_bf16 v[124:127], v[16:19], v[28:31], v[124:127]
  v_mfma_f32_16x16x32_bf16 v[128:131], v[16:19], v[32:35], v[128:131]
  v_mfma_f32_16x16x32_bf16 v[132:135], v[16:19], v[36:39], v[132:135]
  s_waitcnt lgkmcnt(0)
  s_barrier
  ds_read_b64_tr_b16 v[16:17], v3 offset:14400
  ds_read_b64_tr_b16 v[18:19], v3 offset:16192
  v_mfma_f32_16x16x32_bf16 v[136:139], v[20:23], v[24:27], v[136:139]
  ds_read_b128 v[40:43], v10 offset:0
  v_mfma_f32_16x16x32_bf16 v[140:143], v[20:23], v[28:31], v[140:143]
  ds_read_b128 v[44:47], v10 offset:512
  v_mfma_f32_16x16x32_bf16 v[144:147], v[20:23], v[32:35], v[144:147]
  ds_read_b128 v[48:51], v10 offset:4096
  v_mfma_f32_16x16x32_bf16 v[148:151], v[20:23], v[36:39], v[148:151]
  ds_read_b128 v[52:55], v10 offset:4608
  ds_read_b64_tr_b16 v[20:21], v3 offset:14440
  ds_read_b64_tr_b16 v[22:23], v3 offset:16232
  v_mfma_f32_16x16x32_bf16 v[152:155], v[12:15], v[24:27], v[152:155]
  v_mfma_f32_16x16x32_bf16 v[156:159], v[12:15], v[28:31], v[156:159]
  s_add_u32 s79, s79, 16384
  s_and_b32 s79, s79, 65535
  v_add_u32 v9, s79, v11
  v_xor_b32 v10, 64, v9
  v_mfma_f32_16x16x32_bf16 v[160:163], v[12:15], v[32:35], v[160:163]
  v_mfma_f32_16x16x32_bf16 v[164:167], v[12:15], v[36:39], v[164:167]
  ds_read_b64_tr_b16 v[12:13], v4 offset:14400
  ds_read_b64_tr_b16 v[14:15], v4 offset:16192
  s_waitcnt lgkmcnt(7)
  v_mfma_f32_16x16x32_bf16 v[56:59], v[40:43], v[16:19], v[56:59]
  s_waitcnt lgkmcnt(6)
  v_mfma_f32_16x16x32_bf16 v[60:63], v[44:47], v[16:19], v[60:63]
  s_waitcnt lgkmcnt(5)
  v_mfma_f32_16x16x32_bf16 v[64:67], v[48:51], v[16:19], v[64:67]
  s_waitcnt lgkmcnt(4)
  v_mfma_f32_16x16x32_bf16 v[68:71], v[52:55], v[16:19], v[68:71]
  ds_read_b64_tr_b16 v[16:17], v5 offset:14400
  ds_read_b64_tr_b16 v[18:19], v5 offset:16192
  s_waitcnt lgkmcnt(4)
  v_mfma_f32_16x16x32_bf16 v[72:75], v[40:43], v[20:23], v[72:75]
  v_mfma_f32_16x16x32_bf16 v[76:79], v[44:47], v[20:23], v[76:79]
  v_mfma_f32_16x16x32_bf16 v[80:83], v[48:51], v[20:23], v[80:83]
  v_mfma_f32_16x16x32_bf16 v[84:87], v[52:55], v[20:23], v[84:87]
  ds_read_b64_tr_b16 v[20:21], v5 offset:14440
  ds_read_b64_tr_b16 v[22:23], v5 offset:16232
  s_waitcnt lgkmcnt(4)
  v_mfma_f32_16x16x32_bf16 v[88:91], v[12:15], v[40:43], v[88:91]
  v_mfma_f32_16x16x32_bf16 v[92:95], v[12:15], v[44:47], v[92:95]
  v_mfma_f32_16x16x32_bf16 v[96:99], v[12:15], v[48:51], v[96:99]
  v_mfma_f32_16x16x32_bf16 v[100:103], v[12:15], v[52:55], v[100:103]
  ds_read_b64_tr_b16 v[12:13], v5 offset:14472
  ds_read_b64_tr_b16 v[14:15], v5 offset:16264
  s_waitcnt lgkmcnt(4)
  v_mfma_f32_16x16x32_bf16 v[104:107], v[16:19], v[40:43], v[104:107]
  v_mfma_f32_16x16x32_bf16 v[108:111], v[16:19], v[44:47], v[108:111]
  v_mfma_f32_16x16x32_bf16 v[112:115], v[16:19], v[48:51], v[112:115]
  v_mfma_f32_16x16x32_bf16 v[116:119], v[16:19], v[52:55], v[116:119]
  ds_read_b64_tr_b16 v[16:17], v5 offset:14512
  ds_read_b64_tr_b16 v[18:19], v5 offset:16304
  s_waitcnt lgkmcnt(4)
  v_mfma_f32_16x16x32_bf16 v[120:123], v[20:23], v[40:43], v[120:123]
  v_mfma_f32_16x16x32_bf16 v[124:127], v[20:23], v[44:47], v[124:127]
  v_mfma_f32_16x16x32_bf16 v[128:131], v[20:23], v[48:51], v[128:131]
  v_mfma_f32_16x16x32_bf16 v[132:135], v[20:23], v[52:55], v[132:135]
  s_waitcnt lgkmcnt(0)
  s_barrier
  ds_read_b64_tr_b16 v[20:21], v3 offset:28800
  ds_read_b64_tr_b16 v[22:23], v3 offset:30592
  v_mfma_f32_16x16x32_bf16 v[136:139], v[12:15], v[40:43], v[136:139]
  ds_read_b128 v[24:27], v9 offset:0
  v_mfma_f32_16x16x32_bf16 v[140:143], v[12:15], v[44:47], v[140:143]
  ds_read_b128 v[28:31], v9 offset:512
  v_mfma_f32_16x16x32_bf16 v[144:147], v[12:15], v[48:51], v[144:147]
  ds_read_b128 v[32:35], v9 offset:4096
  v_mfma_f32_16x16x32_bf16 v[148:151], v[12:15], v[52:55], v[148:151]
  ds_read_b128 v[36:39], v9 offset:4608
  ds_read_b64_tr_b16 v[12:13], v3 offset:28840
  ds_read_b64_tr_b16 v[14:15], v3 offset:30632
  v_mfma_f32_16x16x32_bf16 v[152:155], v[16:19], v[40:43], v[152:155]
  v_mfma_f32_16x16x32_bf16 v[156:159], v[16:19], v[44:47], v[156:159]
  v_mfma_f32_16x16x32_bf16 v[160:163], v[16:19], v[48:51], v[160:163]
  v_mfma_f32_16x16x32_bf16 v[164:167], v[16:19], v[52:55], v[164:167]
  ds_read_b64_tr_b16 v[16:17], v4 offset:28800
  ds_read_b64_tr_b16 v[18:19], v4 offset:30592
  s_waitcnt lgkmcnt(7)
  v_mfma_f32_16x16x32_bf16 v[56:59], v[24:27], v[20:23], v[56:59]
  s_waitcnt lgkmcnt(6)
  v_mfma_f32_16x16x32_bf16 v[60:63], v[28:31], v[20:23], v[60:63]
  s_waitcnt lgkmcnt(5)
  v_mfma_f32_16x16x32_bf16 v[64:67], v[32:35], v[20:23], v[64:67]
  s_waitcnt lgkmcnt(4)
  v_mfma_f32_16x16x32_bf16 v[68:71], v[36:39], v[20:23], v[68:71]
  ds_read_b64_tr_b16 v[20:21], v5 offset:28800
  ds_read_b64_tr_b16 v[22:23], v5 offset:30592
  s_waitcnt lgkmcnt(4)
  v_mfma_f32_16x16x32_bf16 v[72:75], v[24:27], v[12:15], v[72:75]
  v_mfma_f32_16x16x32_bf16 v[76:79], v[28:31], v[12:15], v[76:79]
  v_mfma_f32_16x16x32_bf16 v[80:83], v[32:35], v[12:15], v[80:83]
  v_mfma_f32_16x16x32_bf16 v[84:87], v[36:39], v[12:15], v[84:87]
  ds_read_b64_tr_b16 v[12:13], v5 offset:28840
  ds_read_b64_tr_b16 v[14:15], v5 offset:30632
  s_waitcnt lgkmcnt(4)
  v_mfma_f32_16x16x32_bf16 v[88:91], v[16:19], v[24:27], v[88:91]
  v_mfma_f32_16x16x32_bf16 v[92:95], v[16:19], v[28:31], v[92:95]
  v_mfma_f32_16x16x32_bf16 v[96:99], v[16:19], v[32:35], v[96:99]
  v_mfma_f32_16x16x32_bf16 v[100:103], v[16:19], v[36:39], v[100:103]
  ds_read_b64_tr_b16 v[16:17], v5 offset:28872
  ds_read_b64_tr_b16 v[18:19], v5 offset:30664
  s_waitcnt lgkmcnt(4)
  v_mfma_f32_16x16x32_bf16 v[104:107], v[20:23], v[24:27], v[104:107]
  v_mfma_f32_16x16x32_bf16 v[108:111], v[20:23], v[28:31], v[108:111]
  v_mfma_f32_16x16x32_bf16 v[112:115], v[20:23], v[32:35], v[112:115]
  v_mfma_f32_16x16x32_bf16 v[116:119], v[20:23], v[36:39], v[116:119]
  ds_read_b64_tr_b16 v[20:21], v5 offset:28912
  ds_read_b64_tr_b16 v[22:23], v5 offset:30704
  s_waitcnt lgkmcnt(4)
  v_mfma_f32_16x16x32_bf16 v[120:123], v[12:15], v[24:27], v[120:123]
  v_mfma_f32_16x16x32_bf16 v[124:127], v[12:15], v[28:31], v[124:127]
  v_mfma_f32_16x16x32_bf16 v[128:131], v[12:15], v[32:35], v[128:131]
  v_mfma_f32_16x16x32_bf16 v[132:135], v[12:15], v[36:39], v[132:135]
  s_waitcnt lgkmcnt(0)
  s_barrier
  ds_read_b64_tr_b16 v[12:13], v6 offset:0
  ds_read_b64_tr_b16 v[14:15], v6 offset:1792
  v_mfma_f32_16x16x32_bf16 v[136:139], v[16:19], v[24:27], v[136:139]
  ds_read_b128 v[40:43], v10 offset:0
  v_mfma_f32_16x16x32_bf16 v[140:143], v[16:19], v[28:31], v[140:143]
  ds_read_b128 v[44:47], v10 offset:512
  v_mfma_f32_16x16x32_bf16 v[144:147], v[16:19], v[32:35], v[144:147]
  ds_read_b128 v[48:51], v10 offset:4096
  v_mfma_f32_16x16x32_bf16 v[148:151], v[16:19], v[36:39], v[148:151]
  ds_read_b128 v[52:55], v10 offset:4608
  ds_read_b64_tr_b16 v[16:17], v6 offset:40
  ds_read_b64_tr_b16 v[18:19], v6 offset:1832
  v_mfma_f32_16x16x32_bf16 v[152:155], v[20:23], v[24:27], v[152:155]
  v_mfma_f32_16x16x32_bf16 v[156:159], v[20:23], v[28:31], v[156:159]
  s_add_u32 s79, s79, 16384
  s_and_b32 s79, s79, 65535
  v_add_u32 v9, s79, v11
  v_xor_b32 v10, 64, v9
  v_mfma_f32_16x16x32_bf16 v[160:163], v[20:23], v[32:35], v[160:163]
  v_mfma_f32_16x16x32_bf16 v[164:167], v[20:23], v[36:39], v[164:167]
  ds_read_b64_tr_b16 v[20:21], v7 offset:0
  ds_read_b64_tr_b16 v[22:23], v7 offset:1792
  s_waitcnt lgkmcnt(7)
  v_mfma_f32_16x16x32_bf16 v[56:59], v[40:43], v[12:15], v[56:59]
  s_waitcnt lgkmcnt(6)
  v_mfma_f32_16x16x32_bf16 v[60:63], v[44:47], v[12:15], v[60:63]
  s_waitcnt lgkmcnt(5)
  v_mfma_f32_16x16x32_bf16 v[64:67], v[48:51], v[12:15], v[64:67]
  s_waitcnt lgkmcnt(4)
  v_mfma_f32_16x16x32_bf16 v[68:71], v[52:55], v[12:15], v[68:71]
  ds_read_b64_tr_b16 v[12:13], v8 offset:0
  ds_read_b64_tr_b16 v[14:15], v8 offset:1792
  s_waitcnt lgkmcnt(4)
  v_mfma_f32_16x16x32_bf16 v[72:75], v[40:43], v[16:19], v[72:75]
  v_mfma_f32_16x16x32_bf16 v[76:79], v[44:47], v[16:19], v[76:79]
  v_mfma_f32_16x16x32_bf16 v[80:83], v[48:51], v[16:19], v[80:83]
  v_mfma_f32_16x16x32_bf16 v[84:87], v[52:55], v[16:19], v[84:87]
  ds_read_b64_tr_b16 v[16:17], v8 offset:40
  ds_read_b64_tr_b16 v[18:19], v8 offset:1832
  s_waitcnt lgkmcnt(4)
  v_mfma_f32_16x16x32_bf16 v[88:91], v[20:23], v[40:43], v[88:91]
  v_mfma_f32_16x16x32_bf16 v[92:95], v[20:23], v[44:47], v[92:95]
  v_mfma_f32_16x16x32_bf16 v[96:99], v[20:23], v[48:51], v[96:99]
  v_mfma_f32_16x16x32_bf16 v[100:103], v[20:23], v[52:55], v[100:103]
  ds_read_b64_tr_b16 v[20:21], v8 offset:72
  ds_read_b64_tr_b16 v[22:23], v8 offset:1864
  s_waitcnt lgkmcnt(4)
  v_mfma_f32_16x16x32_bf16 v[104:107], v[12:15], v[40:43], v[104:107]
  v_mfma_f32_16x16x32_bf16 v[108:111], v[12:15], v[44:47], v[108:111]
  v_mfma_f32_16x16x32_bf16 v[112:115], v[12:15], v[48:51], v[112:115]
  v_mfma_f32_16x16x32_bf16 v[116:119], v[12:15], v[52:55], v[116:119]
  ds_read_b64_tr_b16 v[12:13], v8 offset:112
  ds_read_b64_tr_b16 v[14:15], v8 offset:1904
  s_waitcnt lgkmcnt(4)
  v_mfma_f32_16x16x32_bf16 v[120:123], v[16:19], v[40:43], v[120:123]
  v_mfma_f32_16x16x32_bf16 v[124:127], v[16:19], v[44:47], v[124:127]
  v_mfma_f32_16x16x32_bf16 v[128:131], v[16:19], v[48:51], v[128:131]
  v_mfma_f32_16x16x32_bf16 v[132:135], v[16:19], v[52:55], v[132:135]
  s_waitcnt lgkmcnt(0)
  s_barrier
  ds_read_b64_tr_b16 v[16:17], v6 offset:14400
  ds_read_b64_tr_b16 v[18:19], v6 offset:16192
  v_mfma_f32_16x16x32_bf16 v[136:139], v[20:23], v[40:43], v[136:139]
  ds_read_b128 v[24:27], v9 offset:0
  v_mfma_f32_16x16x32_bf16 v[140:143], v[20:23], v[44:47], v[140:143]
  ds_read_b128 v[28:31], v9 offset:512
  v_mfma_f32_16x16x32_bf16 v[144:147], v[20:23], v[48:51], v[144:147]
  ds_read_b128 v[32:35], v9 offset:4096
  v_mfma_f32_16x16x32_bf16 v[148:151], v[20:23], v[52:55], v[148:151]
  ds_read_b128 v[36:39], v9 offset:4608
  ds_read_b64_tr_b16 v[20:21], v6 offset:14440
  ds_read_b64_tr_b16 v[22:23], v6 offset:16232
  v_mfma_f32_16x16x32_bf16 v[152:155], v[12:15], v[40:43], v[152:155]
  v_mfma_f32_16x16x32_bf16 v[156:159], v[12:15], v[44:47], v[156:159]
  v_mfma_f32_16x16x32_bf16 v[160:163], v[12:15], v[48:51], v[160:163]
  v_mfma_f32_16x16x32_bf16 v[164:167], v[12:15], v[52:55], v[164:167]
  ds_read_b64_tr_b16 v[12:13], v7 offset:14400
  ds_read_b64_tr_b16 v[14:15], v7 offset:16192
  s_waitcnt lgkmcnt(7)
  v_mfma_f32_16x16x32_bf16 v[56:59], v[24:27], v[16:19], v[56:59]
  s_waitcnt lgkmcnt(6)
  v_mfma_f32_16x16x32_bf16 v[60:63], v[28:31], v[16:19], v[60:63]
  s_waitcnt lgkmcnt(5)
  v_mfma_f32_16x16x32_bf16 v[64:67], v[32:35], v[16:19], v[64:67]
  s_waitcnt lgkmcnt(4)
  v_mfma_f32_16x16x32_bf16 v[68:71], v[36:39], v[16:19], v[68:71]
  ds_read_b64_tr_b16 v[16:17], v8 offset:14400
  ds_read_b64_tr_b16 v[18:19], v8 offset:16192
  s_waitcnt lgkmcnt(4)
  v_mfma_f32_16x16x32_bf16 v[72:75], v[24:27], v[20:23], v[72:75]
  v_mfma_f32_16x16x32_bf16 v[76:79], v[28:31], v[20:23], v[76:79]
  v_mfma_f32_16x16x32_bf16 v[80:83], v[32:35], v[20:23], v[80:83]
  v_mfma_f32_16x16x32_bf16 v[84:87], v[36:39], v[20:23], v[84:87]
  ds_read_b64_tr_b16 v[20:21], v8 offset:14440
  ds_read_b64_tr_b16 v[22:23], v8 offset:16232
  s_waitcnt lgkmcnt(4)
  v_mfma_f32_16x16x32_bf16 v[88:91], v[12:15], v[24:27], v[88:91]
  v_mfma_f32_16x16x32_bf16 v[92:95], v[12:15], v[28:31], v[92:95]
  v_mfma_f32_16x16x32_bf16 v[96:99], v[12:15], v[32:35], v[96:99]
  v_mfma_f32_16x16x32_bf16 v[100:103], v[12:15], v[36:39], v[100:103]
  ds_read_b64_tr_b16 v[12:13], v8 offset:14472
  ds_read_b64_tr_b16 v[14:15], v8 offset:16264
  s_waitcnt lgkmcnt(4)
  v_mfma_f32_16x16x32_bf16 v[104:107], v[16:19], v[24:27], v[104:107]
  v_mfma_f32_16x16x32_bf16 v[108:111], v[16:19], v[28:31], v[108:111]
  v_mfma_f32_16x16x32_bf16 v[112:115], v[16:19], v[32:35], v[112:115]
  v_mfma_f32_16x16x32_bf16 v[116:119], v[16:19], v[36:39], v[116:119]
  ds_read_b64_tr_b16 v[16:17], v8 offset:14512
  ds_read_b64_tr_b16 v[18:19], v8 offset:16304
  s_waitcnt lgkmcnt(4)
  v_mfma_f32_16x16x32_bf16 v[120:123], v[20:23], v[24:27], v[120:123]
  v_mfma_f32_16x16x32_bf16 v[124:127], v[20:23], v[28:31], v[124:127]
  v_mfma_f32_16x16x32_bf16 v[128:131], v[20:23], v[32:35], v[128:131]
  v_mfma_f32_16x16x32_bf16 v[132:135], v[20:23], v[36:39], v[132:135]
  s_waitcnt lgkmcnt(0)
  s_barrier
  ds_read_b64_tr_b16 v[20:21], v6 offset:28800
  ds_read_b64_tr_b16 v[22:23], v6 offset:30592
  v_mfma_f32_16x16x32_bf16 v[136:139], v[12:15], v[24:27], v[136:139]
  ds_read_b128 v[40:43], v10 offset:0
  v_mfma_f32_16x16x32_bf16 v[140:143], v[12:15], v[28:31], v[140:143]
  ds_read_b128 v[44:47], v10 offset:512
  v_mfma_f32_16x16x32_bf16 v[144:147], v[12:15], v[32:35], v[144:147]
  ds_read_b128 v[48:51], v10 offset:4096
  v_mfma_f32_16x16x32_bf16 v[148:151], v[12:15], v[36:39], v[148:151]
  ds_read_b128 v[52:55], v10 offset:4608
  ds_read_b64_tr_b16 v[12:13], v6 offset:28840
  ds_read_b64_tr_b16 v[14:15], v6 offset:30632
  v_mfma_f32_16x16x32_bf16 v[152:155], v[16:19], v[24:27], v[152:155]
  v_mfma_f32_16x16x32_bf16 v[156:159], v[16:19], v[28:31], v[156:159]
  s_add_u32 s79, s79, 16384
  s_and_b32 s79, s79, 65535
  v_add_u32 v9, s79, v11
  v_xor_b32 v10, 64, v9
  v_mfma_f32_16x16x32_bf16 v[160:163], v[16:19], v[32:35], v[160:163]
  v_mfma_f32_16x16x32_bf16 v[164:167], v[16:19], v[36:39], v[164:167]
  ds_read_b64_tr_b16 v[16:17], v7 offset:28800
  ds_read_b64_tr_b16 v[18:19], v7 offset:30592
  s_waitcnt lgkmcnt(7)
  v_mfma_f32_16x16x32_bf16 v[56:59], v[40:43], v[20:23], v[56:59]
  s_waitcnt lgkmcnt(6)
  v_mfma_f32_16x16x32_bf16 v[60:63], v[44:47], v[20:23], v[60:63]
  s_waitcnt lgkmcnt(5)
  v_mfma_f32_16x16x32_bf16 v[64:67], v[48:51], v[20:23], v[64:67]
  s_waitcnt lgkmcnt(4)
  v_mfma_f32_16x16x32_bf16 v[68:71], v[52:55], v[20:23], v[68:71]
  ds_read_b64_tr_b16 v[20:21], v8 offset:28800
  ds_read_b64_tr_b16 v[22:23], v8 offset:30592
  s_waitcnt lgkmcnt(4)
  v_mfma_f32_16x16x32_bf16 v[72:75], v[40:43], v[12:15], v[72:75]
  v_mfma_f32_16x16x32_bf16 v[76:79], v[44:47], v[12:15], v[76:79]
  v_mfma_f32_16x16x32_bf16 v[80:83], v[48:51], v[12:15], v[80:83]
  v_mfma_f32_16x16x32_bf16 v[84:87], v[52:55], v[12:15], v[84:87]
  ds_read_b64_tr_b16 v[12:13], v8 offset:28840
  ds_read_b64_tr_b16 v[14:15], v8 offset:30632
  s_waitcnt lgkmcnt(4)
  v_mfma_f32_16x16x32_bf16 v[88:91], v[16:19], v[40:43], v[88:91]
  v_mfma_f32_16x16x32_bf16 v[92:95], v[16:19], v[44:47], v[92:95]
  v_mfma_f32_16x16x32_bf16 v[96:99], v[16:19], v[48:51], v[96:99]
  v_mfma_f32_16x16x32_bf16 v[100:103], v[16:19], v[52:55], v[100:103]
  ds_read_b64_tr_b16 v[16:17], v8 offset:28872
  ds_read_b64_tr_b16 v[18:19], v8 offset:30664
  s_waitcnt lgkmcnt(4)
  v_mfma_f32_16x16x32_bf16 v[104:107], v[20:23], v[40:43], v[104:107]
  v_mfma_f32_16x16x32_bf16 v[108:111], v[20:23], v[44:47], v[108:111]
  v_mfma_f32_16x16x32_bf16 v[112:115], v[20:23], v[48:51], v[112:115]
  v_mfma_f32_16x16x32_bf16 v[116:119], v[20:23], v[52:55], v[116:119]
  ds_read_b64_tr_b16 v[20:21], v8 offset:28912
  ds_read_b64_tr_b16 v[22:23], v8 offset:30704
  s_waitcnt lgkmcnt(4)
  v_mfma_f32_16x16x32_bf16 v[120:123], v[12:15], v[40:43], v[120:123]
  v_mfma_f32_16x16x32_bf16 v[124:127], v[12:15], v[44:47], v[124:127]
  v_mfma_f32_16x16x32_bf16 v[128:131], v[12:15], v[48:51], v[128:131]
  v_mfma_f32_16x16x32_bf16 v[132:135], v[12:15], v[52:55], v[132:135]
  s_waitcnt lgkmcnt(0)
  s_barrier
  ds_read_b64_tr_b16 v[12:13], v3 offset:0
  ds_read_b64_tr_b16 v[14:15], v3 offset:1792
  v_mfma_f32_16x16x32_bf16 v[136:139], v[16:19], v[40:43], v[136:139]
  ds_read_b128 v[24:27], v9 offset:0
  v_mfma_f32_16x16x32_bf16 v[140:143], v[16:19], v[44:47], v[140:143]
  ds_read_b128 v[28:31], v9 offset:512
  v_mfma_f32_16x16x32_bf16 v[144:147], v[16:19], v[48:51], v[144:147]
  ds_read_b128 v[32:35], v9 offset:4096
  v_mfma_f32_16x16x32_bf16 v[148:151], v[16:19], v[52:55], v[148:151]
  ds_read_b128 v[36:39], v9 offset:4608
  ds_read_b64_tr_b16 v[16:17], v3 offset:40
  ds_read_b64_tr_b16 v[18:19], v3 offset:1832
  v_mfma_f32_16x16x32_bf16 v[152:155], v[20:23], v[40:43], v[152:155]
  v_mfma_f32_16x16x32_bf16 v[156:159], v[20:23], v[44:47], v[156:159]
  v_mfma_f32_16x16x32_bf16 v[160:163], v[20:23], v[48:51], v[160:163]
  v_mfma_f32_16x16x32_bf16 v[164:167], v[20:23], v[52:55], v[164:167]
  ds_read_b64_tr_b16 v[20:21], v4 offset:0
  ds_read_b64_tr_b16 v[22:23], v4 offset:1792
  s_sub_u32 s73, s73, 1
  s_cmp_lg_u32 s73, 0
  s_cbranch_scc1 K1_NT_LOOP
  s_waitcnt lgkmcnt(0)
  v_and_b32 v19, 15, v2
  v_lshrrev_b32 v20, 2, v19
  v_and_b32 v19, 3, v19
  v_lshl_add_u32 v12, v20, 3, v19
  v_lshrrev_b32 v13, 4, v2
  v_mov_b32 v22, 3049366176
  v_mov_b32 v23, 3049366176
  v_and_b32 v19, 1, v13
  v_lshl_add_u32 v19, v19, 2, v12
  v_lshlrev_b32 v19, 4, v19
  v_lshrrev_b32 v20, 1, v13
  v_lshl_add_u32 v14, v20, 9, v19
  s_lshl_b32 s58, s77, 5
  v_add_u32 v14, s58, v14
  v_add_u32 v19, s77, v12
  v_lshlrev_b32 v19, 3, v19
  v_lshl_add_u32 v15, v13, 14, v19
  v_mov_b32 v20, 0x7FF00000
  v_cmp_gt_u32 vcc, s50, v13
  s_nop 1
  v_cndmask_b32 v15, v20, v15, vcc
  s_lshr_b32 s58, s77, 3
  v_add_u32 v19, s58, v13
  v_mul_u32_u24 v19, 18, v19
  v_and_b32 v20, 15, v2
  v_add_u32 v16, v19, v20
  v_lshlrev_b32 v16, 4, v16
  s_cmp_eq_u32 s66, 0
  s_cbranch_scc1 K1_NT_a_nophi
  v_pk_fma_f32 v[24:25], v[56:57], s[74:75], v[22:23]
  v_pk_fma_f32 v[26:27], v[58:59], s[74:75], v[22:23]
  v_pk_fma_f32 v[28:29], v[60:61], s[74:75], v[22:23]
  v_pk_fma_f32 v[30:31], v[62:63], s[74:75], v[22:23]
  v_pk_fma_f32 v[32:33], v[64:65], s[74:75], v[22:23]
  v_pk_fma_f32 v[34:35], v[66:67], s[74:75], v[22:23]
  v_pk_fma_f32 v[36:37], v[68:69], s[74:75], v[22:23]
  v_pk_fma_f32 v[38:39], v[70:71], s[74:75], v[22:23]
  v_exp_f32_e64 v24, v24 clamp
  v_max_f32 v56, s76, v56
  v_exp_f32_e64 v25, v25 clamp
  v_max_f32 v57, s76, v57
  v_exp_f32_e64 v26, v26 clamp
  v_max_f32 v58, s76, v58
  v_exp_f32_e64 v27, v27 clamp
  v_max_f32 v59, s76, v59
  v_exp_f32_e64 v28, v28 clamp
  v_max_f32 v60, s76, v60
  v_exp_f32_e64 v29, v29 clamp
  v_max_f32 v61, s76, v61
  v_exp_f32_e64 v30, v30 clamp
  v_max_f32 v62, s76, v62
  v_exp_f32_e64 v31, v31 clamp
  v_max_f32 v63, s76, v63
  v_exp_f32_e64 v32, v32 clamp
  v_max_f32 v64, s76, v64
  v_exp_f32_e64 v33, v33 clamp
  v_max_f32 v65, s76, v65
  v_exp_f32_e64 v34, v34 clamp
  v_max_f32 v66, s76, v66
  v_exp_f32_e64 v35, v35 clamp
  v_max_f32 v67, s76, v67
  v_exp_f32_e64 v36, v36 clamp
  v_max_f32 v68, s76, v68
  v_exp_f32_e64 v37, v37 clamp
  v_max_f32 v69, s76, v69
  v_exp_f32_e64 v38, v38 clamp
  v_max_f32 v70, s76, v70
  v_exp_f32_e64 v39, v39 clamp
  v_max_f32 v71, s76, v71
  v_pk_add_f32 v[56:57], v[56:57], v[24:25]
  v_pk_add_f32 v[58:59], v[58:59], v[26:27]
  v_pk_add_f32 v[60:61], v[60:61], v[28:29]
  v_pk_add_f32 v[62:63], v[62:63], v[30:31]
  v_pk_add_f32 v[64:65], v[64:65], v[32:33]
  v_pk_add_f32 v[66:67], v[66:67], v[34:35]
  v_pk_add_f32 v[68:69], v[68:69], v[36:37]
  v_pk_add_f32 v[70:71], v[70:71], v[38:39]
  v_cvt_pk_bf16_f32 v40, v56, v57
  v_cvt_pk_bf16_f32 v41, v58, v59
  v_cvt_pk_bf16_f32 v42, v60, v61
  v_cvt_pk_bf16_f32 v43, v62, v63
  s_add_u32 s58, s80, 0
  buffer_store_dwordx4 v[40:43], v16, s[24:27], s58 offen sc1
  v_cvt_pk_bf16_f32 v44, v64, v65
  v_cvt_pk_bf16_f32 v45, v66, v67
  v_cvt_pk_bf16_f32 v46, v68, v69
  v_cvt_pk_bf16_f32 v47, v70, v71
  s_add_u32 s58, s80, 1152
  buffer_store_dwordx4 v[44:47], v16, s[24:27], s58 offen sc1
  v_pk_fma_f32 v[24:25], v[72:73], s[74:75], v[22:23]
  v_pk_fma_f32 v[26:27], v[74:75], s[74:75], v[22:23]
  v_pk_fma_f32 v[28:29], v[76:77], s[74:75], v[22:23]
  v_pk_fma_f32 v[30:31], v[78:79], s[74:75], v[22:23]
  v_pk_fma_f32 v[32:33], v[80:81], s[74:75], v[22:23]
  v_pk_fma_f32 v[34:35], v[82:83], s[74:75], v[22:23]
  v_pk_fma_f32 v[36:37], v[84:85], s[74:75], v[22:23]
  v_pk_fma_f32 v[38:39], v[86:87], s[74:75], v[22:23]
  v_exp_f32_e64 v24, v24 clamp
  v_max_f32 v72, s76, v72
  v_exp_f32_e64 v25, v25 clamp
  v_max_f32 v73, s76, v73
  v_exp_f32_e64 v26, v26 clamp
  v_max_f32 v74, s76, v74
  v_exp_f32_e64 v27, v27 clamp
  v_max_f32 v75, s76, v75
  v_exp_f32_e64 v28, v28 clamp
  v_max_f32 v76, s76, v76
  v_exp_f32_e64 v29, v29 clamp
  v_max_f32 v77, s76, v77
  v_exp_f32_e64 v30, v30 clamp
  v_max_f32 v78, s76, v78
  v_exp_f32_e64 v31, v31 clamp
  v_max_f32 v79, s76, v79
  v_exp_f32_e64 v32, v32 clamp
  v_max_f32 v80, s76, v80
  v_exp_f32_e64 v33, v33 clamp
  v_max_f32 v81, s76, v81
  v_exp_f32_e64 v34, v34 clamp
  v_max_f32 v82, s76, v82
  v_exp_f32_e64 v35, v35 clamp
  v_max_f32 v83, s76, v83
  v_exp_f32_e64 v36, v36 clamp
  v_max_f32 v84, s76, v84
  v_exp_f32_e64 v37, v37 clamp
  v_max_f32 v85, s76, v85
  v_exp_f32_e64 v38, v38 clamp
  v_max_f32 v86, s76, v86
  v_exp_f32_e64 v39, v39 clamp
  v_max_f32 v87, s76, v87
  v_pk_add_f32 v[72:73], v[72:73], v[24:25]
  v_pk_add_f32 v[74:75], v[74:75], v[26:27]
  v_pk_add_f32 v[76:77], v[76:77], v[28:29]
  v_pk_add_f32 v[78:79], v[78:79], v[30:31]
  v_pk_add_f32 v[80:81], v[80:81], v[32:33]
  v_pk_add_f32 v[82:83], v[82:83], v[34:35]
  v_pk_add_f32 v[84:85], v[84:85], v[36:37]
  v_pk_add_f32 v[86:87], v[86:87], v[38:39]
  v_cvt_pk_bf16_f32 v48, v72, v73
  v_cvt_pk_bf16_f32 v49, v74, v75
  v_cvt_pk_bf16_f32 v50, v76, v77
  v_cvt_pk_bf16_f32 v51, v78, v79
  s_add_u32 s58, s80, 73728
  buffer_store_dwordx4 v[48:51], v16, s[24:27], s58 offen sc1
  v_cvt_pk_bf16_f32 v52, v80, v81
  v_cvt_pk_bf16_f32 v53, v82, v83
  v_cvt_pk_bf16_f32 v54, v84, v85
  v_cvt_pk_bf16_f32 v55, v86, v87
  s_add_u32 s58, s80, 74880
  buffer_store_dwordx4 v[52:55], v16, s[24:27], s58 offen sc1
  s_branch K1_NT_a_done
K1_NT_a_nophi:
  v_cvt_pk_bf16_f32 v40, v56, v57
  v_cvt_pk_bf16_f32 v41, v58, v59
  v_cvt_pk_bf16_f32 v42, v60, v61
  v_cvt_pk_bf16_f32 v43, v62, v63
  s_add_u32 s58, s80, 0
  buffer_store_dwordx4 v[40:43], v16, s[24:27], s58 offen sc1
  v_cvt_pk_bf16_f32 v44, v64, v65
  v_cvt_pk_bf16_f32 v45, v66, v67
  v_cvt_pk_bf16_f32 v46, v68, v69
  v_cvt_pk_bf16_f32 v47, v70, v71
  s_add_u32 s58, s80, 1152
  buffer_store_dwordx4 v[44:47], v16, s[24:27], s58 offen sc1
  v_cvt_pk_bf16_f32 v48, v72, v73
  v_cvt_pk_bf16_f32 v49, v74, v75
  v_cvt_pk_bf16_f32 v50, v76, v77
  v_cvt_pk_bf16_f32 v51, v78, v79
  s_add_u32 s58, s80, 73728
  buffer_store_dwordx4 v[48:51], v16, s[24:27], s58 offen sc1
  v_cvt_pk_bf16_f32 v52, v80, v81
  v_cvt_pk_bf16_f32 v53, v82, v83
  v_cvt_pk_bf16_f32 v54, v84, v85
  v_cvt_pk_bf16_f32 v55, v86, v87
  s_add_u32 s58, s80, 74880
  buffer_store_dwordx4 v[52:55], v16, s[24:27], s58 offen sc1
K1_NT_a_done:
  s_nop 1
  s_cmp_eq_u32 s67, 0
  s_cbranch_scc1 K1_NT_b_nophi
  v_pk_fma_f32 v[24:25], v[88:89], s[74:75], v[22:23]
  v_pk_fma_f32 v[26:27], v[90:91], s[74:75], v[22:23]
  v_pk_fma_f32 v[28:29], v[92:93], s[74:75], v[22:23]
  v_pk_fma_f32 v[30:31], v[94:95], s[74:75], v[22:23]
  v_pk_fma_f32 v[32:33], v[96:97], s[74:75], v[22:23]
  v_pk_fma_f32 v[34:35], v[98:99], s[74:75], v[22:23]
  v_pk_fma_f32 v[36:37], v[100:101], s[74:75], v[22:23]
  v_pk_fma_f32 v[38:39], v[102:103], s[74:75], v[22:23]
  v_exp_f32_e64 v24, v24 clamp
  v_max_f32 v88, s76, v88
  v_exp_f32_e64 v25, v25 clamp
  v_max_f32 v89, s76, v89
  v_exp_f32_e64 v26, v26 clamp
  v_max_f32 v90, s76, v90
  v_exp_f32_e64 v27, v27 clamp
  v_max_f32 v91, s76, v91
  v_exp_f32_e64 v28, v28 clamp
  v_max_f32 v92, s76, v92
  v_exp_f32_e64 v29, v29 clamp
  v_max_f32 v93, s76, v93
  v_exp_f32_e64 v30, v30 clamp
  v_max_f32 v94, s76, v94
  v_exp_f32_e64 v31, v31 clamp
  v_max_f32 v95, s76, v95
  v_exp_f32_e64 v32, v32 clamp
  v_max_f32 v96, s76, v96
  v_exp_f32_e64 v33, v33 clamp
  v_max_f32 v97, s76, v97
  v_exp_f32_e64 v34, v34 clamp
  v_max_f32 v98, s76, v98
  v_exp_f32_e64 v35, v35 clamp
  v_max_f32 v99, s76, v99
  v_exp_f32_e64 v36, v36 clamp
  v_max_f32 v100, s76, v100
  v_exp_f32_e64 v37, v37 clamp
  v_max_f32 v101, s76, v101
  v_exp_f32_e64 v38, v38 clamp
  v_max_f32 v102, s76, v102
  v_exp_f32_e64 v39, v39 clamp
  v_max_f32 v103, s76, v103
  v_pk_add_f32 v[88:89], v[88:89], v[24:25]
  v_pk_add_f32 v[90:91], v[90:91], v[26:27]
  v_pk_add_f32 v[92:93], v[92:93], v[28:29]
  v_pk_add_f32 v[94:95], v[94:95], v[30:31]
  v_pk_add_f32 v[96:97], v[96:97], v[32:33]
  v_pk_add_f32 v[98:99], v[98:99], v[34:35]
  v_pk_add_f32 v[100:101], v[100:101], v[36:37]
  v_pk_add_f32 v[102:103], v[102:103], v[38:39]
  v_cvt_pk_bf16_f32 v40, v88, v89
  v_cvt_pk_bf16_f32 v41, v90, v91
  v_cvt_pk_bf16_f32 v42, v92, v93
  v_cvt_pk_bf16_f32 v43, v94, v95
  buffer_store_dwordx2 v[40:41], v15, s[24:27], s82 offen offset:0 sc1
  buffer_store_dwordx2 v[42:43], v15, s[24:27], s82 offen offset:32 sc1
  v_cvt_pk_bf16_f32 v44, v96, v97
  v_cvt_pk_bf16_f32 v45, v98, v99
  v_cvt_pk_bf16_f32 v46, v100, v101
  v_cvt_pk_bf16_f32 v47, v102, v103
  buffer_store_dwordx2 v[44:45], v15, s[24:27], s82 offen offset:256 sc1
  buffer_store_dwordx2 v[46:47], v15, s[24:27], s82 offen offset:288 sc1
  v_pk_fma_f32 v[24:25], v[104:105], s[74:75], v[22:23]
  v_pk_fma_f32 v[26:27], v[106:107], s[74:75], v[22:23]
  v_pk_fma_f32 v[28:29], v[108:109], s[74:75], v[22:23]
  v_pk_fma_f32 v[30:31], v[110:111], s[74:75], v[22:23]
  v_pk_fma_f32 v[32:33], v[112:113], s[74:75], v[22:23]
  v_pk_fma_f32 v[34:35], v[114:115], s[74:75], v[22:23]
  v_pk_fma_f32 v[36:37], v[116:117], s[74:75], v[22:23]
  v_pk_fma_f32 v[38:39], v[118:119], s[74:75], v[22:23]
  v_exp_f32_e64 v24, v24 clamp
  v_max_f32 v104, s76, v104
  v_exp_f32_e64 v25, v25 clamp
  v_max_f32 v105, s76, v105
  v_exp_f32_e64 v26, v26 clamp
  v_max_f32 v106, s76, v106
  v_exp_f32_e64 v27, v27 clamp
  v_max_f32 v107, s76, v107
  v_exp_f32_e64 v28, v28 clamp
  v_max_f32 v108, s76, v108
  v_exp_f32_e64 v29, v29 clamp
  v_max_f32 v109, s76, v109
  v_exp_f32_e64 v30, v30 clamp
  v_max_f32 v110, s76, v110
  v_exp_f32_e64 v31, v31 clamp
  v_max_f32 v111, s76, v111
  v_exp_f32_e64 v32, v32 clamp
  v_max_f32 v112, s76, v112
  v_exp_f32_e64 v33, v33 clamp
  v_max_f32 v113, s76, v113
  v_exp_f32_e64 v34, v34 clamp
  v_max_f32 v114, s76, v114
  v_exp_f32_e64 v35, v35 clamp
  v_max_f32 v115, s76, v115
  v_exp_f32_e64 v36, v36 clamp
  v_max_f32 v116, s76, v116
  v_exp_f32_e64 v37, v37 clamp
  v_max_f32 v117, s76, v117
  v_exp_f32_e64 v38, v38 clamp
  v_max_f32 v118, s76, v118
  v_exp_f32_e64 v39, v39 clamp
  v_max_f32 v119, s76, v119
  v_pk_add_f32 v[104:105], v[104:105], v[24:25]
  v_pk_add_f32 v[106:107], v[106:107], v[26:27]
  v_pk_add_f32 v[108:109], v[108:109], v[28:29]
  v_pk_add_f32 v[110:111], v[110:111], v[30:31]
  v_pk_add_f32 v[112:113], v[112:113], v[32:33]
  v_pk_add_f32 v[114:115], v[114:115], v[34:35]
  v_pk_add_f32 v[116:117], v[116:117], v[36:37]
  v_pk_add_f32 v[118:119], v[118:119], v[38:39]
  v_cvt_pk_bf16_f32 v48, v104, v105
  v_cvt_pk_bf16_f32 v49, v106, v107
  v_cvt_pk_bf16_f32 v50, v108, v109
  v_cvt_pk_bf16_f32 v51, v110, v111
  s_add_u32 s58, s81, 0
  v_permlane16_swap_b32 v48, v50
  v_permlane16_swap_b32 v49, v51
  buffer_store_dwordx4 v[48:51], v14, s[24:27], s58 offen sc1
  v_cvt_pk_bf16_f32 v52, v112, v113
  v_cvt_pk_bf16_f32 v53, v114, v115
  v_cvt_pk_bf16_f32 v54, v116, v117
  v_cvt_pk_bf16_f32 v55, v118, v119
  s_add_u32 s58, s81, 1024
  v_permlane16_swap_b32 v52, v54
  v_permlane16_swap_b32 v53, v55
  buffer_store_dwordx4 v[52:55], v14, s[24:27], s58 offen sc1
  v_pk_fma_f32 v[24:25], v[120:121], s[74:75], v[22:23]
  v_pk_fma_f32 v[26:27], v[122:123], s[74:75], v[22:23]
  v_pk_fma_f32 v[28:29], v[124:125], s[74:75], v[22:23]
  v_pk_fma_f32 v[30:31], v[126:127], s[74:75], v[22:23]
  v_pk_fma_f32 v[32:33], v[128:129], s[74:75], v[22:23]
  v_pk_fma_f32 v[34:35], v[130:131], s[74:75], v[22:23]
  v_pk_fma_f32 v[36:37], v[132:133], s[74:75], v[22:23]
  v_pk_fma_f32 v[38:39], v[134:135], s[74:75], v[22:23]
  v_exp_f32_e64 v24, v24 clamp
  v_max_f32 v120, s76, v120
  v_exp_f32_e64 v25, v25 clamp
  v_max_f32 v121, s76, v121
  v_exp_f32_e64 v26, v26 clamp
  v_max_f32 v122, s76, v122
  v_exp_f32_e64 v27, v27 clamp
  v_max_f32 v123, s76, v123
  v_exp_f32_e64 v28, v28 clamp
  v_max_f32 v124, s76, v124
  v_exp_f32_e64 v29, v29 clamp
  v_max_f32 v125, s76, v125
  v_exp_f32_e64 v30, v30 clamp
  v_max_f32 v126, s76, v126
  v_exp_f32_e64 v31, v31 clamp
  v_max_f32 v127, s76, v127
  v_exp_f32_e64 v32, v32 clamp
  v_max_f32 v128, s76, v128
  v_exp_f32_e64 v33, v33 clamp
  v_max_f32 v129, s76, v129
  v_exp_f32_e64 v34, v34 clamp
  v_max_f32 v130, s76, v130
  v_exp_f32_e64 v35, v35 clamp
  v_max_f32 v131, s76, v131
  v_exp_f32_e64 v36, v36 clamp
  v_max_f32 v132, s76, v132
  v_exp_f32_e64 v37, v37 clamp
  v_max_f32 v133, s76, v133
  v_exp_f32_e64 v38, v38 clamp
  v_max_f32 v134, s76, v134
  v_exp_f32_e64 v39, v39 clamp
  v_max_f32 v135, s76, v135
  v_pk_add_f32 v[120:121], v[120:121], v[24:25]
  v_pk_add_f32 v[122:123], v[122:123], v[26:27]
  v_pk_add_f32 v[124:125], v[124:125], v[28:29]
  v_pk_add_f32 v[126:127], v[126:127], v[30:31]
  v_pk_add_f32 v[128:129], v[128:129], v[32:33]
  v_pk_add_f32 v[130:131], v[130:131], v[34:35]
  v_pk_add_f32 v[132:133], v[132:133], v[36:37]
  v_pk_add_f32 v[134:135], v[134:135], v[38:39]
  v_cvt_pk_bf16_f32 v40, v120, v121
  v_cvt_pk_bf16_f32 v41, v122, v123
  v_cvt_pk_bf16_f32 v42, v124, v125
  v_cvt_pk_bf16_f32 v43, v126, v127
  s_add_u32 s58, s81, 65536
  v_permlane16_swap_b32 v40, v42
  v_permlane16_swap_b32 v41, v43
  buffer_store_dwordx4 v[40:43], v14, s[24:27], s58 offen sc1
  v_cvt_pk_bf16_f32 v44, v128, v129
  v_cvt_pk_bf16_f32 v45, v130, v131
  v_cvt_pk_bf16_f32 v46, v132, v133
  v_cvt_pk_bf16_f32 v47, v134, v135
  s_add_u32 s58, s81, 66560
  v_permlane16_swap_b32 v44, v46
  v_permlane16_swap_b32 v45, v47
  buffer_store_dwordx4 v[44:47], v14, s[24:27], s58 offen sc1
  v_pk_fma_f32 v[24:25], v[136:137], s[74:75], v[22:23]
  v_pk_fma_f32 v[26:27], v[138:139], s[74:75], v[22:23]
  v_pk_fma_f32 v[28:29], v[140:141], s[74:75], v[22:23]
  v_pk_fma_f32 v[30:31], v[142:143], s[74:75], v[22:23]
  v_pk_fma_f32 v[32:33], v[144:145], s[74:75], v[22:23]
  v_pk_fma_f32 v[34:35], v[146:147], s[74:75], v[22:23]
  v_pk_fma_f32 v[36:37], v[148:149], s[74:75], v[22:23]
  v_pk_fma_f32 v[38:39], v[150:151], s[74:75], v[22:23]
  v_exp_f32_e64 v24, v24 clamp
  v_max_f32 v136, s76, v136
  v_exp_f32_e64 v25, v25 clamp
  v_max_f32 v137, s76, v137
  v_exp_f32_e64 v26, v26 clamp
  v_max_f32 v138, s76, v138
  v_exp_f32_e64 v27, v27 clamp
  v_max_f32 v139, s76, v139
  v_exp_f32_e64 v28, v28 clamp
  v_max_f32 v140, s76, v140
  v_exp_f32_e64 v29, v29 clamp
  v_max_f32 v141, s76, v141
  v_exp_f32_e64 v30, v30 clamp
  v_max_f32 v142, s76, v142
  v_exp_f32_e64 v31, v31 clamp
  v_max_f32 v143, s76, v143
  v_exp_f32_e64 v32, v32 clamp
  v_max_f32 v144, s76, v144
  v_exp_f32_e64 v33, v33 clamp
  v_max_f32 v145, s76, v145
  v_exp_f32_e64 v34, v34 clamp
  v_max_f32 v146, s76, v146
  v_exp_f32_e64 v35, v35 clamp
  v_max_f32 v147, s76, v147
  v_exp_f32_e64 v36, v36 clamp
  v_max_f32 v148, s76, v148
  v_exp_f32_e64 v37, v37 clamp
  v_max_f32 v149, s76, v149
  v_exp_f32_e64 v38, v38 clamp
  v_max_f32 v150, s76, v150
  v_exp_f32_e64 v39, v39 clamp
  v_max_f32 v151, s76, v151
  v_pk_add_f32 v[136:137], v[136:137], v[24:25]
  v_pk_add_f32 v[138:139], v[138:139], v[26:27]
  v_pk_add_f32 v[140:141], v[140:141], v[28:29]
  v_pk_add_f32 v[142:143], v[142:143], v[30:31]
  v_pk_add_f32 v[144:145], v[144:145], v[32:33]
  v_pk_add_f32 v[146:147], v[146:147], v[34:35]
  v_pk_add_f32 v[148:149], v[148:149], v[36:37]
  v_pk_add_f32 v[150:151], v[150:151], v[38:39]
  v_cvt_pk_bf16_f32 v48, v136, v137
  v_cvt_pk_bf16_f32 v49, v138, v139
  v_cvt_pk_bf16_f32 v50, v140, v141
  v_cvt_pk_bf16_f32 v51, v142, v143
  s_add_u32 s58, s81, 131072
  v_permlane16_swap_b32 v48, v50
  v_permlane16_swap_b32 v49, v51
  buffer_store_dwordx4 v[48:51], v14, s[24:27], s58 offen sc1
  v_cvt_pk_bf16_f32 v52, v144, v145
  v_cvt_pk_bf16_f32 v53, v146, v147
  v_cvt_pk_bf16_f32 v54, v148, v149
  v_cvt_pk_bf16_f32 v55, v150, v151
  s_add_u32 s58, s81, 132096
  v_permlane16_swap_b32 v52, v54
  v_permlane16_swap_b32 v53, v55
  buffer_store_dwordx4 v[52:55], v14, s[24:27], s58 offen sc1
  v_pk_fma_f32 v[24:25], v[152:153], s[74:75], v[22:23]
  v_pk_fma_f32 v[26:27], v[154:155], s[74:75], v[22:23]
  v_pk_fma_f32 v[28:29], v[156:157], s[74:75], v[22:23]
  v_pk_fma_f32 v[30:31], v[158:159], s[74:75], v[22:23]
  v_pk_fma_f32 v[32:33], v[160:161], s[74:75], v[22:23]
  v_pk_fma_f32 v[34:35], v[162:163], s[74:75], v[22:23]
  v_pk_fma_f32 v[36:37], v[164:165], s[74:75], v[22:23]
  v_pk_fma_f32 v[38:39], v[166:167], s[74:75], v[22:23]
  v_exp_f32_e64 v24, v24 clamp
  v_max_f32 v152, s76, v152
  v_exp_f32_e64 v25, v25 clamp
  v_max_f32 v153, s76, v153
  v_exp_f32_e64 v26, v26 clamp
  v_max_f32 v154, s76, v154
  v_exp_f32_e64 v27, v27 clamp
  v_max_f32 v155, s76, v155
  v_exp_f32_e64 v28, v28 clamp
  v_max_f32 v156, s76, v156
  v_exp_f32_e64 v29, v29 clamp
  v_max_f32 v157, s76, v157
  v_exp_f32_e64 v30, v30 clamp
  v_max_f32 v158, s76, v158
  v_exp_f32_e64 v31, v31 clamp
  v_max_f32 v159, s76, v159
  v_exp_f32_e64 v32, v32 clamp
  v_max_f32 v160, s76, v160
  v_exp_f32_e64 v33, v33 clamp
  v_max_f32 v161, s76, v161
  v_exp_f32_e64 v34, v34 clamp
  v_max_f32 v162, s76, v162
  v_exp_f32_e64 v35, v35 clamp
  v_max_f32 v163, s76, v163
  v_exp_f32_e64 v36, v36 clamp
  v_max_f32 v164, s76, v164
  v_exp_f32_e64 v37, v37 clamp
  v_max_f32 v165, s76, v165
  v_exp_f32_e64 v38, v38 clamp
  v_max_f32 v166, s76, v166
  v_exp_f32_e64 v39, v39 clamp
  v_max_f32 v167, s76, v167
  v_pk_add_f32 v[152:153], v[152:153], v[24:25]
  v_pk_add_f32 v[154:155], v[154:155], v[26:27]
  v_pk_add_f32 v[156:157], v[156:157], v[28:29]
  v_pk_add_f32 v[158:159], v[158:159], v[30:31]
  v_pk_add_f32 v[160:161], v[160:161], v[32:33]
  v_pk_add_f32 v[162:163], v[162:163], v[34:35]
  v_pk_add_f32 v[164:165], v[164:165], v[36:37]
  v_pk_add_f32 v[166:167], v[166:167], v[38:39]
  v_cvt_pk_bf16_f32 v40, v152, v153
  v_cvt_pk_bf16_f32 v41, v154, v155
  v_cvt_pk_bf16_f32 v42, v156, v157
  v_cvt_pk_bf16_f32 v43, v158, v159
  s_add_u32 s58, s81, 196608
  v_permlane16_swap_b32 v40, v42
  v_permlane16_swap_b32 v41, v43
  buffer_store_dwordx4 v[40:43], v14, s[24:27], s58 offen sc1
  v_cvt_pk_bf16_f32 v44, v160, v161
  v_cvt_pk_bf16_f32 v45, v162, v163
  v_cvt_pk_bf16_f32 v46, v164, v165
  v_cvt_pk_bf16_f32 v47, v166, v167
  s_add_u32 s58, s81, 197632
  v_permlane16_swap_b32 v44, v46
  v_permlane16_swap_b32 v45, v47
  buffer_store_dwordx4 v[44:47], v14, s[24:27], s58 offen sc1
  s_branch K1_NT_b_done
K1_NT_b_nophi:
  v_pk_mul_f32 v[88:89], v[88:89], s[14:15]
  v_pk_mul_f32 v[90:91], v[90:91], s[14:15]
  v_pk_mul_f32 v[92:93], v[92:93], s[14:15]
  v_pk_mul_f32 v[94:95], v[94:95], s[14:15]
  v_pk_mul_f32 v[96:97], v[96:97], s[14:15]
  v_pk_mul_f32 v[98:99], v[98:99], s[14:15]
  v_pk_mul_f32 v[100:101], v[100:101], s[14:15]
  v_pk_mul_f32 v[102:103], v[102:103], s[14:15]
  v_cvt_pk_bf16_f32 v40, v88, v89
  v_cvt_pk_bf16_f32 v41, v90, v91
  v_cvt_pk_bf16_f32 v42, v92, v93
  v_cvt_pk_bf16_f32 v43, v94, v95
  buffer_store_dwordx2 v[40:41], v15, s[24:27], s82 offen offset:0 sc1
  buffer_store_dwordx2 v[42:43], v15, s[24:27], s82 offen offset:32 sc1
  v_cvt_pk_bf16_f32 v44, v96, v97
  v_cvt_pk_bf16_f32 v45, v98, v99
  v_cvt_pk_bf16_f32 v46, v100, v101
  v_cvt_pk_bf16_f32 v47, v102, v103
  buffer_store_dwordx2 v[44:45], v15, s[24:27], s82 offen offset:256 sc1
  buffer_store_dwordx2 v[46:47], v15, s[24:27], s82 offen offset:288 sc1
  v_pk_mul_f32 v[104:105], v[104:105], s[14:15]
  v_pk_mul_f32 v[106:107], v[106:107], s[14:15]
  v_pk_mul_f32 v[108:109], v[108:109], s[14:15]
  v_pk_mul_f32 v[110:111], v[110:111], s[14:15]
  v_pk_mul_f32 v[112:113], v[112:113], s[14:15]
  v_pk_mul_f32 v[114:115], v[114:115], s[14:15]
  v_pk_mul_f32 v[116:117], v[116:117], s[14:15]
  v_pk_mul_f32 v[118:119], v[118:119], s[14:15]
  v_cvt_pk_bf16_f32 v48, v104, v105
  v_cvt_pk_bf16_f32 v49, v106, v107
  v_cvt_pk_bf16_f32 v50, v108, v109
  v_cvt_pk_bf16_f32 v51, v110, v111
  s_add_u32 s58, s81, 0
  v_permlane16_swap_b32 v48, v50
  v_permlane16_swap_b32 v49, v51
  buffer_store_dwordx4 v[48:51], v14, s[24:27], s58 offen sc1
  v_cvt_pk_bf16_f32 v52, v112, v113
  v_cvt_pk_bf16_f32 v53, v114, v115
  v_cvt_pk_bf16_f32 v54, v116, v117
  v_cvt_pk_bf16_f32 v55, v118, v119
  s_add_u32 s58, s81, 1024
  v_permlane16_swap_b32 v52, v54
  v_permlane16_swap_b32 v53, v55
  buffer_store_dwordx4 v[52:55], v14, s[24:27], s58 offen sc1
  v_pk_mul_f32 v[120:121], v[120:121], s[14:15]
  v_pk_mul_f32 v[122:123], v[122:123], s[14:15]
  v_pk_mul_f32 v[124:125], v[124:125], s[14:15]
  v_pk_mul_f32 v[126:127], v[126:127], s[14:15]
  v_pk_mul_f32 v[128:129], v[128:129], s[14:15]
  v_pk_mul_f32 v[130:131], v[130:131], s[14:15]
  v_pk_mul_f32 v[132:133], v[132:133], s[14:15]
  v_pk_mul_f32 v[134:135], v[134:135], s[14:15]
  v_cvt_pk_bf16_f32 v40, v120, v121
  v_cvt_pk_bf16_f32 v41, v122, v123
  v_cvt_pk_bf16_f32 v42, v124, v125
  v_cvt_pk_bf16_f32 v43, v126, v127
  s_add_u32 s58, s81, 65536
  v_permlane16_swap_b32 v40, v42
  v_permlane16_swap_b32 v41, v43
  buffer_store_dwordx4 v[40:43], v14, s[24:27], s58 offen sc1
  v_cvt_pk_bf16_f32 v44, v128, v129
  v_cvt_pk_bf16_f32 v45, v130, v131
  v_cvt_pk_bf16_f32 v46, v132, v133
  v_cvt_pk_bf16_f32 v47, v134, v135
  s_add_u32 s58, s81, 66560
  v_permlane16_swap_b32 v44, v46
  v_permlane16_swap_b32 v45, v47
  buffer_store_dwordx4 v[44:47], v14, s[24:27], s58 offen sc1
  v_pk_mul_f32 v[136:137], v[136:137], s[14:15]
  v_pk_mul_f32 v[138:139], v[138:139], s[14:15]
  v_pk_mul_f32 v[140:141], v[140:141], s[14:15]
  v_pk_mul_f32 v[142:143], v[142:143], s[14:15]
  v_pk_mul_f32 v[144:145], v[144:145], s[14:15]
  v_pk_mul_f32 v[146:147], v[146:147], s[14:15]
  v_pk_mul_f32 v[148:149], v[148:149], s[14:15]
  v_pk_mul_f32 v[150:151], v[150:151], s[14:15]
  v_cvt_pk_bf16_f32 v48, v136, v137
  v_cvt_pk_bf16_f32 v49, v138, v139
  v_cvt_pk_bf16_f32 v50, v140, v141
  v_cvt_pk_bf16_f32 v51, v142, v143
  s_add_u32 s58, s81, 131072
  v_permlane16_swap_b32 v48, v50
  v_permlane16_swap_b32 v49, v51
  buffer_store_dwordx4 v[48:51], v14, s[24:27], s58 offen sc1
  v_cvt_pk_bf16_f32 v52, v144, v145
  v_cvt_pk_bf16_f32 v53, v146, v147
  v_cvt_pk_bf16_f32 v54, v148, v149
  v_cvt_pk_bf16_f32 v55, v150, v151
  s_add_u32 s58, s81, 132096
  v_permlane16_swap_b32 v52, v54
  v_permlane16_swap_b32 v53, v55
  buffer_store_dwordx4 v[52:55], v14, s[24:27], s58 offen sc1
  v_pk_mul_f32 v[152:153], v[152:153], s[14:15]
  v_pk_mul_f32 v[154:155], v[154:155], s[14:15]
  v_pk_mul_f32 v[156:157], v[156:157], s[14:15]
  v_pk_mul_f32 v[158:159], v[158:159], s[14:15]
  v_pk_mul_f32 v[160:161], v[160:161], s[14:15]
  v_pk_mul_f32 v[162:163], v[162:163], s[14:15]
  v_pk_mul_f32 v[164:165], v[164:165], s[14:15]
  v_pk_mul_f32 v[166:167], v[166:167], s[14:15]
  v_cvt_pk_bf16_f32 v40, v152, v153
  v_cvt_pk_bf16_f32 v41, v154, v155
  v_cvt_pk_bf16_f32 v42, v156, v157
  v_cvt_pk_bf16_f32 v43, v158, v159
  s_add_u32 s58, s81, 196608
  v_permlane16_swap_b32 v40, v42
  v_permlane16_swap_b32 v41, v43
  buffer_store_dwordx4 v[40:43], v14, s[24:27], s58 offen sc1
  v_cvt_pk_bf16_f32 v44, v160, v161
  v_cvt_pk_bf16_f32 v45, v162, v163
  v_cvt_pk_bf16_f32 v46, v164, v165
  v_cvt_pk_bf16_f32 v47, v166, v167
  s_add_u32 s58, s81, 197632
  v_permlane16_swap_b32 v44, v46
  v_permlane16_swap_b32 v45, v47
  buffer_store_dwordx4 v[44:47], v14, s[24:27], s58 offen sc1
K1_NT_b_done:
  s_nop 1
  s_branch K1_FIN
K1_NN:
  s_sub_u32 s58, s56, 3
  s_cmp_eq_u32 s56, 2
  s_cselect_b32 s58, 0, s58
  s_mul_i32 s58, s58, 2359296
  s_mul_i32 s59, s53, 147456
  s_add_u32 s80, s58, s59
  s_add_u32 s80, s80, 7340032
  s_sub_u32 s58, s57, 3
  s_cmp_eq_u32 s57, 2
  s_cselect_b32 s58, 0, s58
  s_mul_i32 s58, s58, 2359296
  s_mul_i32 s59, s54, 147456
  s_add_u32 s81, s58, s59
  s_add_u32 s81, s81, 7340032
  s_sub_u32 s58, s57, 3
  s_cmp_eq_u32 s57, 2
  s_cselect_b32 s58, 0, s58
  s_mul_i32 s58, s58, 2359296
  s_mul_i32 s59, s55, 147456
  s_add_u32 s82, s58, s59
  s_add_u32 s82, s82, 7340032
  s_cmp_eq_u32 s56, 0
  s_cselect_b32 s30, 1051597459, 1.0
  s_mov_b32 s31, s30
  s_cmp_eq_u32 s57, 0
  s_cselect_b32 s14, 1051597459, 1.0
  s_mov_b32 s15, s14
  s_mov_b32 s74, 1069066811
  s_mov_b32 s75, 1069066811
  s_mov_b32 s76, 897988541
  s_barrier
  ds_read_b64_tr_b16 v[12:13], v3 offset:0
  ds_read_b64_tr_b16 v[14:15], v3 offset:1792
  ds_read_b128 v[24:27], v9 offset:0
  ds_read_b128 v[28:31], v9 offset:512
  ds_read_b128 v[32:35], v9 offset:4096
  ds_read_b128 v[36:39], v9 offset:4608
  ds_read_b64_tr_b16 v[16:17], v3 offset:40
  ds_read_b64_tr_b16 v[18:19], v3 offset:1832
  ds_read_b64_tr_b16 v[20:21], v4 offset:0
  ds_read_b64_tr_b16 v[22:23], v4 offset:1792
  s_waitcnt lgkmcnt(10)
K1_NN_LOOP:
  s_waitcnt lgkmcnt(7)
  v_mfma_f32_16x16x32_bf16 v[56:59], v[24:27], v[12:15], v[56:59]
  s_waitcnt lgkmcnt(6)
  v_mfma_f32_16x16x32_bf16 v[60:63], v[28:31], v[12:15], v[60:63]
  s_waitcnt lgkmcnt(5)
  v_mfma_f32_16x16x32_bf16 v[64:67], v[32:35], v[12:15], v[64:67]
  s_waitcnt lgkmcnt(4)
  v_mfma_f32_16x16x32_bf16 v[68:71], v[36:39], v[12:15], v[68:71]
  ds_read_b64_tr_b16 v[12:13], v5 offset:0
  ds_read_b64_tr_b16 v[14:15], v5 offset:1792
  s_waitcnt lgkmcnt(4)
  v_mfma_f32_16x16x32_bf16 v[72:75], v[24:27], v[16:19], v[72:75]
  v_mfma_f32_16x16x32_bf16 v[76:79], v[28:31], v[16:19], v[76:79]
  v_mfma_f32_16x16x32_bf16 v[80:83], v[32:35], v[16:19], v[80:83]
  v_mfma_f32_16x16x32_bf16 v[84:87], v[36:39], v[16:19], v[84:87]
  ds_read_b64_tr_b16 v[16:17], v5 offset:40
  ds_read_b64_tr_b16 v[18:19], v5 offset:1832
  s_waitcnt lgkmcnt(4)
  v_mfma_f32_16x16x32_bf16 v[88:91], v[24:27], v[20:23], v[88:91]
  v_mfma_f32_16x16x32_bf16 v[92:95], v[28:31], v[20:23], v[92:95]
  v_mfma_f32_16x16x32_bf16 v[96:99], v[32:35], v[20:23], v[96:99]
  v_mfma_f32_16x16x32_bf16 v[100:103], v[36:39], v[20:23], v[100:103]
  ds_read_b64_tr_b16 v[20:21], v5 offset:72
  ds_read_b64_tr_b16 v[22:23], v5 offset:1864
  s_waitcnt lgkmcnt(4)
  v_mfma_f32_16x16x32_bf16 v[104:107], v[24:27], v[12:15], v[104:107]
  v_mfma_f32_16x16x32_bf16 v[108:111], v[28:31], v[12:15], v[108:111]
  v_mfma_f32_16x16x32_bf16 v[112:115], v[32:35], v[12:15], v[112:115]
  v_mfma_f32_16x16x32_bf16 v[116:119], v[36:39], v[12:15], v[116:119]
  ds_read_b64_tr_b16 v[12:13], v5 offset:112
  ds_read_b64_tr_b16 v[14:15], v5 offset:1904
  s_waitcnt lgkmcnt(4)
  v_mfma_f32_16x16x32_bf16 v[120:123], v[24:27], v[16:19], v[120:123]
  v_mfma_f32_16x16x32_bf16 v[124:127], v[28:31], v[16:19], v[124:127]
  v_mfma_f32_16x16x32_bf16 v[128:131], v[32:35], v[16:19], v[128:131]
  v_mfma_f32_16x16x32_bf16 v[132:135], v[36:39], v[16:19], v[132:135]
  s_waitcnt lgkmcnt(0)
  s_barrier
  ds_read_b64_tr_b16 v[16:17], v3 offset:14400
  ds_read_b64_tr_b16 v[18:19], v3 offset:16192
  v_mfma_f32_16x16x32_bf16 v[136:139], v[24:27], v[20:23], v[136:139]
  ds_read_b128 v[40:43], v10 offset:0
  v_mfma_f32_16x16x32_bf16 v[140:143], v[28:31], v[20:23], v[140:143]
  ds_read_b128 v[44:47], v10 offset:512
  v_mfma_f32_16x16x32_bf16 v[144:147], v[32:35], v[20:23], v[144:147]
  ds_read_b128 v[48:51], v10 offset:4096
  v_mfma_f32_16x16x32_bf16 v[148:151], v[36:39], v[20:23], v[148:151]
  ds_read_b128 v[52:55], v10 offset:4608
  ds_read_b64_tr_b16 v[20:21], v3 offset:14440
  ds_read_b64_tr_b16 v[22:23], v3 offset:16232
  v_mfma_f32_16x16x32_bf16 v[152:155], v[24:27], v[12:15], v[152:155]
  v_mfma_f32_16x16x32_bf16 v[156:159], v[28:31], v[12:15], v[156:159]
  s_add_u32 s79, s79, 16384
  s_and_b32 s79, s79, 65535
  v_add_u32 v9, s79, v11
  v_xor_b32 v10, 64, v9
  v_mfma_f32_16x16x32_bf16 v[160:163], v[32:35], v[12:15], v[160:163]
  v_mfma_f32_16x16x32_bf16 v[164:167], v[36:39], v[12:15], v[164:167]
  ds_read_b64_tr_b16 v[12:13], v4 offset:14400
  ds_read_b64_tr_b16 v[14:15], v4 offset:16192
  s_waitcnt lgkmcnt(7)
  v_mfma_f32_16x16x32_bf16 v[56:59], v[40:43], v[16:19], v[56:59]
  s_waitcnt lgkmcnt(6)
  v_mfma_f32_16x16x32_bf16 v[60:63], v[44:47], v[16:19], v[60:63]
  s_waitcnt lgkmcnt(5)
  v_mfma_f32_16x16x32_bf16 v[64:67], v[48:51], v[16:19], v[64:67]
  s_waitcnt lgkmcnt(4)
  v_mfma_f32_16x16x32_bf16 v[68:71], v[52:55], v[16:19], v[68:71]
  ds_read_b64_tr_b16 v[16:17], v5 offset:14400
  ds_read_b64_tr_b16 v[18:19], v5 offset:16192
  s_waitcnt lgkmcnt(4)
  v_mfma_f32_16x16x32_bf16 v[72:75], v[40:43], v[20:23], v[72:75]
  v_mfma_f32_16x16x32_bf16 v[76:79], v[44:47], v[20:23], v[76:79]
  v_mfma_f32_16x16x32_bf16 v[80:83], v[48:51], v[20:23], v[80:83]
  v_mfma_f32_16x16x32_bf16 v[84:87], v[52:55], v[20:23], v[84:87]
  ds_read_b64_tr_b16 v[20:21], v5 offset:14440
  ds_read_b64_tr_b16 v[22:23], v5 offset:16232
  s_waitcnt lgkmcnt(4)
  v_mfma_f32_16x16x32_bf16 v[88:91], v[40:43], v[12:15], v[88:91]
  v_mfma_f32_16x16x32_bf16 v[92:95], v[44:47], v[12:15], v[92:95]
  v_mfma_f32_16x16x32_bf16 v[96:99], v[48:51], v[12:15], v[96:99]
  v_mfma_f32_16x16x32_bf16 v[100:103], v[52:55], v[12:15], v[100:103]
  ds_read_b64_tr_b16 v[12:13], v5 offset:14472
  ds_read_b64_tr_b16 v[14:15], v5 offset:16264
  s_waitcnt lgkmcnt(4)
  v_mfma_f32_16x16x32_bf16 v[104:107], v[40:43], v[16:19], v[104:107]
  v_mfma_f32_16x16x32_bf16 v[108:111], v[44:47], v[16:19], v[108:111]
  v_mfma_f32_16x16x32_bf16 v[112:115], v[48:51], v[16:19], v[112:115]
  v_mfma_f32_16x16x32_bf16 v[116:119], v[52:55], v[16:19], v[116:119]
  ds_read_b64_tr_b16 v[16:17], v5 offset:14512
  ds_read_b64_tr_b16 v[18:19], v5 offset:16304
  s_waitcnt lgkmcnt(4)
  v_mfma_f32_16x16x32_bf16 v[120:123], v[40:43], v[20:23], v[120:123]
  v_mfma_f32_16x16x32_bf16 v[124:127], v[44:47], v[20:23], v[124:127]
  v_mfma_f32_16x16x32_bf16 v[128:131], v[48:51], v[20:23], v[128:131]
  v_mfma_f32_16x16x32_bf16 v[132:135], v[52:55], v[20:23], v[132:135]
  s_waitcnt lgkmcnt(0)
  s_barrier
  ds_read_b64_tr_b16 v[20:21], v3 offset:28800
  ds_read_b64_tr_b16 v[22:23], v3 offset:30592
  v_mfma_f32_16x16x32_bf16 v[136:139], v[40:43], v[12:15], v[136:139]
  ds_read_b128 v[24:27], v9 offset:0
  v_mfma_f32_16x16x32_bf16 v[140:143], v[44:47], v[12:15], v[140:143]
  ds_read_b128 v[28:31], v9 offset:512
  v_mfma_f32_16x16x32_bf16 v[144:147], v[48:51], v[12:15], v[144:147]
  ds_read_b128 v[32:35], v9 offset:4096
  v_mfma_f32_16x16x32_bf16 v[148:151], v[52:55], v[12:15], v[148:151]
  ds_read_b128 v[36:39], v9 offset:4608
  ds_read_b64_tr_b16 v[12:13], v3 offset:28840
  ds_read_b64_tr_b16 v[14:15], v3 offset:30632
  v_mfma_f32_16x16x32_bf16 v[152:155], v[40:43], v[16:19], v[152:155]
  v_mfma_f32_16x16x32_bf16 v[156:159], v[44:47], v[16:19], v[156:159]
  v_mfma_f32_16x16x32_bf16 v[160:163], v[48:51], v[16:19], v[160:163]
  v_mfma_f32_16x16x32_bf16 v[164:167], v[52:55], v[16:19], v[164:167]
  ds_read_b64_tr_b16 v[16:17], v4 offset:28800
  ds_read_b64_tr_b16 v[18:19], v4 offset:30592
  s_waitcnt lgkmcnt(7)
  v_mfma_f32_16x16x32_bf16 v[56:59], v[24:27], v[20:23], v[56:59]
  s_waitcnt lgkmcnt(6)
  v_mfma_f32_16x16x32_bf16 v[60:63], v[28:31], v[20:23], v[60:63]
  s_waitcnt lgkmcnt(5)
  v_mfma_f32_16x16x32_bf16 v[64:67], v[32:35], v[20:23], v[64:67]
  s_waitcnt lgkmcnt(4)
  v_mfma_f32_16x16x32_bf16 v[68:71], v[36:39], v[20:23], v[68:71]
  ds_read_b64_tr_b16 v[20:21], v5 offset:28800
  ds_read_b64_tr_b16 v[22:23], v5 offset:30592
  s_waitcnt lgkmcnt(4)
  v_mfma_f32_16x16x32_bf16 v[72:75], v[24:27], v[12:15], v[72:75]
  v_mfma_f32_16x16x32_bf16 v[76:79], v[28:31], v[12:15], v[76:79]
  v_mfma_f32_16x16x32_bf16 v[80:83], v[32:35], v[12:15], v[80:83]
  v_mfma_f32_16x16x32_bf16 v[84:87], v[36:39], v[12:15], v[84:87]
  ds_read_b64_tr_b16 v[12:13], v5 offset:28840
  ds_read_b64_tr_b16 v[14:15], v5 offset:30632
  s_waitcnt lgkmcnt(4)
  v_mfma_f32_16x16x32_bf16 v[88:91], v[24:27], v[16:19], v[88:91]
  v_mfma_f32_16x16x32_bf16 v[92:95], v[28:31], v[16:19], v[92:95]
  v_mfma_f32_16x16x32_bf16 v[96:99], v[32:35], v[16:19], v[96:99]
  v_mfma_f32_16x16x32_bf16 v[100:103], v[36:39], v[16:19], v[100:103]
  ds_read_b64_tr_b16 v[16:17], v5 offset:28872
  ds_read_b64_tr_b16 v[18:19], v5 offset:30664
  s_waitcnt lgkmcnt(4)
  v_mfma_f32_16x16x32_bf16 v[104:107], v[24:27], v[20:23], v[104:107]
  v_mfma_f32_16x16x32_bf16 v[108:111], v[28:31], v[20:23], v[108:111]
  v_mfma_f32_16x16x32_bf16 v[112:115], v[32:35], v[20:23], v[112:115]
  v_mfma_f32_16x16x32_bf16 v[116:119], v[36:39], v[20:23], v[116:119]
  ds_read_b64_tr_b16 v[20:21], v5 offset:28912
  ds_read_b64_tr_b16 v[22:23], v5 offset:30704
  s_waitcnt lgkmcnt(4)
  v_mfma_f32_16x16x32_bf16 v[120:123], v[24:27], v[12:15], v[120:123]
  v_mfma_f32_16x16x32_bf16 v[124:127], v[28:31], v[12:15], v[124:127]
  v_mfma_f32_16x16x32_bf16 v[128:131], v[32:35], v[12:15], v[128:131]
  v_mfma_f32_16x16x32_bf16 v[132:135], v[36:39], v[12:15], v[132:135]
  s_waitcnt lgkmcnt(0)
  s_barrier
  ds_read_b64_tr_b16 v[12:13], v6 offset:0
  ds_read_b64_tr_b16 v[14:15], v6 offset:1792
  v_mfma_f32_16x16x32_bf16 v[136:139], v[24:27], v[16:19], v[136:139]
  ds_read_b128 v[40:43], v10 offset:0
  v_mfma_f32_16x16x32_bf16 v[140:143], v[28:31], v[16:19], v[140:143]
  ds_read_b128 v[44:47], v10 offset:512
  v_mfma_f32_16x16x32_bf16 v[144:147], v[32:35], v[16:19], v[144:147]
  ds_read_b128 v[48:51], v10 offset:4096
  v_mfma_f32_16x16x32_bf16 v[148:151], v[36:39], v[16:19], v[148:151]
  ds_read_b128 v[52:55], v10 offset:4608
  ds_read_b64_tr_b16 v[16:17], v6 offset:40
  ds_read_b64_tr_b16 v[18:19], v6 offset:1832
  v_mfma_f32_16x16x32_bf16 v[152:155], v[24:27], v[20:23], v[152:155]
  v_mfma_f32_16x16x32_bf16 v[156:159], v[28:31], v[20:23], v[156:159]
  s_add_u32 s79, s79, 16384
  s_and_b32 s79, s79, 65535
  v_add_u32 v9, s79, v11
  v_xor_b32 v10, 64, v9
  v_mfma_f32_16x16x32_bf16 v[160:163], v[32:35], v[20:23], v[160:163]
  v_mfma_f32_16x16x32_bf16 v[164:167], v[36:39], v[20:23], v[164:167]
  ds_read_b64_tr_b16 v[20:21], v7 offset:0
  ds_read_b64_tr_b16 v[22:23], v7 offset:1792
  s_waitcnt lgkmcnt(7)
  v_mfma_f32_16x16x32_bf16 v[56:59], v[40:43], v[12:15], v[56:59]
  s_waitcnt lgkmcnt(6)
  v_mfma_f32_16x16x32_bf16 v[60:63], v[44:47], v[12:15], v[60:63]
  s_waitcnt lgkmcnt(5)
  v_mfma_f32_16x16x32_bf16 v[64:67], v[48:51], v[12:15], v[64:67]
  s_waitcnt lgkmcnt(4)
  v_mfma_f32_16x16x32_bf16 v[68:71], v[52:55], v[12:15], v[68:71]
  ds_read_b64_tr_b16 v[12:13], v8 offset:0
  ds_read_b64_tr_b16 v[14:15], v8 offset:1792
  s_waitcnt lgkmcnt(4)
  v_mfma_f32_16x16x32_bf16 v[72:75], v[40:43], v[16:19], v[72:75]
  v_mfma_f32_16x16x32_bf16 v[76:79], v[44:47], v[16:19], v[76:79]
  v_mfma_f32_16x16x32_bf16 v[80:83], v[48:51], v[16:19], v[80:83]
  v_mfma_f32_16x16x32_bf16 v[84:87], v[52:55], v[16:19], v[84:87]
  ds_read_b64_tr_b16 v[16:17], v8 offset:40
  ds_read_b64_tr_b16 v[18:19], v8 offset:1832
  s_waitcnt lgkmcnt(4)
  v_mfma_f32_16x16x32_bf16 v[88:91], v[40:43], v[20:23], v[88:91]
  v_mfma_f32_16x16x32_bf16 v[92:95], v[44:47], v[20:23], v[92:95]
  v_mfma_f32_16x16x32_bf16 v[96:99], v[48:51], v[20:23], v[96:99]
  v_mfma_f32_16x16x32_bf16 v[100:103], v[52:55], v[20:23], v[100:103]
  ds_read_b64_tr_b16 v[20:21], v8 offset:72
  ds_read_b64_tr_b16 v[22:23], v8 offset:1864
  s_waitcnt lgkmcnt(4)
  v_mfma_f32_16x16x32_bf16 v[104:107], v[40:43], v[12:15], v[104:107]
  v_mfma_f32_16x16x32_bf16 v[108:111], v[44:47], v[12:15], v[108:111]
  v_mfma_f32_16x16x32_bf16 v[112:115], v[48:51], v[12:15], v[112:115]
  v_mfma_f32_16x16x32_bf16 v[116:119], v[52:55], v[12:15], v[116:119]
  ds_read_b64_tr_b16 v[12:13], v8 offset:112
  ds_read_b64_tr_b16 v[14:15], v8 offset:1904
  s_waitcnt lgkmcnt(4)
  v_mfma_f32_16x16x32_bf16 v[120:123], v[40:43], v[16:19], v[120:123]
  v_mfma_f32_16x16x32_bf16 v[124:127], v[44:47], v[16:19], v[124:127]
  v_mfma_f32_16x16x32_bf16 v[128:131], v[48:51], v[16:19], v[128:131]
  v_mfma_f32_16x16x32_bf16 v[132:135], v[52:55], v[16:19], v[132:135]
  s_waitcnt lgkmcnt(0)
  s_barrier
  ds_read_b64_tr_b16 v[16:17], v6 offset:14400
  ds_read_b64_tr_b16 v[18:19], v6 offset:16192
  v_mfma_f32_16x16x32_bf16 v[136:139], v[40:43], v[20:23], v[136:139]
  ds_read_b128 v[24:27], v9 offset:0
  v_mfma_f32_16x16x32_bf16 v[140:143], v[44:47], v[20:23], v[140:143]
  ds_read_b128 v[28:31], v9 offset:512
  v_mfma_f32_16x16x32_bf16 v[144:147], v[48:51], v[20:23], v[144:147]
  ds_read_b128 v[32:35], v9 offset:4096
  v_mfma_f32_16x16x32_bf16 v[148:151], v[52:55], v[20:23], v[148:151]
  ds_read_b128 v[36:39], v9 offset:4608
  ds_read_b64_tr_b16 v[20:21], v6 offset:14440
  ds_read_b64_tr_b16 v[22:23], v6 offset:16232
  v_mfma_f32_16x16x32_bf16 v[152:155], v[40:43], v[12:15], v[152:155]
  v_mfma_f32_16x16x32_bf16 v[156:159], v[44:47], v[12:15], v[156:159]
  v_mfma_f32_16x16x32_bf16 v[160:163], v[48:51], v[12:15], v[160:163]
  v_mfma_f32_16x16x32_bf16 v[164:167], v[52:55], v[12:15], v[164:167]
  ds_read_b64_tr_b16 v[12:13], v7 offset:14400
  ds_read_b64_tr_b16 v[14:15], v7 offset:16192
  s_waitcnt lgkmcnt(7)
  v_mfma_f32_16x16x32_bf16 v[56:59], v[24:27], v[16:19], v[56:59]
  s_waitcnt lgkmcnt(6)
  v_mfma_f32_16x16x32_bf16 v[60:63], v[28:31], v[16:19], v[60:63]
  s_waitcnt lgkmcnt(5)
  v_mfma_f32_16x16x32_bf16 v[64:67], v[32:35], v[16:19], v[64:67]
  s_waitcnt lgkmcnt(4)
  v_mfma_f32_16x16x32_bf16 v[68:71], v[36:39], v[16:19], v[68:71]
  ds_read_b64_tr_b16 v[16:17], v8 offset:14400
  ds_read_b64_tr_b16 v[18:19], v8 offset:16192
  s_waitcnt lgkmcnt(4)
  v_mfma_f32_16x16x32_bf16 v[72:75], v[24:27], v[20:23], v[72:75]
  v_mfma_f32_16x16x32_bf16 v[76:79], v[28:31], v[20:23], v[76:79]
  v_mfma_f32_16x16x32_bf16 v[80:83], v[32:35], v[20:23], v[80:83]
  v_mfma_f32_16x16x32_bf16 v[84:87], v[36:39], v[20:23], v[84:87]
  ds_read_b64_tr_b16 v[20:21], v8 offset:14440
  ds_read_b64_tr_b16 v[22:23], v8 offset:16232
  s_waitcnt lgkmcnt(4)
  v_mfma_f32_16x16x32_bf16 v[88:91], v[24:27], v[12:15], v[88:91]
  v_mfma_f32_16x16x32_bf16 v[92:95], v[28:31], v[12:15], v[92:95]
  v_mfma_f32_16x16x32_bf16 v[96:99], v[32:35], v[12:15], v[96:99]
  v_mfma_f32_16x16x32_bf16 v[100:103], v[36:39], v[12:15], v[100:103]
  ds_read_b64_tr_b16 v[12:13], v8 offset:14472
  ds_read_b64_tr_b16 v[14:15], v8 offset:16264
  s_waitcnt lgkmcnt(4)
  v_mfma_f32_16x16x32_bf16 v[104:107], v[24:27], v[16:19], v[104:107]
  v_mfma_f32_16x16x32_bf16 v[108:111], v[28:31], v[16:19], v[108:111]
  v_mfma_f32_16x16x32_bf16 v[112:115], v[32:35], v[16:19], v[112:115]
  v_mfma_f32_16x16x32_bf16 v[116:119], v[36:39], v[16:19], v[116:119]
  ds_read_b64_tr_b16 v[16:17], v8 offset:14512
  ds_read_b64_tr_b16 v[18:19], v8 offset:16304
  s_waitcnt lgkmcnt(4)
  v_mfma_f32_16x16x32_bf16 v[120:123], v[24:27], v[20:23], v[120:123]
  v_mfma_f32_16x16x32_bf16 v[124:127], v[28:31], v[20:23], v[124:127]
  v_mfma_f32_16x16x32_bf16 v[128:131], v[32:35], v[20:23], v[128:131]
  v_mfma_f32_16x16x32_bf16 v[132:135], v[36:39], v[20:23], v[132:135]
  s_waitcnt lgkmcnt(0)
  s_barrier
  ds_read_b64_tr_b16 v[20:21], v6 offset:28800
  ds_read_b64_tr_b16 v[22:23], v6 offset:30592
  v_mfma_f32_16x16x32_bf16 v[136:139], v[24:27], v[12:15], v[136:139]
  ds_read_b128 v[40:43], v10 offset:0
  v_mfma_f32_16x16x32_bf16 v[140:143], v[28:31], v[12:15], v[140:143]
  ds_read_b128 v[44:47], v10 offset:512
  v_mfma_f32_16x16x32_bf16 v[144:147], v[32:35], v[12:15], v[144:147]
  ds_read_b128 v[48:51], v10 offset:4096
  v_mfma_f32_16x16x32_bf16 v[148:151], v[36:39], v[12:15], v[148:151]
  ds_read_b128 v[52:55], v10 offset:4608
  ds_read_b64_tr_b16 v[12:13], v6 offset:28840
  ds_read_b64_tr_b16 v[14:15], v6 offset:30632
  v_mfma_f32_16x16x32_bf16 v[152:155], v[24:27], v[16:19], v[152:155]
  v_mfma_f32_16x16x32_bf16 v[156:159], v[28:31], v[16:19], v[156:159]
  s_add_u32 s79, s79, 16384
  s_and_b32 s79, s79, 65535
  v_add_u32 v9, s79, v11
  v_xor_b32 v10, 64, v9
  v_mfma_f32_16x16x32_bf16 v[160:163], v[32:35], v[16:19], v[160:163]
  v_mfma_f32_16x16x32_bf16 v[164:167], v[36:39], v[16:19], v[164:167]
  ds_read_b64_tr_b16 v[16:17], v7 offset:28800
  ds_read_b64_tr_b16 v[18:19], v7 offset:30592
  s_waitcnt lgkmcnt(7)
  v_mfma_f32_16x16x32_bf16 v[56:59], v[40:43], v[20:23], v[56:59]
  s_waitcnt lgkmcnt(6)
  v_mfma_f32_16x16x32_bf16 v[60:63], v[44:47], v[20:23], v[60:63]
  s_waitcnt lgkmcnt(5)
  v_mfma_f32_16x16x32_bf16 v[64:67], v[48:51], v[20:23], v[64:67]
  s_waitcnt lgkmcnt(4)
  v_mfma_f32_16x16x32_bf16 v[68:71], v[52:55], v[20:23], v[68:71]
  ds_read_b64_tr_b16 v[20:21], v8 offset:28800
  ds_read_b64_tr_b16 v[22:23], v8 offset:30592
  s_waitcnt lgkmcnt(4)
  v_mfma_f32_16x16x32_bf16 v[72:75], v[40:43], v[12:15], v[72:75]
  v_mfma_f32_16x16x32_bf16 v[76:79], v[44:47], v[12:15], v[76:79]
  v_mfma_f32_16x16x32_bf16 v[80:83], v[48:51], v[12:15], v[80:83]
  v_mfma_f32_16x16x32_bf16 v[84:87], v[52:55], v[12:15], v[84:87]
  ds_read_b64_tr_b16 v[12:13], v8 offset:28840
  ds_read_b64_tr_b16 v[14:15], v8 offset:30632
  s_waitcnt lgkmcnt(4)
  v_mfma_f32_16x16x32_bf16 v[88:91], v[40:43], v[16:19], v[88:91]
  v_mfma_f32_16x16x32_bf16 v[92:95], v[44:47], v[16:19], v[92:95]
  v_mfma_f32_16x16x32_bf16 v[96:99], v[48:51], v[16:19], v[96:99]
  v_mfma_f32_16x16x32_bf16 v[100:103], v[52:55], v[16:19], v[100:103]
  ds_read_b64_tr_b16 v[16:17], v8 offset:28872
  ds_read_b64_tr_b16 v[18:19], v8 offset:30664
  s_waitcnt lgkmcnt(4)
  v_mfma_f32_16x16x32_bf16 v[104:107], v[40:43], v[20:23], v[104:107]
  v_mfma_f32_16x16x32_bf16 v[108:111], v[44:47], v[20:23], v[108:111]
  v_mfma_f32_16x16x32_bf16 v[112:115], v[48:51], v[20:23], v[112:115]
  v_mfma_f32_16x16x32_bf16 v[116:119], v[52:55], v[20:23], v[116:119]
  ds_read_b64_tr_b16 v[20:21], v8 offset:28912
  ds_read_b64_tr_b16 v[22:23], v8 offset:30704
  s_waitcnt lgkmcnt(4)
  v_mfma_f32_16x16x32_bf16 v[120:123], v[40:43], v[12:15], v[120:123]
  v_mfma_f32_16x16x32_bf16 v[124:127], v[44:47], v[12:15], v[124:127]
  v_mfma_f32_16x16x32_bf16 v[128:131], v[48:51], v[12:15], v[128:131]
  v_mfma_f32_16x16x32_bf16 v[132:135], v[52:55], v[12:15], v[132:135]
  s_waitcnt lgkmcnt(0)
  s_barrier
  ds_read_b64_tr_b16 v[12:13], v3 offset:0
  ds_read_b64_tr_b16 v[14:15], v3 offset:1792
  v_mfma_f32_16x16x32_bf16 v[136:139], v[40:43], v[16:19], v[136:139]
  ds_read_b128 v[24:27], v9 offset:0
  v_mfma_f32_16x16x32_bf16 v[140:143], v[44:47], v[16:19], v[140:143]
  ds_read_b128 v[28:31], v9 offset:512
  v_mfma_f32_16x16x32_bf16 v[144:147], v[48:51], v[16:19], v[144:147]
  ds_read_b128 v[32:35], v9 offset:4096
  v_mfma_f32_16x16x32_bf16 v[148:151], v[52:55], v[16:19], v[148:151]
  ds_read_b128 v[36:39], v9 offset:4608
  ds_read_b64_tr_b16 v[16:17], v3 offset:40
  ds_read_b64_tr_b16 v[18:19], v3 offset:1832
  v_mfma_f32_16x16x32_bf16 v[152:155], v[40:43], v[20:23], v[152:155]
  v_mfma_f32_16x16x32_bf16 v[156:159], v[44:47], v[20:23], v[156:159]
  v_mfma_f32_16x16x32_bf16 v[160:163], v[48:51], v[20:23], v[160:163]
  v_mfma_f32_16x16x32_bf16 v[164:167], v[52:55], v[20:23], v[164:167]
  ds_read_b64_tr_b16 v[20:21], v4 offset:0
  ds_read_b64_tr_b16 v[22:23], v4 offset:1792
  s_sub_u32 s73, s73, 1
  s_cmp_lg_u32 s73, 0
  s_cbranch_scc1 K1_NN_LOOP
  s_waitcnt lgkmcnt(0)
  v_and_b32 v19, 15, v2
  v_lshrrev_b32 v20, 2, v19
  v_and_b32 v19, 3, v19
  v_lshl_add_u32 v12, v20, 3, v19
  v_lshrrev_b32 v13, 4, v2
  v_mov_b32 v22, 3049366176
  v_mov_b32 v23, 3049366176
  s_lshr_b32 s58, s77, 3
  v_add_u32 v19, s58, v13
  v_mul_u32_u24 v19, 18, v19
  v_and_b32 v20, 15, v2
  v_add_u32 v16, v19, v20
  v_lshlrev_b32 v16, 4, v16
  v_and_b32 v21, 1, v20
  v_add3_u32 v21, v19, v21, 16
  v_lshlrev_b32 v21, 4, v21
  v_lshrrev_b32 v1, 1, v20
  s_mov_b32 s58, 73728
  v_mul_lo_u32 v1, v1, s58
  v_add_u32 v17, v21, v1
  v_mov_b32 v21, 0x7FF00000
  v_lshrrev_b32 v1, 2, v20
  v_cmp_gt_u32 vcc, s50, v1
  s_nop 1
  v_cndmask_b32 v17, v21, v17, vcc
  s_cmp_eq_u32 s66, 0
  s_cbranch_scc1 K1_NN_a_nophi
  v_pk_fma_f32 v[24:25], v[56:57], s[74:75], v[22:23]
  v_pk_fma_f32 v[26:27], v[58:59], s[74:75], v[22:23]
  v_pk_fma_f32 v[28:29], v[60:61], s[74:75], v[22:23]
  v_pk_fma_f32 v[30:31], v[62:63], s[74:75], v[22:23]
  v_pk_fma_f32 v[32:33], v[64:65], s[74:75], v[22:23]
  v_pk_fma_f32 v[34:35], v[66:67], s[74:75], v[22:23]
  v_pk_fma_f32 v[36:37], v[68:69], s[74:75], v[22:23]
  v_pk_fma_f32 v[38:39], v[70:71], s[74:75], v[22:23]
  v_exp_f32_e64 v24, v24 clamp
  v_max_f32 v56, s76, v56
  v_exp_f32_e64 v25, v25 clamp
  v_max_f32 v57, s76, v57
  v_exp_f32_e64 v26, v26 clamp
  v_max_f32 v58, s76, v58
  v_exp_f32_e64 v27, v27 clamp
  v_max_f32 v59, s76, v59
  v_exp_f32_e64 v28, v28 clamp
  v_max_f32 v60, s76, v60
  v_exp_f32_e64 v29, v29 clamp
  v_max_f32 v61, s76, v61
  v_exp_f32_e64 v30, v30 clamp
  v_max_f32 v62, s76, v62
  v_exp_f32_e64 v31, v31 clamp
  v_max_f32 v63, s76, v63
  v_exp_f32_e64 v32, v32 clamp
  v_max_f32 v64, s76, v64
  v_exp_f32_e64 v33, v33 clamp
  v_max_f32 v65, s76, v65
  v_exp_f32_e64 v34, v34 clamp
  v_max_f32 v66, s76, v66
  v_exp_f32_e64 v35, v35 clamp
  v_max_f32 v67, s76, v67
  v_exp_f32_e64 v36, v36 clamp
  v_max_f32 v68, s76, v68
  v_exp_f32_e64 v37, v37 clamp
  v_max_f32 v69, s76, v69
  v_exp_f32_e64 v38, v38 clamp
  v_max_f32 v70, s76, v70
  v_exp_f32_e64 v39, v39 clamp
  v_max_f32 v71, s76, v71
  v_pk_add_f32 v[56:57], v[56:57], v[24:25]
  v_pk_add_f32 v[58:59], v[58:59], v[26:27]
  v_pk_add_f32 v[60:61], v[60:61], v[28:29]
  v_pk_add_f32 v[62:63], v[62:63], v[30:31]
  v_pk_add_f32 v[64:65], v[64:65], v[32:33]
  v_pk_add_f32 v[66:67], v[66:67], v[34:35]
  v_pk_add_f32 v[68:69], v[68:69], v[36:37]
  v_pk_add_f32 v[70:71], v[70:71], v[38:39]
  v_cvt_pk_bf16_f32 v40, v56, v57
  v_cvt_pk_bf16_f32 v41, v58, v59
  v_cvt_pk_bf16_f32 v42, v60, v61
  v_cvt_pk_bf16_f32 v43, v62, v63
  s_add_u32 s58, s80, 0
  buffer_store_dwordx4 v[40:43], v16, s[24:27], s58 offen sc1
  v_cvt_pk_bf16_f32 v44, v64, v65
  v_cvt_pk_bf16_f32 v45, v66, v67
  v_cvt_pk_bf16_f32 v46, v68, v69
  v_cvt_pk_bf16_f32 v47, v70, v71
  s_add_u32 s58, s80, 1152
  buffer_store_dwordx4 v[44:47], v16, s[24:27], s58 offen sc1
  v_pk_fma_f32 v[24:25], v[72:73], s[74:75], v[22:23]
  v_pk_fma_f32 v[26:27], v[74:75], s[74:75], v[22:23]
  v_pk_fma_f32 v[28:29], v[76:77], s[74:75], v[22:23]
  v_pk_fma_f32 v[30:31], v[78:79], s[74:75], v[22:23]
  v_pk_fma_f32 v[32:33], v[80:81], s[74:75], v[22:23]
  v_pk_fma_f32 v[34:35], v[82:83], s[74:75], v[22:23]
  v_pk_fma_f32 v[36:37], v[84:85], s[74:75], v[22:23]
  v_pk_fma_f32 v[38:39], v[86:87], s[74:75], v[22:23]
  v_exp_f32_e64 v24, v24 clamp
  v_max_f32 v72, s76, v72
  v_exp_f32_e64 v25, v25 clamp
  v_max_f32 v73, s76, v73
  v_exp_f32_e64 v26, v26 clamp
  v_max_f32 v74, s76, v74
  v_exp_f32_e64 v27, v27 clamp
  v_max_f32 v75, s76, v75
  v_exp_f32_e64 v28, v28 clamp
  v_max_f32 v76, s76, v76
  v_exp_f32_e64 v29, v29 clamp
  v_max_f32 v77, s76, v77
  v_exp_f32_e64 v30, v30 clamp
  v_max_f32 v78, s76, v78
  v_exp_f32_e64 v31, v31 clamp
  v_max_f32 v79, s76, v79
  v_exp_f32_e64 v32, v32 clamp
  v_max_f32 v80, s76, v80
  v_exp_f32_e64 v33, v33 clamp
  v_max_f32 v81, s76, v81
  v_exp_f32_e64 v34, v34 clamp
  v_max_f32 v82, s76, v82
  v_exp_f32_e64 v35, v35 clamp
  v_max_f32 v83, s76, v83
  v_exp_f32_e64 v36, v36 clamp
  v_max_f32 v84, s76, v84
  v_exp_f32_e64 v37, v37 clamp
  v_max_f32 v85, s76, v85
  v_exp_f32_e64 v38, v38 clamp
  v_max_f32 v86, s76, v86
  v_exp_f32_e64 v39, v39 clamp
  v_max_f32 v87, s76, v87
  v_pk_add_f32 v[72:73], v[72:73], v[24:25]
  v_pk_add_f32 v[74:75], v[74:75], v[26:27]
  v_pk_add_f32 v[76:77], v[76:77], v[28:29]
  v_pk_add_f32 v[78:79], v[78:79], v[30:31]
  v_pk_add_f32 v[80:81], v[80:81], v[32:33]
  v_pk_add_f32 v[82:83], v[82:83], v[34:35]
  v_pk_add_f32 v[84:85], v[84:85], v[36:37]
  v_pk_add_f32 v[86:87], v[86:87], v[38:39]
  v_cvt_pk_bf16_f32 v48, v72, v73
  v_cvt_pk_bf16_f32 v49, v74, v75
  v_cvt_pk_bf16_f32 v50, v76, v77
  v_cvt_pk_bf16_f32 v51, v78, v79
  s_add_u32 s58, s80, 73728
  buffer_store_dwordx4 v[48:51], v16, s[24:27], s58 offen sc1
  v_cvt_pk_bf16_f32 v52, v80, v81
  v_cvt_pk_bf16_f32 v53, v82, v83
  v_cvt_pk_bf16_f32 v54, v84, v85
  v_cvt_pk_bf16_f32 v55, v86, v87
  s_add_u32 s58, s80, 74880
  buffer_store_dwordx4 v[52:55], v16, s[24:27], s58 offen sc1
  s_branch K1_NN_a_done
K1_NN_a_nophi:
  v_cvt_pk_bf16_f32 v40, v56, v57
  v_cvt_pk_bf16_f32 v41, v58, v59
  v_cvt_pk_bf16_f32 v42, v60, v61
  v_cvt_pk_bf16_f32 v43, v62, v63
  s_add_u32 s58, s80, 0
  buffer_store_dwordx4 v[40:43], v16, s[24:27], s58 offen sc1
  v_cvt_pk_bf16_f32 v44, v64, v65
  v_cvt_pk_bf16_f32 v45, v66, v67
  v_cvt_pk_bf16_f32 v46, v68, v69
  v_cvt_pk_bf16_f32 v47, v70, v71
  s_add_u32 s58, s80, 1152
  buffer_store_dwordx4 v[44:47], v16, s[24:27], s58 offen sc1
  v_cvt_pk_bf16_f32 v48, v72, v73
  v_cvt_pk_bf16_f32 v49, v74, v75
  v_cvt_pk_bf16_f32 v50, v76, v77
  v_cvt_pk_bf16_f32 v51, v78, v79
  s_add_u32 s58, s80, 73728
  buffer_store_dwordx4 v[48:51], v16, s[24:27], s58 offen sc1
  v_cvt_pk_bf16_f32 v52, v80, v81
  v_cvt_pk_bf16_f32 v53, v82, v83
  v_cvt_pk_bf16_f32 v54, v84, v85
  v_cvt_pk_bf16_f32 v55, v86, v87
  s_add_u32 s58, s80, 74880
  buffer_store_dwordx4 v[52:55], v16, s[24:27], s58 offen sc1
K1_NN_a_done:
  s_nop 1
  s_cmp_eq_u32 s67, 0
  s_cbranch_scc1 K1_NN_b_nophi
  v_pk_fma_f32 v[24:25], v[88:89], s[74:75], v[22:23]
  v_pk_fma_f32 v[26:27], v[90:91], s[74:75], v[22:23]
  v_pk_fma_f32 v[28:29], v[92:93], s[74:75], v[22:23]
  v_pk_fma_f32 v[30:31], v[94:95], s[74:75], v[22:23]
  v_pk_fma_f32 v[32:33], v[96:97], s[74:75], v[22:23]
  v_pk_fma_f32 v[34:35], v[98:99], s[74:75], v[22:23]
  v_pk_fma_f32 v[36:37], v[100:101], s[74:75], v[22:23]
  v_pk_fma_f32 v[38:39], v[102:103], s[74:75], v[22:23]
  v_exp_f32_e64 v24, v24 clamp
  v_max_f32 v88, s76, v88
  v_exp_f32_e64 v25, v25 clamp
  v_max_f32 v89, s76, v89
  v_exp_f32_e64 v26, v26 clamp
  v_max_f32 v90, s76, v90
  v_exp_f32_e64 v27, v27 clamp
  v_max_f32 v91, s76, v91
  v_exp_f32_e64 v28, v28 clamp
  v_max_f32 v92, s76, v92
  v_exp_f32_e64 v29, v29 clamp
  v_max_f32 v93, s76, v93
  v_exp_f32_e64 v30, v30 clamp
  v_max_f32 v94, s76, v94
  v_exp_f32_e64 v31, v31 clamp
  v_max_f32 v95, s76, v95
  v_exp_f32_e64 v32, v32 clamp
  v_max_f32 v96, s76, v96
  v_exp_f32_e64 v33, v33 clamp
  v_max_f32 v97, s76, v97
  v_exp_f32_e64 v34, v34 clamp
  v_max_f32 v98, s76, v98
  v_exp_f32_e64 v35, v35 clamp
  v_max_f32 v99, s76, v99
  v_exp_f32_e64 v36, v36 clamp
  v_max_f32 v100, s76, v100
  v_exp_f32_e64 v37, v37 clamp
  v_max_f32 v101, s76, v101
  v_exp_f32_e64 v38, v38 clamp
  v_max_f32 v102, s76, v102
  v_exp_f32_e64 v39, v39 clamp
  v_max_f32 v103, s76, v103
  v_pk_add_f32 v[88:89], v[88:89], v[24:25]
  v_pk_add_f32 v[90:91], v[90:91], v[26:27]
  v_pk_add_f32 v[92:93], v[92:93], v[28:29]
  v_pk_add_f32 v[94:95], v[94:95], v[30:31]
  v_pk_add_f32 v[96:97], v[96:97], v[32:33]
  v_pk_add_f32 v[98:99], v[98:99], v[34:35]
  v_pk_add_f32 v[100:101], v[100:101], v[36:37]
  v_pk_add_f32 v[102:103], v[102:103], v[38:39]
  v_cvt_pk_bf16_f32 v40, v88, v89
  v_cvt_pk_bf16_f32 v41, v90, v91
  v_cvt_pk_bf16_f32 v42, v92, v93
  v_cvt_pk_bf16_f32 v43, v94, v95
  s_add_u32 s58, s82, 0
  buffer_store_dwordx4 v[40:43], v17, s[24:27], s58 offen sc1
  v_cvt_pk_bf16_f32 v44, v96, v97
  v_cvt_pk_bf16_f32 v45, v98, v99
  v_cvt_pk_bf16_f32 v46, v100, v101
  v_cvt_pk_bf16_f32 v47, v102, v103
  s_add_u32 s58, s82, 1152
  buffer_store_dwordx4 v[44:47], v17, s[24:27], s58 offen sc1
  v_pk_fma_f32 v[24:25], v[104:105], s[74:75], v[22:23]
  v_pk_fma_f32 v[26:27], v[106:107], s[74:75], v[22:23]
  v_pk_fma_f32 v[28:29], v[108:109], s[74:75], v[22:23]
  v_pk_fma_f32 v[30:31], v[110:111], s[74:75], v[22:23]
  v_pk_fma_f32 v[32:33], v[112:113], s[74:75], v[22:23]
  v_pk_fma_f32 v[34:35], v[114:115], s[74:75], v[22:23]
  v_pk_fma_f32 v[36:37], v[116:117], s[74:75], v[22:23]
  v_pk_fma_f32 v[38:39], v[118:119], s[74:75], v[22:23]
  v_exp_f32_e64 v24, v24 clamp
  v_max_f32 v104, s76, v104
  v_exp_f32_e64 v25, v25 clamp
  v_max_f32 v105, s76, v105
  v_exp_f32_e64 v26, v26 clamp
  v_max_f32 v106, s76, v106
  v_exp_f32_e64 v27, v27 clamp
  v_max_f32 v107, s76, v107
  v_exp_f32_e64 v28, v28 clamp
  v_max_f32 v108, s76, v108
  v_exp_f32_e64 v29, v29 clamp
  v_max_f32 v109, s76, v109
  v_exp_f32_e64 v30, v30 clamp
  v_max_f32 v110, s76, v110
  v_exp_f32_e64 v31, v31 clamp
  v_max_f32 v111, s76, v111
  v_exp_f32_e64 v32, v32 clamp
  v_max_f32 v112, s76, v112
  v_exp_f32_e64 v33, v33 clamp
  v_max_f32 v113, s76, v113
  v_exp_f32_e64 v34, v34 clamp
  v_max_f32 v114, s76, v114
  v_exp_f32_e64 v35, v35 clamp
  v_max_f32 v115, s76, v115
  v_exp_f32_e64 v36, v36 clamp
  v_max_f32 v116, s76, v116
  v_exp_f32_e64 v37, v37 clamp
  v_max_f32 v117, s76, v117
  v_exp_f32_e64 v38, v38 clamp
  v_max_f32 v118, s76, v118
  v_exp_f32_e64 v39, v39 clamp
  v_max_f32 v119, s76, v119
  v_pk_add_f32 v[104:105], v[104:105], v[24:25]
  v_pk_add_f32 v[106:107], v[106:107], v[26:27]
  v_pk_add_f32 v[108:109], v[108:109], v[28:29]
  v_pk_add_f32 v[110:111], v[110:111], v[30:31]
  v_pk_add_f32 v[112:113], v[112:113], v[32:33]
  v_pk_add_f32 v[114:115], v[114:115], v[34:35]
  v_pk_add_f32 v[116:117], v[116:117], v[36:37]
  v_pk_add_f32 v[118:119], v[118:119], v[38:39]
  v_cvt_pk_bf16_f32 v48, v104, v105
  v_cvt_pk_bf16_f32 v49, v106, v107
  v_cvt_pk_bf16_f32 v50, v108, v109
  v_cvt_pk_bf16_f32 v51, v110, v111
  s_add_u32 s58, s81, 0
  buffer_store_dwordx4 v[48:51], v16, s[24:27], s58 offen sc1
  v_cvt_pk_bf16_f32 v52, v112, v113
  v_cvt_pk_bf16_f32 v53, v114, v115
  v_cvt_pk_bf16_f32 v54, v116, v117
  v_cvt_pk_bf16_f32 v55, v118, v119
  s_add_u32 s58, s81, 1152
  buffer_store_dwordx4 v[52:55], v16, s[24:27], s58 offen sc1
  v_pk_fma_f32 v[24:25], v[120:121], s[74:75], v[22:23]
  v_pk_fma_f32 v[26:27], v[122:123], s[74:75], v[22:23]
  v_pk_fma_f32 v[28:29], v[124:125], s[74:75], v[22:23]
  v_pk_fma_f32 v[30:31], v[126:127], s[74:75], v[22:23]
  v_pk_fma_f32 v[32:33], v[128:129], s[74:75], v[22:23]
  v_pk_fma_f32 v[34:35], v[130:131], s[74:75], v[22:23]
  v_pk_fma_f32 v[36:37], v[132:133], s[74:75], v[22:23]
  v_pk_fma_f32 v[38:39], v[134:135], s[74:75], v[22:23]
  v_exp_f32_e64 v24, v24 clamp
  v_max_f32 v120, s76, v120
  v_exp_f32_e64 v25, v25 clamp
  v_max_f32 v121, s76, v121
  v_exp_f32_e64 v26, v26 clamp
  v_max_f32 v122, s76, v122
  v_exp_f32_e64 v27, v27 clamp
  v_max_f32 v123, s76, v123
  v_exp_f32_e64 v28, v28 clamp
  v_max_f32 v124, s76, v124
  v_exp_f32_e64 v29, v29 clamp
  v_max_f32 v125, s76, v125
  v_exp_f32_e64 v30, v30 clamp
  v_max_f32 v126, s76, v126
  v_exp_f32_e64 v31, v31 clamp
  v_max_f32 v127, s76, v127
  v_exp_f32_e64 v32, v32 clamp
  v_max_f32 v128, s76, v128
  v_exp_f32_e64 v33, v33 clamp
  v_max_f32 v129, s76, v129
  v_exp_f32_e64 v34, v34 clamp
  v_max_f32 v130, s76, v130
  v_exp_f32_e64 v35, v35 clamp
  v_max_f32 v131, s76, v131
  v_exp_f32_e64 v36, v36 clamp
  v_max_f32 v132, s76, v132
  v_exp_f32_e64 v37, v37 clamp
  v_max_f32 v133, s76, v133
  v_exp_f32_e64 v38, v38 clamp
  v_max_f32 v134, s76, v134
  v_exp_f32_e64 v39, v39 clamp
  v_max_f32 v135, s76, v135
  v_pk_add_f32 v[120:121], v[120:121], v[24:25]
  v_pk_add_f32 v[122:123], v[122:123], v[26:27]
  v_pk_add_f32 v[124:125], v[124:125], v[28:29]
  v_pk_add_f32 v[126:127], v[126:127], v[30:31]
  v_pk_add_f32 v[128:129], v[128:129], v[32:33]
  v_pk_add_f32 v[130:131], v[130:131], v[34:35]
  v_pk_add_f32 v[132:133], v[132:133], v[36:37]
  v_pk_add_f32 v[134:135], v[134:135], v[38:39]
  v_cvt_pk_bf16_f32 v40, v120, v121
  v_cvt_pk_bf16_f32 v41, v122, v123
  v_cvt_pk_bf16_f32 v42, v124, v125
  v_cvt_pk_bf16_f32 v43, v126, v127
  s_add_u32 s58, s81, 73728
  buffer_store_dwordx4 v[40:43], v16, s[24:27], s58 offen sc1
  v_cvt_pk_bf16_f32 v44, v128, v129
  v_cvt_pk_bf16_f32 v45, v130, v131
  v_cvt_pk_bf16_f32 v46, v132, v133
  v_cvt_pk_bf16_f32 v47, v134, v135
  s_add_u32 s58, s81, 74880
  buffer_store_dwordx4 v[44:47], v16, s[24:27], s58 offen sc1
  v_pk_fma_f32 v[24:25], v[136:137], s[74:75], v[22:23]
  v_pk_fma_f32 v[26:27], v[138:139], s[74:75], v[22:23]
  v_pk_fma_f32 v[28:29], v[140:141], s[74:75], v[22:23]
  v_pk_fma_f32 v[30:31], v[142:143], s[74:75], v[22:23]
  v_pk_fma_f32 v[32:33], v[144:145], s[74:75], v[22:23]
  v_pk_fma_f32 v[34:35], v[146:147], s[74:75], v[22:23]
  v_pk_fma_f32 v[36:37], v[148:149], s[74:75], v[22:23]
  v_pk_fma_f32 v[38:39], v[150:151], s[74:75], v[22:23]
  v_exp_f32_e64 v24, v24 clamp
  v_max_f32 v136, s76, v136
  v_exp_f32_e64 v25, v25 clamp
  v_max_f32 v137, s76, v137
  v_exp_f32_e64 v26, v26 clamp
  v_max_f32 v138, s76, v138
  v_exp_f32_e64 v27, v27 clamp
  v_max_f32 v139, s76, v139
  v_exp_f32_e64 v28, v28 clamp
  v_max_f32 v140, s76, v140
  v_exp_f32_e64 v29, v29 clamp
  v_max_f32 v141, s76, v141
  v_exp_f32_e64 v30, v30 clamp
  v_max_f32 v142, s76, v142
  v_exp_f32_e64 v31, v31 clamp
  v_max_f32 v143, s76, v143
  v_exp_f32_e64 v32, v32 clamp
  v_max_f32 v144, s76, v144
  v_exp_f32_e64 v33, v33 clamp
  v_max_f32 v145, s76, v145
  v_exp_f32_e64 v34, v34 clamp
  v_max_f32 v146, s76, v146
  v_exp_f32_e64 v35, v35 clamp
  v_max_f32 v147, s76, v147
  v_exp_f32_e64 v36, v36 clamp
  v_max_f32 v148, s76, v148
  v_exp_f32_e64 v37, v37 clamp
  v_max_f32 v149, s76, v149
  v_exp_f32_e64 v38, v38 clamp
  v_max_f32 v150, s76, v150
  v_exp_f32_e64 v39, v39 clamp
  v_max_f32 v151, s76, v151
  v_pk_add_f32 v[136:137], v[136:137], v[24:25]
  v_pk_add_f32 v[138:139], v[138:139], v[26:27]
  v_pk_add_f32 v[140:141], v[140:141], v[28:29]
  v_pk_add_f32 v[142:143], v[142:143], v[30:31]
  v_pk_add_f32 v[144:145], v[144:145], v[32:33]
  v_pk_add_f32 v[146:147], v[146:147], v[34:35]
  v_pk_add_f32 v[148:149], v[148:149], v[36:37]
  v_pk_add_f32 v[150:151], v[150:151], v[38:39]
  v_cvt_pk_bf16_f32 v48, v136, v137
  v_cvt_pk_bf16_f32 v49, v138, v139
  v_cvt_pk_bf16_f32 v50, v140, v141
  v_cvt_pk_bf16_f32 v51, v142, v143
  s_add_u32 s58, s81, 147456
  buffer_store_dwordx4 v[48:51], v16, s[24:27], s58 offen sc1
  v_cvt_pk_bf16_f32 v52, v144, v145
  v_cvt_pk_bf16_f32 v53, v146, v147
  v_cvt_pk_bf16_f32 v54, v148, v149
  v_cvt_pk_bf16_f32 v55, v150, v151
  s_add_u32 s58, s81, 148608
  buffer_store_dwordx4 v[52:55], v16, s[24:27], s58 offen sc1
  v_pk_fma_f32 v[24:25], v[152:153], s[74:75], v[22:23]
  v_pk_fma_f32 v[26:27], v[154:155], s[74:75], v[22:23]
  v_pk_fma_f32 v[28:29], v[156:157], s[74:75], v[22:23]
  v_pk_fma_f32 v[30:31], v[158:159], s[74:75], v[22:23]
  v_pk_fma_f32 v[32:33], v[160:161], s[74:75], v[22:23]
  v_pk_fma_f32 v[34:35], v[162:163], s[74:75], v[22:23]
  v_pk_fma_f32 v[36:37], v[164:165], s[74:75], v[22:23]
  v_pk_fma_f32 v[38:39], v[166:167], s[74:75], v[22:23]
  v_exp_f32_e64 v24, v24 clamp
  v_max_f32 v152, s76, v152
  v_exp_f32_e64 v25, v25 clamp
  v_max_f32 v153, s76, v153
  v_exp_f32_e64 v26, v26 clamp
  v_max_f32 v154, s76, v154
  v_exp_f32_e64 v27, v27 clamp
  v_max_f32 v155, s76, v155
  v_exp_f32_e64 v28, v28 clamp
  v_max_f32 v156, s76, v156
  v_exp_f32_e64 v29, v29 clamp
  v_max_f32 v157, s76, v157
  v_exp_f32_e64 v30, v30 clamp
  v_max_f32 v158, s76, v158
  v_exp_f32_e64 v31, v31 clamp
  v_max_f32 v159, s76, v159
  v_exp_f32_e64 v32, v32 clamp
  v_max_f32 v160, s76, v160
  v_exp_f32_e64 v33, v33 clamp
  v_max_f32 v161, s76, v161
  v_exp_f32_e64 v34, v34 clamp
  v_max_f32 v162, s76, v162
  v_exp_f32_e64 v35, v35 clamp
  v_max_f32 v163, s76, v163
  v_exp_f32_e64 v36, v36 clamp
  v_max_f32 v164, s76, v164
  v_exp_f32_e64 v37, v37 clamp
  v_max_f32 v165, s76, v165
  v_exp_f32_e64 v38, v38 clamp
  v_max_f32 v166, s76, v166
  v_exp_f32_e64 v39, v39 clamp
  v_max_f32 v167, s76, v167
  v_pk_add_f32 v[152:153], v[152:153], v[24:25]
  v_pk_add_f32 v[154:155], v[154:155], v[26:27]
  v_pk_add_f32 v[156:157], v[156:157], v[28:29]
  v_pk_add_f32 v[158:159], v[158:159], v[30:31]
  v_pk_add_f32 v[160:161], v[160:161], v[32:33]
  v_pk_add_f32 v[162:163], v[162:163], v[34:35]
  v_pk_add_f32 v[164:165], v[164:165], v[36:37]
  v_pk_add_f32 v[166:167], v[166:167], v[38:39]
  v_cvt_pk_bf16_f32 v40, v152, v153
  v_cvt_pk_bf16_f32 v41, v154, v155
  v_cvt_pk_bf16_f32 v42, v156, v157
  v_cvt_pk_bf16_f32 v43, v158, v159
  s_add_u32 s58, s81, 221184
  buffer_store_dwordx4 v[40:43], v16, s[24:27], s58 offen sc1
  v_cvt_pk_bf16_f32 v44, v160, v161
  v_cvt_pk_bf16_f32 v45, v162, v163
  v_cvt_pk_bf16_f32 v46, v164, v165
  v_cvt_pk_bf16_f32 v47, v166, v167
  s_add_u32 s58, s81, 222336
  buffer_store_dwordx4 v[44:47], v16, s[24:27], s58 offen sc1
  s_branch K1_NN_b_done
K1_NN_b_nophi:
  v_cvt_pk_bf16_f32 v40, v88, v89
  v_cvt_pk_bf16_f32 v41, v90, v91
  v_cvt_pk_bf16_f32 v42, v92, v93
  v_cvt_pk_bf16_f32 v43, v94, v95
  s_add_u32 s58, s82, 0
  buffer_store_dwordx4 v[40:43], v17, s[24:27], s58 offen sc1
  v_cvt_pk_bf16_f32 v44, v96, v97
  v_cvt_pk_bf16_f32 v45, v98, v99
  v_cvt_pk_bf16_f32 v46, v100, v101
  v_cvt_pk_bf16_f32 v47, v102, v103
  s_add_u32 s58, s82, 1152
  buffer_store_dwordx4 v[44:47], v17, s[24:27], s58 offen sc1
  v_cvt_pk_bf16_f32 v48, v104, v105
  v_cvt_pk_bf16_f32 v49, v106, v107
  v_cvt_pk_bf16_f32 v50, v108, v109
  v_cvt_pk_bf16_f32 v51, v110, v111
  s_add_u32 s58, s81, 0
  buffer_store_dwordx4 v[48:51], v16, s[24:27], s58 offen sc1
  v_cvt_pk_bf16_f32 v52, v112, v113
  v_cvt_pk_bf16_f32 v53, v114, v115
  v_cvt_pk_bf16_f32 v54, v116, v117
  v_cvt_pk_bf16_f32 v55, v118, v119
  s_add_u32 s58, s81, 1152
  buffer_store_dwordx4 v[52:55], v16, s[24:27], s58 offen sc1
  v_cvt_pk_bf16_f32 v40, v120, v121
  v_cvt_pk_bf16_f32 v41, v122, v123
  v_cvt_pk_bf16_f32 v42, v124, v125
  v_cvt_pk_bf16_f32 v43, v126, v127
  s_add_u32 s58, s81, 73728
  buffer_store_dwordx4 v[40:43], v16, s[24:27], s58 offen sc1
  v_cvt_pk_bf16_f32 v44, v128, v129
  v_cvt_pk_bf16_f32 v45, v130, v131
  v_cvt_pk_bf16_f32 v46, v132, v133
  v_cvt_pk_bf16_f32 v47, v134, v135
  s_add_u32 s58, s81, 74880
  buffer_store_dwordx4 v[44:47], v16, s[24:27], s58 offen sc1
  v_cvt_pk_bf16_f32 v48, v136, v137
  v_cvt_pk_bf16_f32 v49, v138, v139
  v_cvt_pk_bf16_f32 v50, v140, v141
  v_cvt_pk_bf16_f32 v51, v142, v143
  s_add_u32 s58, s81, 147456
  buffer_store_dwordx4 v[48:51], v16, s[24:27], s58 offen sc1
  v_cvt_pk_bf16_f32 v52, v144, v145
  v_cvt_pk_bf16_f32 v53, v146, v147
  v_cvt_pk_bf16_f32 v54, v148, v149
  v_cvt_pk_bf16_f32 v55, v150, v151
  s_add_u32 s58, s81, 148608
  buffer_store_dwordx4 v[52:55], v16, s[24:27], s58 offen sc1
  v_cvt_pk_bf16_f32 v40, v152, v153
  v_cvt_pk_bf16_f32 v41, v154, v155
  v_cvt_pk_bf16_f32 v42, v156, v157
  v_cvt_pk_bf16_f32 v43, v158, v159
  s_add_u32 s58, s81, 221184
  buffer_store_dwordx4 v[40:43], v16, s[24:27], s58 offen sc1
  v_cvt_pk_bf16_f32 v44, v160, v161
  v_cvt_pk_bf16_f32 v45, v162, v163
  v_cvt_pk_bf16_f32 v46, v164, v165
  v_cvt_pk_bf16_f32 v47, v166, v167
  s_add_u32 s58, s81, 222336
  buffer_store_dwordx4 v[44:47], v16, s[24:27], s58 offen sc1
K1_NN_b_done:
  s_nop 1
  s_branch K1_FIN
K1_FIN:
  s_setprio 0
  s_waitcnt vmcnt(0)
  s_barrier
K2_ENTRY:
  s_nop 1
  s_load_dwordx2 s[6:7], s[0:1], 72
  s_load_dwordx2 s[4:5], s[0:1], 56
  v_and_b32 v2, 63, v0
  s_and_b32 s37, s2, 7
  s_lshl_b32 s37, s37, 2
  s_lshr_b32 s38, s2, 3
  s_and_b32 s39, s38, 3
  s_add_u32 s37, s37, s39
  s_lshr_b32 s38, s38, 2
  v_lshlrev_b32 v3, 4, v2
  v_and_b32 v8, 31, v2
  v_lshrrev_b32 v9, 5, v2
  s_lshl_b32 s41, s37, 16
  s_lshr_b32 s44, s37, 1
  s_lshl_b32 s44, s44, 14
  s_and_b32 s45, s37, 1
  s_lshl_b32 s45, s45, 2
  s_add_u32 s44, s44, s45
  s_mul_i32 s48, s37, 73728
  s_and_b32 s39, s36, 3
  s_lshl_b32 s42, s38, 3
  s_lshl_b32 s43, s39, 1
  s_add_u32 s42, s42, s43
  s_lshl_b32 s43, s42, 10
  s_add_u32 s43, s43, s41
  s_lshl_b32 s45, s42, 8
  s_add_u32 s45, s45, s44
  v_lshlrev_b32 v10, 3, v8
  v_min_u32 v14, 17, v8
  v_mul_u32_u24 v16, 18, v9
  v_add_u32 v17, v14, v16
  v_lshlrev_b32 v17, 4, v17
  s_mov_b32 s34, 0x3FFFF
  s_mov_b32 s35, 0x3FFFF
  s_cmp_ge_u32 s36, 8
  s_cbranch_scc1 K2_HELPER
  s_lshr_b32 s40, s36, 2
  s_add_u32 s51, s45, 6291456
  s_waitcnt lgkmcnt(0)
  s_mov_b32 s16, s6
  s_mov_b32 s17, s7
  s_mov_b32 s18, 21889024
  s_mov_b32 s19, 0x00020000
  s_add_u32 s46, s42, s40
  s_lshl_b32 s75, s46, 7
  s_add_u32 s75, s75, 14811136
  v_lshlrev_b32 v4, 2, v2
  v_add_u32 v4, 65536, v4
  v_add_u32 v5, 73728, v17
  s_lshl_b32 s52, s40, 15
  v_add_u32 v11, s52, v3
  s_lshl_b32 s52, s40, 12
  v_add_u32 v12, s52, v4
  s_mul_i32 s52, s40, 36864
  v_add_u32 v13, s52, v5
  v_mov_b32 v166, 0xDDDD
  v_mov_b32 v153, 0x3F80
  v_mov_b32 v159, 0
  v_mov_b32 v165, 0
  v_mov_b32 v15, 0
  v_mov_b32 v14, 0x3F803F80
  v_cmp_eq_u32 vcc, 18, v8
  s_nop 1
  v_cndmask_b32 v15, v15, v14, vcc
  v_cmp_eq_u32 vcc, 28, v8
  s_nop 1
  v_cndmask_b32 v15, v15, v14, vcc
  v_mov_b32 v136, v15
  v_mov_b32 v137, v15
  v_mov_b32 v138, v15
  v_mov_b32 v139, v15
  v_mov_b32 v140, v15
  v_mov_b32 v141, v15
  v_mov_b32 v142, v15
  v_mov_b32 v143, v15
  v_mov_b32 v144, v15
  v_mov_b32 v145, v15
  v_mov_b32 v146, v15
  v_mov_b32 v147, v15
  v_mov_b32 v148, v15
  v_mov_b32 v149, v15
  v_mov_b32 v150, v15
  v_mov_b32 v151, v15
  v_mov_b32 v96, 0
  v_mov_b32 v97, 0
  v_mov_b32 v98, 0
  v_mov_b32 v99, 0
  v_mov_b32 v100, 0
  v_mov_b32 v101, 0
  v_mov_b32 v102, 0
  v_mov_b32 v103, 0
  v_mov_b32 v104, 0
  v_mov_b32 v105, 0
  v_mov_b32 v106, 0
  v_mov_b32 v107, 0
  v_mov_b32 v108, 0
  v_mov_b32 v109, 0
  v_mov_b32 v110, 0
  v_mov_b32 v111, 0
  v_mov_b32 v112, 0
  v_mov_b32 v113, 0
  v_mov_b32 v114, 0
  v_mov_b32 v115, 0
  v_mov_b32 v116, 0
  v_mov_b32 v117, 0
  v_mov_b32 v118, 0
  v_mov_b32 v119, 0
  v_mov_b32 v120, 0
  v_mov_b32 v121, 0
  v_mov_b32 v122, 0
  v_mov_b32 v123, 0
  v_mov_b32 v124, 0
  v_mov_b32 v125, 0
  v_mov_b32 v126, 0
  v_mov_b32 v127, 0
  v_lshrrev_b32 v20, 4, v8
  v_mul_u32_u24 v20, 36864, v20
  v_and_b32 v21, 15, v8
  v_lshl_add_u32 v22, v21, 4, v20
  v_lshl_add_u32 v21, v9, 8, v22
  s_mul_i32 s61, s46, 73728
  s_add_u32 s61, s61, 16777216
  s_lshr_b32 s62, s37, 1
  s_lshl_b32 s62, s62, 10
  s_and_b32 s63, s37, 1
  s_lshl_b32 s63, s63, 9
  s_add_u32 s62, s62, s63
  s_add_u32 s62, s62, s61
  s_lshr_b32 s64, s37, 4
  s_lshl_b32 s64, s64, 10
  s_bfe_u32 s65, s37, 0x20002
  s_lshl_b32 s65, s65, 8
  s_add_u32 s64, s64, s65
  s_and_b32 s65, s37, 3
  s_lshl_b32 s65, s65, 2
  s_add_u32 s64, s64, s65
  s_add_u32 s64, s64, s61
  s_add_u32 s64, s64, 16384
  s_lshr_b32 s66, s36, 2
  s_mul_i32 s66, s66, 6144
  s_and_b32 s52, s37, 7
  s_lshr_b32 s53, s37, 3
  s_mul_i32 s67, s52, 147456
  s_add_u32 s67, s67, 14876672
  s_and_b32 s54, s52, 3
  s_add_u32 s54, s54, 32
  s_mul_i32 s68, s54, 36864
  s_add_u32 s68, s68, s66
  s_add_u32 s68, s68, 14876672
  s_lshl_b32 s71, s54, 5
  s_lshl_b32 s72, s52, 7
  s_lshr_b32 s55, s39, 1
  s_lshr_b32 s56, s52, 2
  s_cmp_eq_u32 s55, s56
  s_cselect_b32 s68, s68, 0x7FF00000
  s_cselect_b32 s71, s71, 0x7FF00000
  s_lshl_b32 s70, s38, 2
  s_add_u32 s70, s70, s53
  s_lshl_b32 s73, s70, 2
  s_add_u32 s73, s73, s39
  s_mul_i32 s69, s73, 36864
  s_add_u32 s69, s69, s66
  s_add_u32 s69, s69, 16777216
  s_lshl_b32 s74, s70, 12
  s_add_u32 s74, s74, 21757952
  s_lshl_b32 s70, s70, 13
  s_add_u32 s70, s70, 21495808
  s_mov_b32 s47, 0
  v_mov_b32 v24, 153536
  s_barrier
  buffer_load_dwordx4 v[154:157], v3, s[16:19], s43 offen offset:0
  buffer_load_dword v158, v10, s[16:19], s51 offen offset:0
  buffer_load_dwordx4 v[160:163], v3, s[16:19], s43 offen offset:1024
  buffer_load_dword v164, v10, s[16:19], s51 offen offset:256
  s_waitcnt vmcnt(0)
  s_barrier
  ds_read_b32 v152, v4
  ds_read_b128 v[128:131], v3
  s_mov_b64 exec, s[34:35]
  ds_read_b128 v[136:139], v13 offset:0
  s_mov_b64 exec, -1
  s_mov_b64 exec, s[34:35]
  ds_read_b128 v[140:143], v13 offset:576
  s_mov_b64 exec, -1
  s_mov_b64 exec, s[34:35]
  ds_read_b128 v[144:147], v13 offset:1152
  s_mov_b64 exec, -1
  s_mov_b64 exec, s[34:35]
  ds_read_b128 v[148:151], v13 offset:1728
  s_mov_b64 exec, -1
  s_waitcnt lgkmcnt(5)
  v_mfma_f32_32x32x4_2b_bf16 v[32:63], v[152:153], v[158:159], 0
  v_mfma_f32_32x32x4_2b_bf16 v[64:95], v[152:153], v[164:165], 0
  s_waitcnt lgkmcnt(4)
  s_nop 15
  v_mfma_f32_32x32x16_bf16 v[32:47], v[128:131], v[154:157], v[32:47]
  v_mfma_f32_32x32x16_bf16 v[64:79], v[128:131], v[160:163], v[64:79]
  ds_read_b32 v152, v12 offset:0
  ds_read_b128 v[128:131], v11 offset:0
  ds_read_b128 v[132:135], v11 offset:1024
  s_nop 7
  v_max3_f32 v18, v32, v33, v34
  v_max3_f32 v19, v35, v36, v37
  v_max3_f32 v18, v38, v39, v18
  v_max3_f32 v19, v40, v41, v19
  v_max3_f32 v18, v42, v43, v18
  v_max3_f32 v19, v44, v45, v19
  v_max3_f32 v18, v46, v47, v18
  v_max_f32 v18, v18, v19
  v_mov_b32 v19, v18
  s_nop 1
  v_permlane32_swap_b32 v18, v19
  v_max_f32 v18, v18, v19
  v_xor_b32 v18, 0x80000000, v18
  v_lshrrev_b32 v159, 16, v18
  s_waitcnt lgkmcnt(2)
  s_nop 0
  v_mfma_f32_32x32x4_2b_bf16 v[32:63], v[152:153], v[158:159], 0
  v_max3_f32 v18, v64, v65, v66
  v_max3_f32 v19, v67, v68, v69
  v_max3_f32 v18, v70, v71, v18
  v_max3_f32 v19, v72, v73, v19
  v_max3_f32 v18, v74, v75, v18
  v_max3_f32 v19, v76, v77, v19
  v_max3_f32 v18, v78, v79, v18
  v_max_f32 v18, v18, v19
  v_mov_b32 v19, v18
  s_nop 1
  v_permlane32_swap_b32 v18, v19
  v_max_f32 v18, v18, v19
  v_xor_b32 v18, 0x80000000, v18
  v_lshrrev_b32 v165, 16, v18
  s_waitcnt lgkmcnt(1)
  s_nop 1
  v_mfma_f32_32x32x16_bf16 v[32:47], v[128:131], v[154:157], v[32:47]
  s_waitcnt lgkmcnt(0)
  v_mfma_f32_32x32x16_bf16 v[48:63], v[132:135], v[154:157], v[48:63]
  v_mov_b32 v88, 0
  v_mov_b32 v89, 0
  v_mov_b32 v90, 0
  v_mov_b32 v91, 0
  v_mov_b32 v92, 0
  v_mov_b32 v93, 0
  v_mov_b32 v94, 0
  v_mov_b32 v95, 0
  s_waitcnt lgkmcnt(0)
.p2align 6
K2_LOOP:
  s_bitcmp1_b32 0xA, s47
  s_cbranch_scc0 K2_NOB1
  s_barrier
K2_NOB1:
  s_setprio 3
  v_exp_f32 v32, v32
  v_exp_f32 v33, v33
  v_smfmac_f32_32x32x32_bf16 v[112:127], v[148:151], v[88:95], v166
  s_mov_b64 exec, s[34:35]
  ds_read_b128 v[148:151], v13 offset:1728
  s_mov_b64 exec, -1
  v_exp_f32 v34, v34
  v_exp_f32 v35, v35
  v_exp_f32 v36, v36
  v_exp_f32 v37, v37
  v_mfma_f32_32x32x4_2b_bf16 v[64:95], v[152:153], v[164:165], 0
  ds_read_b32 v152, v12 offset:256
  v_exp_f32 v38, v38
  v_exp_f32 v39, v39
  v_exp_f32 v40, v40
  v_exp_f32 v41, v41
  v_exp_f32 v42, v42
  v_exp_f32 v43, v43
  v_exp_f32 v44, v44
  v_exp_f32 v45, v45
  s_waitcnt lgkmcnt(4)
  v_smfmac_f32_32x32x32_bf16 v[96:111], v[136:139], v[32:39], v166
  v_exp_f32 v46, v46
  v_exp_f32 v47, v47
  v_exp_f32 v48, v48
  v_exp_f32 v49, v49
  s_nop 2
  v_mfma_f32_32x32x16_bf16 v[64:79], v[128:131], v[160:163], v[64:79]
  ds_read_b128 v[128:131], v11 offset:2048
  v_exp_f32 v50, v50
  v_exp_f32 v51, v51
  v_exp_f32 v52, v52
  v_exp_f32 v53, v53
  s_waitcnt lgkmcnt(4)
  v_smfmac_f32_32x32x32_bf16 v[96:111], v[140:143], v[40:47], v166
  v_exp_f32 v54, v54
  v_exp_f32 v55, v55
  v_exp_f32 v56, v56
  v_exp_f32 v57, v57
  v_mfma_f32_32x32x16_bf16 v[80:95], v[132:135], v[160:163], v[80:95]
  ds_read_b128 v[132:135], v11 offset:3072
  v_exp_f32 v58, v58
  v_exp_f32 v59, v59
  v_exp_f32 v60, v60
  v_exp_f32 v61, v61
  s_waitcnt lgkmcnt(4)
  v_smfmac_f32_32x32x32_bf16 v[96:111], v[144:147], v[48:55], v166
  v_exp_f32 v62, v62
  v_exp_f32 v63, v63
  s_setprio 2
  v_exp_f32 v64, v64
  v_exp_f32 v65, v65
  s_waitcnt lgkmcnt(3)
  v_smfmac_f32_32x32x32_bf16 v[96:111], v[148:151], v[56:63], v166
  v_exp_f32 v66, v66
  v_exp_f32 v67, v67
  v_exp_f32 v68, v68
  v_exp_f32 v69, v69
  s_waitcnt lgkmcnt(2)
  v_mfma_f32_32x32x4_2b_bf16 v[32:63], v[152:153], v[158:159], 0
  v_exp_f32 v70, v70
  v_exp_f32 v71, v71
  v_exp_f32 v72, v72
  v_exp_f32 v73, v73
  v_exp_f32 v74, v74
  v_exp_f32 v75, v75
  v_exp_f32 v76, v76
  v_exp_f32 v77, v77
  v_smfmac_f32_32x32x32_bf16 v[112:127], v[136:139], v[64:71], v166
  s_mov_b64 exec, s[34:35]
  ds_read_b128 v[136:139], v13 offset:2304
  s_mov_b64 exec, -1
  v_exp_f32 v78, v78
  v_exp_f32 v79, v79
  v_exp_f32 v80, v80
  v_exp_f32 v81, v81
  s_waitcnt lgkmcnt(2)
  s_nop 0
  v_mfma_f32_32x32x16_bf16 v[32:47], v[128:131], v[154:157], v[32:47]
  v_exp_f32 v82, v82
  v_exp_f32 v83, v83
  v_exp_f32 v84, v84
  v_exp_f32 v85, v85
  v_smfmac_f32_32x32x32_bf16 v[112:127], v[140:143], v[72:79], v166
  s_mov_b64 exec, s[34:35]
  ds_read_b128 v[140:143], v13 offset:2880
  s_mov_b64 exec, -1
  v_exp_f32 v86, v86
  v_exp_f32 v87, v87
  v_exp_f32 v88, v88
  v_exp_f32 v89, v89
  s_waitcnt lgkmcnt(2)
  v_mfma_f32_32x32x16_bf16 v[48:63], v[132:135], v[154:157], v[48:63]
  v_exp_f32 v90, v90
  v_exp_f32 v91, v91
  v_exp_f32 v92, v92
  v_exp_f32 v93, v93
  v_smfmac_f32_32x32x32_bf16 v[112:127], v[144:147], v[80:87], v166
  s_mov_b64 exec, s[34:35]
  ds_read_b128 v[144:147], v13 offset:3456
  s_mov_b64 exec, -1
  v_exp_f32 v94, v94
  v_exp_f32 v95, v95
  s_setprio 1
  v_exp_f32 v32, v32
  v_exp_f32 v33, v33
  v_smfmac_f32_32x32x32_bf16 v[112:127], v[148:151], v[88:95], v166
  s_mov_b64 exec, s[34:35]
  ds_read_b128 v[148:151], v13 offset:4032
  s_mov_b64 exec, -1
  v_exp_f32 v34, v34
  v_exp_f32 v35, v35
  v_exp_f32 v36, v36
  v_exp_f32 v37, v37
  v_mfma_f32_32x32x4_2b_bf16 v[64:95], v[152:153], v[164:165], 0
  ds_read_b32 v152, v12 offset:512
  v_exp_f32 v38, v38
  v_exp_f32 v39, v39
  v_exp_f32 v40, v40
  v_exp_f32 v41, v41
  v_exp_f32 v42, v42
  v_exp_f32 v43, v43
  v_exp_f32 v44, v44
  v_exp_f32 v45, v45
  s_waitcnt lgkmcnt(4)
  v_smfmac_f32_32x32x32_bf16 v[96:111], v[136:139], v[32:39], v166
  v_exp_f32 v46, v46
  v_exp_f32 v47, v47
  v_exp_f32 v48, v48
  v_exp_f32 v49, v49
  s_nop 2
  v_mfma_f32_32x32x16_bf16 v[64:79], v[128:131], v[160:163], v[64:79]
  ds_read_b128 v[128:131], v11 offset:4096
  v_exp_f32 v50, v50
  v_exp_f32 v51, v51
  v_exp_f32 v52, v52
  v_exp_f32 v53, v53
  s_waitcnt lgkmcnt(4)
  v_smfmac_f32_32x32x32_bf16 v[96:111], v[140:143], v[40:47], v166
  v_exp_f32 v54, v54
  v_exp_f32 v55, v55
  v_exp_f32 v56, v56
  v_exp_f32 v57, v57
  v_mfma_f32_32x32x16_bf16 v[80:95], v[132:135], v[160:163], v[80:95]
  ds_read_b128 v[132:135], v11 offset:5120
  v_exp_f32 v58, v58
  v_exp_f32 v59, v59
  v_exp_f32 v60, v60
  v_exp_f32 v61, v61
  s_waitcnt lgkmcnt(4)
  v_smfmac_f32_32x32x32_bf16 v[96:111], v[144:147], v[48:55], v166
  v_exp_f32 v62, v62
  v_exp_f32 v63, v63
  s_setprio 0
  v_exp_f32 v64, v64
  v_exp_f32 v65, v65
  s_waitcnt lgkmcnt(3)
  v_smfmac_f32_32x32x32_bf16 v[96:111], v[148:151], v[56:63], v166
  v_exp_f32 v66, v66
  v_exp_f32 v67, v67
  v_exp_f32 v68, v68
  v_exp_f32 v69, v69
  s_waitcnt lgkmcnt(2)
  v_mfma_f32_32x32x4_2b_bf16 v[32:63], v[152:153], v[158:159], 0
  v_exp_f32 v70, v70
  v_exp_f32 v71, v71
  v_exp_f32 v72, v72
  v_exp_f32 v73, v73
  v_exp_f32 v74, v74
  v_exp_f32 v75, v75
  v_exp_f32 v76, v76
  v_exp_f32 v77, v77
  v_smfmac_f32_32x32x32_bf16 v[112:127], v[136:139], v[64:71], v166
  s_mov_b64 exec, s[34:35]
  ds_read_b128 v[136:139], v13 offset:4608
  s_mov_b64 exec, -1
  v_exp_f32 v78, v78
  v_exp_f32 v79, v79
  v_exp_f32 v80, v80
  v_exp_f32 v81, v81
  s_waitcnt lgkmcnt(2)
  s_nop 0
  v_mfma_f32_32x32x16_bf16 v[32:47], v[128:131], v[154:157], v[32:47]
  v_exp_f32 v82, v82
  v_exp_f32 v83, v83
  v_exp_f32 v84, v84
  v_exp_f32 v85, v85
  v_smfmac_f32_32x32x32_bf16 v[112:127], v[140:143], v[72:79], v166
  s_mov_b64 exec, s[34:35]
  ds_read_b128 v[140:143], v13 offset:5184
  s_mov_b64 exec, -1
  v_exp_f32 v86, v86
  v_exp_f32 v87, v87
  v_exp_f32 v88, v88
  v_exp_f32 v89, v89
  s_waitcnt lgkmcnt(2)
  v_mfma_f32_32x32x16_bf16 v[48:63], v[132:135], v[154:157], v[48:63]
  v_exp_f32 v90, v90
  v_exp_f32 v91, v91
  v_exp_f32 v92, v92
  v_exp_f32 v93, v93
  v_smfmac_f32_32x32x32_bf16 v[112:127], v[144:147], v[80:87], v166
  s_mov_b64 exec, s[34:35]
  ds_read_b128 v[144:147], v13 offset:5760
  s_mov_b64 exec, -1
  v_exp_f32 v94, v94
  v_exp_f32 v95, v95
  v_add_u32 v11, 4096, v11
  v_add_u32 v12, 512, v12
  v_add_u32 v13, 4608, v13
  s_add_u32 s47, s47, 1
  s_cmp_lg_u32 s47, 8
  s_cbranch_scc1 K2_LOOP
  s_setprio 3
  v_smfmac_f32_32x32x32_bf16 v[112:127], v[148:151], v[88:95], v166
  v_lshlrev_b32 v12, 2, v8
  buffer_load_dword v167, v12, s[16:19], s75 offen
  v_cmp_eq_u32 vcc, 0, v9
  s_nop 1
  v_cndmask_b32 v106, v108, v106, vcc
  s_nop 5
  v_cndmask_b32 v122, v124, v122, vcc
  v_max_f32 v19, v106, v122
  v_fmac_f32 v19, 0, v106
  v_fmac_f32 v19, 0, v122
  v_fmac_f32 v19, 0, v96
  v_fmac_f32 v19, 0, v112
  v_fmac_f32 v19, 0, v97
  v_fmac_f32 v19, 0, v113
  v_fmac_f32 v19, 0, v98
  v_fmac_f32 v19, 0, v114
  v_fmac_f32 v19, 0, v99
  v_fmac_f32 v19, 0, v115
  v_fmac_f32 v19, 0, v100
  v_fmac_f32 v19, 0, v116
  v_fmac_f32 v19, 0, v101
  v_fmac_f32 v19, 0, v117
  v_fmac_f32 v19, 0, v102
  v_fmac_f32 v19, 0, v118
  v_fmac_f32 v19, 0, v103
  v_fmac_f32 v19, 0, v119
  v_fmac_f32 v19, 0, v104
  v_fmac_f32 v19, 0, v120
  v_fmac_f32 v19, 0, v105
  v_fmac_f32 v19, 0, v121
  v_mov_b32 v20, 0x5F000000
  v_cmp_nlt_f32 vcc, v19, v20
  s_nop 0
  s_cmp_eq_u64 vcc, 0
  s_cbranch_scc1 K2_OK
  v_mov_b32 v19, 1
  ds_write_b32 v24, v19
K2_OK:
  s_waitcnt lgkmcnt(0)
  s_barrier
  ds_read_b32 v19, v24
  s_mul_i32 s52, s36, 3072
  s_add_u32 s52, s52, 122880
  s_xor_b32 s53, s36, 4
  s_mul_i32 s53, s53, 3072
  s_add_u32 s53, s53, 122880
  v_add_u32 v25, s52, v3
  v_add_u32 v26, s53, v3
  s_waitcnt lgkmcnt(0)
  v_readfirstlane_b32 s52, v19
  s_nop 0
  s_cmp_lg_u32 s52, 0
  s_cbranch_scc1 K2_SLOW
  s_cmp_eq_u32 s40, 0
  s_cbranch_scc1 K2_X0
  v_swap_b32 v96, v112
  v_swap_b32 v97, v113
  v_swap_b32 v98, v114
  v_swap_b32 v99, v115
  v_swap_b32 v100, v116
  v_swap_b32 v101, v117
  v_swap_b32 v102, v118
  v_swap_b32 v103, v119
  v_swap_b32 v104, v120
  v_swap_b32 v105, v121
  v_swap_b32 v106, v122
K2_X0:
  s_nop 0
  ds_write_b128 v25, v[112:115] offset:0
  ds_write_b128 v25, v[116:119] offset:1024
  ds_write_b128 v25, v[120:123] offset:2048
  s_waitcnt lgkmcnt(0)
  s_barrier
  ds_read_b128 v[120:123], v26 offset:2048
  ds_read_b128 v[112:115], v26 offset:0
  ds_read_b128 v[116:119], v26 offset:1024
  s_waitcnt lgkmcnt(2)
  v_pk_add_f32 v[106:107], v[106:107], v[122:123]
  v_pk_add_f32 v[104:105], v[104:105], v[120:121]
  s_waitcnt lgkmcnt(1)
  v_pk_add_f32 v[96:97], v[96:97], v[112:113]
  v_pk_add_f32 v[98:99], v[98:99], v[114:115]
  s_waitcnt lgkmcnt(0)
  v_pk_add_f32 v[100:101], v[100:101], v[116:117]
  v_pk_add_f32 v[102:103], v[102:103], v[118:119]
K2_EPI:
  s_nop 1
  v_rcp_f32 v18, v106
  s_waitcnt vmcnt(0)
  v_mul_f32 v18, v18, v167
  v_mul_f32 v96, v96, v18
  v_mul_f32 v97, v97, v18
  v_mul_f32 v98, v98, v18
  v_mul_f32 v99, v99, v18
  v_mul_f32 v100, v100, v18
  v_mul_f32 v101, v101, v18
  v_mul_f32 v102, v102, v18
  v_mul_f32 v103, v103, v18
  v_mul_f32 v104, v104, v18
  v_mul_f32 v105, v105, v18
  v_cvt_pk_bf16_f32 v28, v96, v97
  v_cvt_pk_bf16_f32 v29, v98, v99
  v_cvt_pk_bf16_f32 v30, v100, v101
  v_cvt_pk_bf16_f32 v31, v102, v103
  v_cvt_pk_bf16_f32 v104, v104, v105
  v_permlane32_swap_b32 v28, v30
  v_permlane32_swap_b32 v29, v31
  buffer_store_dwordx4 v[28:31], v21, s[16:19], s62 offen sc1
  s_mov_b32 exec_hi, 0
  buffer_store_dword v104, v22, s[16:19], s64 offen sc1
  s_mov_b32 exec_hi, -1
  s_setprio 0
  s_add_u32 s56, s69, 18432
  s_add_u32 s57, s69, 22528
  buffer_load_dwordx4 v[32:35], v3, s[16:19], s56 offen offset:0
  buffer_load_dwordx4 v[36:39], v3, s[16:19], s56 offen offset:1024
  buffer_load_dwordx4 v[40:43], v3, s[16:19], s56 offen offset:2048
  buffer_load_dwordx4 v[44:47], v3, s[16:19], s56 offen offset:3072
  buffer_load_dwordx4 v[48:51], v3, s[16:19], s57 offen offset:0
  buffer_load_dwordx4 v[52:55], v3, s[16:19], s57 offen offset:1024
  s_xor_b32 s45, s36, 4
  s_mul_i32 s45, s45, 3072
  s_add_u32 s52, s45, 86016
  s_add_u32 s55, s45, 104448
  s_cmp_ge_u32 s45, 6144
  s_cselect_b32 s52, s55, s52
  s_add_u32 s52, s52, s67
  s_add_u32 m0, s45, 122880
  s_cmp_ge_u32 s68, 0x7FF00000
  s_cbranch_scc1 K2_NOXB
  s_add_u32 s56, s68, 18432
  s_add_u32 s57, s68, 22528
  buffer_load_dwordx4 v[56:59], v3, s[16:19], s56 offen offset:0
  buffer_load_dwordx4 v[60:63], v3, s[16:19], s56 offen offset:1024
  buffer_load_dwordx4 v[64:67], v3, s[16:19], s56 offen offset:2048
  buffer_load_dwordx4 v[68:71], v3, s[16:19], s56 offen offset:3072
  buffer_load_dwordx4 v[72:75], v3, s[16:19], s57 offen offset:0
  buffer_load_dwordx4 v[76:79], v3, s[16:19], s57 offen offset:1024
K2_NOXB:
  s_barrier
  buffer_load_dwordx4 v3, s[16:19], s52 offen offset:0 lds
  buffer_load_dwordx4 v3, s[16:19], s52 offen offset:1024 lds
  buffer_load_dwordx4 v3, s[16:19], s52 offen offset:2048 lds
  s_branch K2_P3
K2_SLOW:
  s_waitcnt vmcnt(0) lgkmcnt(0)
  s_nop 15
  s_nop 3
  s_cmp_eq_u32 s40, 0
  s_cbranch_scc1 K2_S0
  v_mov_b32 v154, v160
  v_mov_b32 v155, v161
  v_mov_b32 v156, v162
  v_mov_b32 v157, v163
  v_mov_b32 v158, v164
K2_S0:
  v_mov_b32 v159, 0
  v_mov_b32 v20, 0xFF800000
  v_mov_b32 v96, 0
  v_mov_b32 v97, 0
  v_mov_b32 v98, 0
  v_mov_b32 v99, 0
  v_mov_b32 v100, 0
  v_mov_b32 v101, 0
  v_mov_b32 v102, 0
  v_mov_b32 v103, 0
  v_mov_b32 v104, 0
  v_mov_b32 v105, 0
  v_mov_b32 v106, 0
  v_mov_b32 v107, 0
  v_mov_b32 v108, 0
  v_mov_b32 v109, 0
  v_mov_b32 v110, 0
  v_mov_b32 v111, 0
  v_mov_b32 v11, v3
  v_mov_b32 v12, v4
  v_mov_b32 v13, v5
  s_mov_b32 s47, 32
K2_SLOW_LOOP:
  s_waitcnt vmcnt(0) lgkmcnt(0)
  s_nop 15
  s_nop 3
  ds_read_b32 v152, v12 offset:0
  ds_read_b128 v[128:131], v11 offset:0
  ds_read_b128 v[132:135], v11 offset:1024
  s_mov_b64 exec, s[34:35]
  ds_read_b128 v[136:139], v13 offset:0
  s_mov_b64 exec, -1
  s_mov_b64 exec, s[34:35]
  ds_read_b128 v[140:143], v13 offset:576
  s_mov_b64 exec, -1
  s_mov_b64 exec, s[34:35]
  ds_read_b128 v[144:147], v13 offset:1152
  s_mov_b64 exec, -1
  s_mov_b64 exec, s[34:35]
  ds_read_b128 v[148:151], v13 offset:1728
  s_mov_b64 exec, -1
  s_waitcnt lgkmcnt(6)
  v_mfma_f32_32x32x4_2b_bf16 v[32:63], v[152:153], v[158:159], 0
  s_waitcnt lgkmcnt(5)
  s_nop 15
  s_nop 0
  v_mfma_f32_32x32x16_bf16 v[32:47], v[128:131], v[154:157], v[32:47]
  s_waitcnt lgkmcnt(4)
  v_mfma_f32_32x32x16_bf16 v[48:63], v[132:135], v[154:157], v[48:63]
  s_nop 9
  v_max3_f32 v18, v32, v33, v34
  v_max3_f32 v19, v35, v36, v37
  v_max3_f32 v18, v38, v39, v18
  v_max3_f32 v19, v40, v41, v19
  v_max3_f32 v18, v42, v43, v18
  v_max3_f32 v19, v44, v45, v19
  v_max3_f32 v18, v46, v47, v18
  v_max3_f32 v19, v48, v49, v19
  v_max3_f32 v18, v50, v51, v18
  v_max3_f32 v19, v52, v53, v19
  v_max3_f32 v18, v54, v55, v18
  v_max3_f32 v19, v56, v57, v19
  v_max3_f32 v18, v58, v59, v18
  v_max3_f32 v19, v60, v61, v19
  v_max3_f32 v18, v62, v63, v18
  v_max_f32 v18, v18, v19
  v_mov_b32 v19, v18
  s_nop 1
  v_permlane32_swap_b32 v18, v19
  v_max_f32 v18, v18, v19
  v_max_f32 v18, v18, v20
  v_sub_f32 v19, v20, v18
  v_exp_f32 v19, v19
  v_mov_b32 v20, v18
  v_sub_f32 v32, v32, v18
  v_sub_f32 v33, v33, v18
  v_sub_f32 v34, v34, v18
  v_sub_f32 v35, v35, v18
  v_sub_f32 v36, v36, v18
  v_sub_f32 v37, v37, v18
  v_sub_f32 v38, v38, v18
  v_sub_f32 v39, v39, v18
  v_sub_f32 v40, v40, v18
  v_sub_f32 v41, v41, v18
  v_sub_f32 v42, v42, v18
  v_sub_f32 v43, v43, v18
  v_sub_f32 v44, v44, v18
  v_sub_f32 v45, v45, v18
  v_sub_f32 v46, v46, v18
  v_sub_f32 v47, v47, v18
  v_sub_f32 v48, v48, v18
  v_sub_f32 v49, v49, v18
  v_sub_f32 v50, v50, v18
  v_sub_f32 v51, v51, v18
  v_sub_f32 v52, v52, v18
  v_sub_f32 v53, v53, v18
  v_sub_f32 v54, v54, v18
  v_sub_f32 v55, v55, v18
  v_sub_f32 v56, v56, v18
  v_sub_f32 v57, v57, v18
  v_sub_f32 v58, v58, v18
  v_sub_f32 v59, v59, v18
  v_sub_f32 v60, v60, v18
  v_sub_f32 v61, v61, v18
  v_sub_f32 v62, v62, v18
  v_sub_f32 v63, v63, v18
  v_exp_f32 v32, v32
  v_exp_f32 v33, v33
  v_exp_f32 v34, v34
  v_exp_f32 v35, v35
  v_exp_f32 v36, v36
  v_exp_f32 v37, v37
  v_exp_f32 v38, v38
  v_exp_f32 v39, v39
  v_exp_f32 v40, v40
  v_exp_f32 v41, v41
  v_exp_f32 v42, v42
  v_exp_f32 v43, v43
  v_exp_f32 v44, v44
  v_exp_f32 v45, v45
  v_exp_f32 v46, v46
  v_exp_f32 v47, v47
  v_exp_f32 v48, v48
  v_exp_f32 v49, v49
  v_exp_f32 v50, v50
  v_exp_f32 v51, v51
  v_exp_f32 v52, v52
  v_exp_f32 v53, v53
  v_exp_f32 v54, v54
  v_exp_f32 v55, v55
  v_exp_f32 v56, v56
  v_exp_f32 v57, v57
  v_exp_f32 v58, v58
  v_exp_f32 v59, v59
  v_exp_f32 v60, v60
  v_exp_f32 v61, v61
  v_exp_f32 v62, v62
  v_exp_f32 v63, v63
  v_mul_f32 v96, v96, v19
  v_mul_f32 v97, v97, v19
  v_mul_f32 v98, v98, v19
  v_mul_f32 v99, v99, v19
  v_mul_f32 v100, v100, v19
  v_mul_f32 v101, v101, v19
  v_mul_f32 v102, v102, v19
  v_mul_f32 v103, v103, v19
  v_mul_f32 v104, v104, v19
  v_mul_f32 v105, v105, v19
  v_mul_f32 v106, v106, v19
  v_mul_f32 v107, v107, v19
  v_mul_f32 v108, v108, v19
  v_mul_f32 v109, v109, v19
  v_mul_f32 v110, v110, v19
  v_mul_f32 v111, v111, v19
  s_waitcnt lgkmcnt(3)
  s_nop 0
  v_smfmac_f32_32x32x32_bf16 v[96:111], v[136:139], v[32:39], v166
  s_waitcnt lgkmcnt(2)
  v_smfmac_f32_32x32x32_bf16 v[96:111], v[140:143], v[40:47], v166
  s_waitcnt lgkmcnt(1)
  v_smfmac_f32_32x32x32_bf16 v[96:111], v[144:147], v[48:55], v166
  s_waitcnt lgkmcnt(0)
  v_smfmac_f32_32x32x32_bf16 v[96:111], v[148:151], v[56:63], v166
  v_add_u32 v11, 2048, v11
  v_add_u32 v12, 256, v12
  v_add_u32 v13, 2304, v13
  s_sub_u32 s47, s47, 1
  s_cmp_lg_u32 s47, 0
  s_cbranch_scc1 K2_SLOW_LOOP
  s_waitcnt vmcnt(0) lgkmcnt(0)
  s_nop 15
  s_nop 3
  v_cmp_eq_u32 vcc, 0, v9
  s_nop 1
  v_cndmask_b32 v106, v108, v106, vcc
  s_nop 15
  s_nop 3
  s_barrier
  s_branch K2_EPI
K2_HELPER:
  s_setprio 3
  v_lshlrev_b32 v7, 3, v2
  s_lshl_b32 s40, s39, 10
  s_add_u32 s46, s41, s40
  s_add_u32 s46, s46, 2097152
  s_lshl_b32 s47, s39, 9
  s_add_u32 s47, s47, s44
  s_add_u32 s47, s47, 6553600
  s_add_u32 s49, s48, s40
  s_add_u32 s49, s49, 7340032
  s_lshl_b32 s50, s39, 8
  s_waitcnt lgkmcnt(0)
  s_mov_b32 s16, s6
  s_mov_b32 s17, s7
  s_mov_b32 s18, 21889024
  s_mov_b32 s19, 0x00020000
  s_lshr_b32 s52, s37, 1
  s_add_u32 s53, s52, 16
  s_mul_i32 s53, s53, 43
  s_lshr_b32 s54, s53, 8
  s_add_u32 s53, s52, 32
  s_mul_i32 s53, s53, 43
  s_lshr_b32 s55, s53, 8
  s_add_u32 s53, s52, 0
  s_mul_i32 s53, s53, 43
  s_lshr_b32 s56, s53, 8
  v_and_b32 v25, 15, v2
  v_lshlrev_b32 v25, 4, v25
  v_mov_b32 v26, s54
  v_mov_b32 v27, s55
  v_cmp_le_u32 vcc, 16, v2
  s_nop 1
  v_cndmask_b32 v26, v26, v27, vcc
  v_add_u32 v25, v25, v26
  v_and_b32 v26, 1, v2
  s_lshl_b32 s53, s38, 1
  v_add_u32 v26, s53, v26
  v_lshlrev_b32 v26, 4, v26
  s_add_u32 s57, s56, 8
  s_add_u32 s58, s54, 8
  s_add_u32 s59, s55, 8
  v_mov_b32 v27, s56
  v_mov_b32 v28, s57
  v_cmp_le_u32 vcc, 34, v2
  s_nop 1
  v_cndmask_b32 v27, v27, v28, vcc
  v_mov_b32 v28, s58
  v_cmp_le_u32 vcc, 36, v2
  s_nop 1
  v_cndmask_b32 v27, v27, v28, vcc
  v_mov_b32 v28, s59
  v_cmp_le_u32 vcc, 38, v2
  s_nop 1
  v_cndmask_b32 v27, v27, v28, vcc
  v_mov_b32 v28, 0
  v_cmp_le_u32 vcc, 40, v2
  s_nop 1
  v_cndmask_b32 v27, v27, v28, vcc
  v_add_u32 v26, v26, v27
  v_cmp_le_u32 vcc, 32, v2
  s_nop 1
  v_cndmask_b32 v25, v25, v26, vcc
  v_lshlrev_b32 v6, 7, v25
  s_mov_b32 s75, 21495808
  s_mov_b64 s[80:81], -1
  s_cmp_lg_u32 s39, 0
  s_cbranch_scc1 K2_PF1_OK
  s_and_b32 s76, s80, 50529027
  s_and_b32 s77, s81, 3
  s_cmp_eq_u64 s[76:77], 0
  s_cbranch_scc1 K2_PF1_OK
  s_mov_b32 s60, 0
K2_PF1:
  buffer_load_dwordx2 v[26:27], v6, s[16:19], s75 offen sc1
  s_waitcnt vmcnt(0)
  v_cmp_ne_u64 vcc, s[78:79], v[26:27]
  s_nop 0
  s_mov_b64 s[80:81], vcc
  s_and_b32 vcc_lo, vcc_lo, 50529027
  s_and_b32 vcc_hi, vcc_hi, 3
  s_cmp_eq_u64 vcc, 0
  s_cbranch_scc1 K2_PF1_OK
  s_sleep 2
  s_add_u32 s60, s60, 1
  s_cmp_lt_u32 s60, 0x40000
  s_cbranch_scc1 K2_PF1
K2_PF1_OK:
  s_barrier
  s_add_u32 m0, s40, 0
  s_add_u32 s52, s46, 0
  buffer_load_dwordx4 v3, s[16:19], s52 offen lds
  s_add_u32 m0, s50, 65536
  s_add_u32 s52, s47, 0
  buffer_load_dword v7, s[16:19], s52 offen lds
  s_add_u32 m0, s40, 73728
  s_add_u32 s52, s49, 0
  buffer_load_dwordx4 v3, s[16:19], s52 offen lds
  s_add_u32 m0, s40, 32768
  s_add_u32 s52, s46, 32768
  buffer_load_dwordx4 v3, s[16:19], s52 offen lds
  s_add_u32 m0, s50, 69632
  s_add_u32 s52, s47, 8192
  buffer_load_dword v7, s[16:19], s52 offen lds
  s_add_u32 m0, s40, 110592
  s_add_u32 s52, s49, 36864
  buffer_load_dwordx4 v3, s[16:19], s52 offen lds
  s_add_u32 m0, s40, 4096
  s_add_u32 s52, s46, 4096
  buffer_load_dwordx4 v3, s[16:19], s52 offen lds
  s_add_u32 m0, s40, 77824
  s_add_u32 s52, s49, 4096
  buffer_load_dwordx4 v3, s[16:19], s52 offen lds
  s_add_u32 m0, s40, 36864
  s_add_u32 s52, s46, 36864
  buffer_load_dwordx4 v3, s[16:19], s52 offen lds
  s_add_u32 m0, s40, 114688
  s_add_u32 s52, s49, 40960
  buffer_load_dwordx4 v3, s[16:19], s52 offen lds
  v_mov_b32 v15, 0
  v_mov_b32 v24, 153536
  ds_write_b32 v24, v15
  v_mov_b32 v14, 0x3F803F80
  v_cmp_eq_u32 vcc, 18, v8
  s_nop 1
  v_cndmask_b32 v13, v15, v14, vcc
  v_mov_b32 v32, 0
  v_mov_b32 v36, v13
  v_mov_b32 v33, 0
  v_mov_b32 v37, v13
  v_mov_b32 v34, 0
  v_mov_b32 v38, v13
  v_mov_b32 v35, 0
  v_mov_b32 v39, v13
  v_mov_b32 v40, 0
  v_mov_b32 v44, v13
  v_mov_b32 v41, 0
  v_mov_b32 v45, v13
  v_mov_b32 v42, 0
  v_mov_b32 v46, v13
  v_mov_b32 v43, 0
  v_mov_b32 v47, v13
  v_mov_b32 v48, 0
  v_mov_b32 v52, v13
  v_mov_b32 v49, 0
  v_mov_b32 v53, v13
  v_mov_b32 v50, 0
  v_mov_b32 v54, v13
  v_mov_b32 v51, 0
  v_mov_b32 v55, v13
  v_mov_b32 v56, 0
  v_mov_b32 v60, v13
  v_mov_b32 v57, 0
  v_mov_b32 v61, v13
  v_mov_b32 v58, 0
  v_mov_b32 v62, v13
  v_mov_b32 v59, 0
  v_mov_b32 v63, v13
  v_mov_b32 v64, 0
  v_mov_b32 v65, 0
  v_mov_b32 v66, 0
  v_mov_b32 v67, 0
  v_mov_b32 v68, 0
  v_mov_b32 v69, 0
  v_mov_b32 v70, 0
  v_mov_b32 v71, 0
  v_mov_b32 v72, 0
  v_mov_b32 v73, 0
  v_mov_b32 v74, 0
  v_mov_b32 v75, 0
  v_mov_b32 v76, 0
  v_mov_b32 v77, 0
  v_mov_b32 v78, 0
  v_mov_b32 v79, 0
  s_waitcnt vmcnt(0)
  s_waitcnt lgkmcnt(0)
  s_barrier
  s_mul_i32 s61, s42, 1152
  s_add_u32 s61, s61, s48
  s_add_u32 s62, s61, 9699328
  s_add_u32 s63, s61, 12058624
  s_and_b32 s76, s80, 252645135
  s_and_b32 s77, s81, -1
  s_cmp_eq_u64 s[76:77], 0
  s_cbranch_scc1 K2_PF2_OK
  s_mov_b32 s60, 0
K2_PF2:
  buffer_load_dwordx2 v[26:27], v6, s[16:19], s75 offen sc1
  s_waitcnt vmcnt(0)
  v_cmp_ne_u64 vcc, s[78:79], v[26:27]
  s_nop 0
  s_mov_b64 s[80:81], vcc
  s_and_b32 vcc_lo, vcc_lo, 252645135
  s_and_b32 vcc_hi, vcc_hi, -1
  s_cmp_eq_u64 vcc, 0
  s_cbranch_scc1 K2_PF2_OK
  s_sleep 4
  s_add_u32 s60, s60, 1
  s_cmp_lt_u32 s60, 0x40000
  s_cbranch_scc1 K2_PF2
K2_PF2_OK:
  s_add_u32 m0, s40, 8192
  s_add_u32 s52, s46, 8192
  buffer_load_dwordx4 v3, s[16:19], s52 offen lds
  s_add_u32 m0, s40, 81920
  s_add_u32 s52, s49, 8192
  buffer_load_dwordx4 v3, s[16:19], s52 offen lds
  s_add_u32 m0, s50, 66560
  s_add_u32 s52, s47, 2048
  buffer_load_dword v7, s[16:19], s52 offen lds
  s_add_u32 m0, s40, 40960
  s_add_u32 s52, s46, 40960
  buffer_load_dwordx4 v3, s[16:19], s52 offen lds
  s_add_u32 m0, s40, 118784
  s_add_u32 s52, s49, 45056
  buffer_load_dwordx4 v3, s[16:19], s52 offen lds
  s_add_u32 m0, s50, 70656
  s_add_u32 s52, s47, 10240
  buffer_load_dword v7, s[16:19], s52 offen lds
  s_add_u32 m0, s40, 12288
  s_add_u32 s52, s46, 12288
  buffer_load_dwordx4 v3, s[16:19], s52 offen lds
  s_add_u32 m0, s40, 86016
  s_add_u32 s52, s49, 12288
  buffer_load_dwordx4 v3, s[16:19], s52 offen lds
  s_add_u32 m0, s40, 45056
  s_add_u32 s52, s46, 45056
  buffer_load_dwordx4 v3, s[16:19], s52 offen lds
  s_add_u32 m0, s40, 122880
  s_add_u32 s52, s49, 49152
  buffer_load_dwordx4 v3, s[16:19], s52 offen lds
  s_mov_b64 exec, s[34:35]
  buffer_load_dwordx4 v[32:35], v17, s[16:19], s62 offen offset:0
  buffer_load_dwordx4 v[36:39], v17, s[16:19], s63 offen offset:0
  buffer_load_dwordx4 v[40:43], v17, s[16:19], s62 offen offset:576
  buffer_load_dwordx4 v[44:47], v17, s[16:19], s63 offen offset:576
  buffer_load_dwordx4 v[48:51], v17, s[16:19], s62 offen offset:1152
  buffer_load_dwordx4 v[52:55], v17, s[16:19], s63 offen offset:1152
  buffer_load_dwordx4 v[56:59], v17, s[16:19], s62 offen offset:1728
  buffer_load_dwordx4 v[60:63], v17, s[16:19], s63 offen offset:1728
  s_mov_b64 exec, -1
  s_and_b32 s76, s80, -1
  s_and_b32 s77, s81, -1
  s_cmp_eq_u64 s[76:77], 0
  s_cbranch_scc1 K2_PF3_OK
  s_mov_b32 s60, 0
K2_PF3:
  buffer_load_dwordx2 v[26:27], v6, s[16:19], s75 offen sc1
  s_waitcnt vmcnt(0)
  v_cmp_ne_u64 vcc, s[78:79], v[26:27]
  s_nop 0
  s_mov_b64 s[80:81], vcc
  s_and_b32 vcc_lo, vcc_lo, -1
  s_and_b32 vcc_hi, vcc_hi, -1
  s_cmp_eq_u64 vcc, 0
  s_cbranch_scc1 K2_PF3_OK
  s_sleep 4
  s_add_u32 s60, s60, 1
  s_cmp_lt_u32 s60, 0x40000
  s_cbranch_scc1 K2_PF3
K2_PF3_OK:
  s_add_u32 m0, s40, 16384
  s_add_u32 s52, s46, 16384
  buffer_load_dwordx4 v3, s[16:19], s52 offen lds
  s_add_u32 m0, s40, 90112
  s_add_u32 s52, s49, 16384
  buffer_load_dwordx4 v3, s[16:19], s52 offen lds
  s_add_u32 m0, s50, 67584
  s_add_u32 s52, s47, 4096
  buffer_load_dword v7, s[16:19], s52 offen lds
  s_add_u32 m0, s40, 49152
  s_add_u32 s52, s46, 49152
  buffer_load_dwordx4 v3, s[16:19], s52 offen lds
  s_add_u32 m0, s40, 126976
  s_add_u32 s52, s49, 53248
  buffer_load_dwordx4 v3, s[16:19], s52 offen lds
  s_add_u32 m0, s50, 71680
  s_add_u32 s52, s47, 12288
  buffer_load_dword v7, s[16:19], s52 offen lds
  s_waitcnt vmcnt(12)
  v_mfma_f32_32x32x16_bf16 v[64:79], v[32:35], v[36:39], v[64:79]
  s_waitcnt vmcnt(10)
  v_mfma_f32_32x32x16_bf16 v[64:79], v[40:43], v[44:47], v[64:79]
  s_waitcnt vmcnt(8)
  v_mfma_f32_32x32x16_bf16 v[64:79], v[48:51], v[52:55], v[64:79]
  s_waitcnt vmcnt(6)
  v_mfma_f32_32x32x16_bf16 v[64:79], v[56:59], v[60:63], v[64:79]
  v_mul_u32_u24 v18, 80, v8
  v_lshl_add_u32 v18, v9, 4, v18
  s_mul_i32 s61, s39, 1520
  s_add_u32 s61, s61, 147456
  v_add_u32 v18, s61, v18
  s_mov_b32 exec_lo, 0x7FFFF
  s_mov_b32 exec_hi, 0x7FFFF
  s_nop 4
  ds_write_b128 v18, v[64:67]
  ds_write_b128 v18, v[68:71] offset:32
  s_mov_b32 exec_hi, 0
  ds_write_b64 v18, v[72:73] offset:64
  s_mov_b64 exec, -1
  s_waitcnt lgkmcnt(0)
  s_barrier
  s_mul_i32 s57, s37, 12288
  s_add_u32 s57, s57, 16384000
  s_cmp_lg_u32 s39, 0
  s_cbranch_scc1 K2_HPUB
  v_min_u32 v19, 30, v2
  v_lshlrev_b32 v19, 4, v19
  v_add_u32 v19, 1024, v19
  v_add_u32 v18, 147456, v3
  v_add_u32 v20, 147456, v19
  ds_read_b128 v[32:35], v18 offset:0
  ds_read_b128 v[36:39], v20 offset:0
  ds_read_b128 v[40:43], v18 offset:1520
  ds_read_b128 v[44:47], v20 offset:1520
  ds_read_b128 v[48:51], v18 offset:3040
  ds_read_b128 v[52:55], v20 offset:3040
  ds_read_b128 v[56:59], v18 offset:4560
  ds_read_b128 v[60:63], v20 offset:4560
  s_waitcnt lgkmcnt(5)
  v_pk_add_f32 v[32:33], v[32:33], v[40:41]
  v_pk_add_f32 v[34:35], v[34:35], v[42:43]
  s_waitcnt lgkmcnt(4)
  v_pk_add_f32 v[36:37], v[36:37], v[44:45]
  v_pk_add_f32 v[38:39], v[38:39], v[46:47]
  s_waitcnt lgkmcnt(3)
  v_pk_add_f32 v[32:33], v[32:33], v[48:49]
  v_pk_add_f32 v[34:35], v[34:35], v[50:51]
  s_waitcnt lgkmcnt(2)
  v_pk_add_f32 v[36:37], v[36:37], v[52:53]
  v_pk_add_f32 v[38:39], v[38:39], v[54:55]
  s_waitcnt lgkmcnt(1)
  v_pk_add_f32 v[32:33], v[32:33], v[56:57]
  v_pk_add_f32 v[34:35], v[34:35], v[58:59]
  s_waitcnt lgkmcnt(0)
  v_pk_add_f32 v[36:37], v[36:37], v[60:61]
  v_pk_add_f32 v[38:39], v[38:39], v[62:63]
  s_mul_i32 s58, s38, 1536
  s_add_u32 s58, s58, s57
  buffer_store_dwordx4 v[32:35], v3, s[16:19], s58 offen sc1
  buffer_store_dwordx4 v[36:39], v19, s[16:19], s58 offen sc1
  s_waitcnt vmcnt(0)
  v_mov_b32 v18, s78
  v_mov_b32 v19, s79
  v_mov_b32 v20, 1520
  s_mov_b64 exec, 1
  buffer_store_dwordx2 v[18:19], v20, s[16:19], s58 offen sc1
  s_mov_b64 exec, -1
K2_HPUB:
  s_nop 1
  s_add_u32 m0, s40, 20480
  s_add_u32 s52, s46, 20480
  buffer_load_dwordx4 v3, s[16:19], s52 offen lds
  s_add_u32 m0, s40, 94208
  s_add_u32 s52, s49, 20480
  buffer_load_dwordx4 v3, s[16:19], s52 offen lds
  s_add_u32 m0, s40, 53248
  s_add_u32 s52, s46, 53248
  buffer_load_dwordx4 v3, s[16:19], s52 offen lds
  s_add_u32 m0, s40, 131072
  s_add_u32 s52, s49, 57344
  buffer_load_dwordx4 v3, s[16:19], s52 offen lds
  s_add_u32 m0, s40, 24576
  s_add_u32 s52, s46, 24576
  buffer_load_dwordx4 v3, s[16:19], s52 offen lds
  s_add_u32 m0, s40, 98304
  s_add_u32 s52, s49, 24576
  buffer_load_dwordx4 v3, s[16:19], s52 offen lds
  s_add_u32 m0, s50, 68608
  s_add_u32 s52, s47, 6144
  buffer_load_dword v7, s[16:19], s52 offen lds
  s_add_u32 m0, s40, 57344
  s_add_u32 s52, s46, 57344
  buffer_load_dwordx4 v3, s[16:19], s52 offen lds
  s_add_u32 m0, s40, 135168
  s_add_u32 s52, s49, 61440
  buffer_load_dwordx4 v3, s[16:19], s52 offen lds
  s_add_u32 m0, s50, 72704
  s_add_u32 s52, s47, 14336
  buffer_load_dword v7, s[16:19], s52 offen lds
  s_add_u32 m0, s40, 28672
  s_add_u32 s52, s46, 28672
  buffer_load_dwordx4 v3, s[16:19], s52 offen lds
  s_add_u32 m0, s40, 102400
  s_add_u32 s52, s49, 28672
  buffer_load_dwordx4 v3, s[16:19], s52 offen lds
  s_add_u32 m0, s40, 61440
  s_add_u32 s52, s46, 61440
  buffer_load_dwordx4 v3, s[16:19], s52 offen lds
  s_add_u32 m0, s40, 139264
  s_add_u32 s52, s49, 65536
  buffer_load_dwordx4 v3, s[16:19], s52 offen lds
  s_add_u32 m0, s40, 106496
  s_add_u32 s52, s49, 32768
  buffer_load_dwordx4 v3, s[16:19], s52 offen lds
  s_add_u32 m0, s40, 143360
  s_add_u32 s52, s49, 69632
  buffer_load_dwordx4 v3, s[16:19], s52 offen lds
  v_lshrrev_b32 v20, 4, v8
  v_mul_u32_u24 v20, 36864, v20
  v_and_b32 v21, 15, v8
  v_lshl_add_u32 v22, v21, 4, v20
  v_lshl_add_u32 v21, v9, 8, v22
  s_mul_i32 s61, s42, 73728
  s_add_u32 s61, s61, 16777216
  s_lshr_b32 s62, s37, 1
  s_lshl_b32 s62, s62, 10
  s_and_b32 s63, s37, 1
  s_lshl_b32 s63, s63, 9
  s_add_u32 s62, s62, s63
  s_add_u32 s62, s62, s61
  s_lshr_b32 s64, s37, 4
  s_lshl_b32 s64, s64, 10
  s_bfe_u32 s65, s37, 0x20002
  s_lshl_b32 s65, s65, 8
  s_add_u32 s64, s64, s65
  s_and_b32 s65, s37, 3
  s_lshl_b32 s65, s65, 2
  s_add_u32 s64, s64, s65
  s_add_u32 s64, s64, s61
  s_add_u32 s64, s64, 16384
  v_mov_b32 v28, -1
  v_mov_b32 v29, -1
  v_mov_b32 v30, -1
  v_mov_b32 v31, -1
  s_add_u32 s52, s62, 0
  s_add_u32 s53, s64, 0
  buffer_store_dwordx4 v[28:31], v21, s[16:19], s52 offen sc1
  s_mov_b32 exec_hi, 0
  buffer_store_dword v28, v22, s[16:19], s53 offen sc1
  s_mov_b32 exec_hi, -1
  s_add_u32 s52, s62, 73728
  s_add_u32 s53, s64, 73728
  buffer_store_dwordx4 v[28:31], v21, s[16:19], s52 offen sc1
  s_mov_b32 exec_hi, 0
  buffer_store_dword v28, v22, s[16:19], s53 offen sc1
  s_mov_b32 exec_hi, -1
  v_mov_b32 v11, 0x7FF00000
  v_cmp_eq_u32 vcc, 0, v9
  s_nop 1
  v_cndmask_b32 v11, v11, v10, vcc
  v_lshlrev_b32 v12, 2, v8
  s_add_u32 s51, s43, 4194304
  s_add_u32 s52, s45, 6815744
  s_lshl_b32 s53, s42, 7
  s_add_u32 s53, s53, 14811136
  buffer_load_dwordx4 v[96:99], v3, s[16:19], s51 offen offset:0
  buffer_load_dword v100, v11, s[16:19], s52 offen offset:0
  v_mov_b32 v101, 0
  buffer_load_dword v108, v12, s[16:19], s53 offen offset:0
  buffer_load_dwordx4 v[102:105], v3, s[16:19], s51 offen offset:1024
  buffer_load_dword v106, v11, s[16:19], s52 offen offset:256
  v_mov_b32 v107, 0
  buffer_load_dword v109, v12, s[16:19], s53 offen offset:128
  v_min_u32 v18, 18, v8
  v_mul_u32_u24 v19, 80, v18
  v_lshl_add_u32 v18, v9, 5, v19
  v_and_b32 v25, 7, v2
  v_mul_u32_u24 v25, 1536, v25
  v_add_u32 v25, 1520, v25
  s_waitcnt vmcnt(0)
  s_barrier
  s_mov_b32 s60, 0
K2_POLL:
  buffer_load_dwordx2 v[26:27], v25, s[16:19], s57 offen sc1
  s_waitcnt vmcnt(0)
  v_cmp_ne_u64 vcc, s[78:79], v[26:27]
  s_nop 0
  s_cmp_eq_u64 vcc, 0
  s_cbranch_scc1 K2_POLL_OK
  s_sleep 4
  s_add_u32 s60, s60, 1
  s_cmp_lt_u32 s60, 0x40000
  s_cbranch_scc1 K2_POLL
K2_POLL_OK:
  v_min_u32 v20, 30, v2
  v_lshlrev_b32 v20, 4, v20
  v_add_u32 v20, 1024, v20
  s_add_u32 s58, s57, 0
  buffer_load_dwordx4 v[32:35], v3, s[16:19], s58 offen offset:0
  buffer_load_dwordx4 v[36:39], v20, s[16:19], s58 offen offset:0
  buffer_load_dwordx4 v[40:43], v3, s[16:19], s58 offen offset:1536
  buffer_load_dwordx4 v[44:47], v20, s[16:19], s58 offen offset:1536
  s_add_u32 s58, s57, 3072
  buffer_load_dwordx4 v[48:51], v3, s[16:19], s58 offen offset:0
  buffer_load_dwordx4 v[52:55], v20, s[16:19], s58 offen offset:0
  buffer_load_dwordx4 v[56:59], v3, s[16:19], s58 offen offset:1536
  buffer_load_dwordx4 v[60:63], v20, s[16:19], s58 offen offset:1536
  s_add_u32 s58, s57, 6144
  buffer_load_dwordx4 v[64:67], v3, s[16:19], s58 offen offset:0
  buffer_load_dwordx4 v[68:71], v20, s[16:19], s58 offen offset:0
  buffer_load_dwordx4 v[72:75], v3, s[16:19], s58 offen offset:1536
  buffer_load_dwordx4 v[76:79], v20, s[16:19], s58 offen offset:1536
  s_add_u32 s58, s57, 9216
  buffer_load_dwordx4 v[80:83], v3, s[16:19], s58 offen offset:0
  buffer_load_dwordx4 v[84:87], v20, s[16:19], s58 offen offset:0
  buffer_load_dwordx4 v[88:91], v3, s[16:19], s58 offen offset:1536
  buffer_load_dwordx4 v[92:95], v20, s[16:19], s58 offen offset:1536
  s_mul_i32 s58, s39, 1520
  s_add_u32 s58, s58, 147456
  v_add_u32 v25, s58, v3
  v_add_u32 v20, s58, v20
  v_add_u32 v18, s58, v18
  v_add_u32 v19, s58, v19
  s_waitcnt vmcnt(13)
  v_pk_add_f32 v[32:33], v[32:33], v[40:41]
  v_pk_add_f32 v[34:35], v[34:35], v[42:43]
  s_waitcnt vmcnt(12)
  v_pk_add_f32 v[36:37], v[36:37], v[44:45]
  v_pk_add_f32 v[38:39], v[38:39], v[46:47]
  s_waitcnt vmcnt(11)
  v_pk_add_f32 v[32:33], v[32:33], v[48:49]
  v_pk_add_f32 v[34:35], v[34:35], v[50:51]
  s_waitcnt vmcnt(10)
  v_pk_add_f32 v[36:37], v[36:37], v[52:53]
  v_pk_add_f32 v[38:39], v[38:39], v[54:55]
  s_waitcnt vmcnt(9)
  v_pk_add_f32 v[32:33], v[32:33], v[56:57]
  v_pk_add_f32 v[34:35], v[34:35], v[58:59]
  s_waitcnt vmcnt(8)
  v_pk_add_f32 v[36:37], v[36:37], v[60:61]
  v_pk_add_f32 v[38:39], v[38:39], v[62:63]
  s_waitcnt vmcnt(7)
  v_pk_add_f32 v[32:33], v[32:33], v[64:65]
  v_pk_add_f32 v[34:35], v[34:35], v[66:67]
  s_waitcnt vmcnt(6)
  v_pk_add_f32 v[36:37], v[36:37], v[68:69]
  v_pk_add_f32 v[38:39], v[38:39], v[70:71]
  s_waitcnt vmcnt(5)
  v_pk_add_f32 v[32:33], v[32:33], v[72:73]
  v_pk_add_f32 v[34:35], v[34:35], v[74:75]
  s_waitcnt vmcnt(4)
  v_pk_add_f32 v[36:37], v[36:37], v[76:77]
  v_pk_add_f32 v[38:39], v[38:39], v[78:79]
  s_waitcnt vmcnt(3)
  v_pk_add_f32 v[32:33], v[32:33], v[80:81]
  v_pk_add_f32 v[34:35], v[34:35], v[82:83]
  s_waitcnt vmcnt(2)
  v_pk_add_f32 v[36:37], v[36:37], v[84:85]
  v_pk_add_f32 v[38:39], v[38:39], v[86:87]
  s_waitcnt vmcnt(1)
  v_pk_add_f32 v[32:33], v[32:33], v[88:89]
  v_pk_add_f32 v[34:35], v[34:35], v[90:91]
  s_waitcnt vmcnt(0)
  v_pk_add_f32 v[36:37], v[36:37], v[92:93]
  v_pk_add_f32 v[38:39], v[38:39], v[94:95]
  ds_write_b128 v25, v[32:35]
  ds_write_b128 v20, v[36:39]
  s_waitcnt lgkmcnt(0)
  ds_read_b128 v[32:35], v18
  ds_read_b128 v[36:39], v18 offset:16
  ds_read_b64 v[40:41], v19 offset:64
  s_waitcnt lgkmcnt(2)
  v_cvt_pk_bf16_f32 v44, v32, v33
  v_cvt_pk_bf16_f32 v45, v34, v35
  s_waitcnt lgkmcnt(1)
  v_cvt_pk_bf16_f32 v46, v36, v37
  v_cvt_pk_bf16_f32 v47, v38, v39
  s_waitcnt lgkmcnt(0)
  v_cvt_pk_bf16_f32 v48, v40, v41
  v_mov_b32 v49, 0
  v_mfma_f32_32x32x16_bf16 v[64:79], v[44:47], v[96:99], 0
  s_nop 0
  v_mfma_f32_32x32x8bf16_1k v[64:79], v[48:49], v[100:101], v[64:79]
  v_mfma_f32_32x32x16_bf16 v[80:95], v[44:47], v[102:105], 0
  v_mfma_f32_32x32x8bf16_1k v[80:95], v[48:49], v[106:107], v[80:95]
  s_add_u32 s62, s62, 18432
  s_add_u32 s64, s64, 18432
  v_cmp_eq_u32 vcc, 0, v9
  s_nop 6
  v_cndmask_b32 v19, v76, v74, vcc
  v_add_f32 v19, 897988541, v19
  v_rcp_f32 v19, v19
  v_sub_f32 v20, 1.0, v108
  v_mul_f32 v19, v19, v20
  v_mul_f32 v64, v64, v19
  v_mul_f32 v65, v65, v19
  v_mul_f32 v66, v66, v19
  v_mul_f32 v67, v67, v19
  v_mul_f32 v68, v68, v19
  v_mul_f32 v69, v69, v19
  v_mul_f32 v70, v70, v19
  v_mul_f32 v71, v71, v19
  v_mul_f32 v72, v72, v19
  v_mul_f32 v73, v73, v19
  v_cvt_pk_bf16_f32 v28, v64, v65
  v_cvt_pk_bf16_f32 v29, v66, v67
  v_cvt_pk_bf16_f32 v30, v68, v69
  v_cvt_pk_bf16_f32 v31, v70, v71
  v_cvt_pk_bf16_f32 v72, v72, v73
  v_permlane32_swap_b32 v28, v30
  v_permlane32_swap_b32 v29, v31
  buffer_store_dwordx4 v[28:31], v21, s[16:19], s62 offen sc1
  s_mov_b32 exec_hi, 0
  buffer_store_dword v72, v22, s[16:19], s64 offen sc1
  s_mov_b32 exec_hi, -1
  s_add_u32 s62, s62, 73728
  s_add_u32 s64, s64, 73728
  v_cmp_eq_u32 vcc, 0, v9
  s_nop 1
  v_cndmask_b32 v19, v92, v90, vcc
  v_add_f32 v19, 897988541, v19
  v_rcp_f32 v19, v19
  v_sub_f32 v20, 1.0, v109
  v_mul_f32 v19, v19, v20
  v_mul_f32 v80, v80, v19
  v_mul_f32 v81, v81, v19
  v_mul_f32 v82, v82, v19
  v_mul_f32 v83, v83, v19
  v_mul_f32 v84, v84, v19
  v_mul_f32 v85, v85, v19
  v_mul_f32 v86, v86, v19
  v_mul_f32 v87, v87, v19
  v_mul_f32 v88, v88, v19
  v_mul_f32 v89, v89, v19
  v_cvt_pk_bf16_f32 v28, v80, v81
  v_cvt_pk_bf16_f32 v29, v82, v83
  v_cvt_pk_bf16_f32 v30, v84, v85
  v_cvt_pk_bf16_f32 v31, v86, v87
  v_cvt_pk_bf16_f32 v88, v88, v89
  v_permlane32_swap_b32 v28, v30
  v_permlane32_swap_b32 v29, v31
  buffer_store_dwordx4 v[28:31], v21, s[16:19], s62 offen sc1
  s_mov_b32 exec_hi, 0
  buffer_store_dword v88, v22, s[16:19], s64 offen sc1
  s_mov_b32 exec_hi, -1
  s_lshl_b32 s59, s38, 2
  s_add_u32 s59, s59, s39
  s_lshl_b32 s59, s59, 12
  s_add_u32 s59, s59, 21757952
  v_mov_b32 v4, s78
  v_mov_b32 v5, s79
  v_mov_b32 v6, s37
  v_lshlrev_b32 v6, 7, v6
  s_waitcnt vmcnt(0)
  s_mov_b64 exec, 1
  buffer_store_dwordx2 v[4:5], v6, s[16:19], s59 offen sc1
  s_mov_b64 exec, -1
  s_mov_b32 s20, s82
  s_mov_b32 s21, s83
  s_mov_b32 s22, 256
  s_mov_b32 s23, 0x00020000
  v_mov_b32 v25, 8
  s_mov_b32 s60, 0
K2_PW:
  buffer_load_dword v26, v25, s[20:23], 0 offen sc1
  s_waitcnt vmcnt(0)
  v_readfirstlane_b32 s58, v26
  s_nop 0
  s_cmp_ge_u32 s58, 256
  s_cbranch_scc1 K2_PW_OK
  s_sleep 8
  s_add_u32 s60, s60, 1
  s_cmp_lt_u32 s60, 0x40000
  s_cbranch_scc1 K2_PW
K2_PW_OK:
  s_lshr_b32 s66, s36, 2
  s_mul_i32 s66, s66, 6144
  s_and_b32 s52, s37, 7
  s_lshr_b32 s53, s37, 3
  s_mul_i32 s67, s52, 147456
  s_add_u32 s67, s67, 14876672
  s_and_b32 s54, s52, 3
  s_add_u32 s54, s54, 32
  s_mul_i32 s68, s54, 36864
  s_add_u32 s68, s68, s66
  s_add_u32 s68, s68, 14876672
  s_lshl_b32 s71, s54, 5
  s_lshl_b32 s72, s52, 7
  s_lshr_b32 s55, s39, 1
  s_lshr_b32 s56, s52, 2
  s_cmp_eq_u32 s55, s56
  s_cselect_b32 s68, s68, 0x7FF00000
  s_cselect_b32 s71, s71, 0x7FF00000
  s_lshl_b32 s70, s38, 2
  s_add_u32 s70, s70, s53
  s_lshl_b32 s73, s70, 2
  s_add_u32 s73, s73, s39
  s_mul_i32 s69, s73, 36864
  s_add_u32 s69, s69, s66
  s_add_u32 s69, s69, 16777216
  s_lshl_b32 s74, s70, 12
  s_add_u32 s74, s74, 21757952
  s_lshl_b32 s70, s70, 13
  s_add_u32 s70, s70, 21495808
  s_add_u32 s56, s68, 18432
  s_add_u32 s57, s68, 22528
  buffer_load_dwordx4 v[56:59], v3, s[16:19], s56 offen offset:0
  buffer_load_dwordx4 v[60:63], v3, s[16:19], s56 offen offset:1024
  buffer_load_dwordx4 v[64:67], v3, s[16:19], s56 offen offset:2048
  buffer_load_dwordx4 v[68:71], v3, s[16:19], s56 offen offset:3072
  buffer_load_dwordx4 v[72:75], v3, s[16:19], s57 offen offset:0
  buffer_load_dwordx4 v[76:79], v3, s[16:19], s57 offen offset:1024
  s_mul_i32 s45, s39, 36864
  s_add_u32 s45, s45, s67
  s_add_u32 s56, s45, 18432
  s_add_u32 s57, s45, 22528
  buffer_load_dwordx4 v[80:83], v3, s[16:19], s56 offen offset:0
  buffer_load_dwordx4 v[84:87], v3, s[16:19], s56 offen offset:1024
  buffer_load_dwordx4 v[88:91], v3, s[16:19], s56 offen offset:2048
  buffer_load_dwordx4 v[92:95], v3, s[16:19], s56 offen offset:3072
  buffer_load_dwordx4 v[96:99], v3, s[16:19], s57 offen offset:0
  buffer_load_dwordx4 v[100:103], v3, s[16:19], s57 offen offset:1024
  s_add_u32 s56, s45, 24576
  s_add_u32 s57, s45, 28672
  buffer_load_dwordx4 v[104:107], v3, s[16:19], s56 offen offset:0
  buffer_load_dwordx4 v[108:111], v3, s[16:19], s56 offen offset:1024
  buffer_load_dwordx4 v[112:115], v3, s[16:19], s56 offen offset:2048
  buffer_load_dwordx4 v[116:119], v3, s[16:19], s56 offen offset:3072
  buffer_load_dwordx4 v[120:123], v3, s[16:19], s57 offen offset:0
  buffer_load_dwordx4 v[124:127], v3, s[16:19], s57 offen offset:1024
  s_add_u32 s56, s45, 30720
  s_add_u32 s57, s45, 34816
  buffer_load_dwordx4 v[128:131], v3, s[16:19], s56 offen offset:0
  buffer_load_dwordx4 v[132:135], v3, s[16:19], s56 offen offset:1024
  buffer_load_dwordx4 v[136:139], v3, s[16:19], s56 offen offset:2048
  buffer_load_dwordx4 v[140:143], v3, s[16:19], s56 offen offset:3072
  buffer_load_dwordx4 v[144:147], v3, s[16:19], s57 offen offset:0
  buffer_load_dwordx4 v[148:151], v3, s[16:19], s57 offen offset:1024
  s_cmp_eq_u32 s39, 1
  s_mov_b32 s52, 0
  s_cselect_b32 s52, 12288, s52
  s_cmp_eq_u32 s39, 2
  s_cselect_b32 s52, 43008, s52
  s_cmp_eq_u32 s39, 3
  s_cselect_b32 s52, 73728, s52
  s_add_u32 s52, s52, s67
  buffer_load_dwordx4 v[152:155], v3, s[16:19], s52 offen
  s_cmp_eq_u32 s39, 1
  s_mov_b32 s52, 1024
  s_cselect_b32 s52, 13312, s52
  s_cmp_eq_u32 s39, 2
  s_cselect_b32 s52, 44032, s52
  s_cmp_eq_u32 s39, 3
  s_cselect_b32 s52, 74752, s52
  s_add_u32 s52, s52, s67
  buffer_load_dwordx4 v[156:159], v3, s[16:19], s52 offen
  s_cmp_eq_u32 s39, 1
  s_mov_b32 s52, 2048
  s_cselect_b32 s52, 14336, s52
  s_cmp_eq_u32 s39, 2
  s_cselect_b32 s52, 45056, s52
  s_cmp_eq_u32 s39, 3
  s_cselect_b32 s52, 75776, s52
  s_add_u32 s52, s52, s67
  buffer_load_dwordx4 v[160:163], v3, s[16:19], s52 offen
  s_cmp_eq_u32 s39, 1
  s_mov_b32 s52, 3072
  s_cselect_b32 s52, 15360, s52
  s_cmp_eq_u32 s39, 2
  s_cselect_b32 s52, 46080, s52
  s_cmp_eq_u32 s39, 3
  s_cselect_b32 s52, 76800, s52
  s_add_u32 s52, s52, s67
  buffer_load_dwordx4 v[164:167], v3, s[16:19], s52 offen
  s_lshr_b32 s53, s2, 3
  s_lshl_b32 s53, s53, 2
  s_add_u32 s53, s53, s39
  s_mul_i32 s53, s53, 11264
  s_add_u32 s53, s53, 14876672
  buffer_load_dwordx4 v[4:7], v3, s[16:19], s53 offen offset:0
  buffer_load_dwordx4 v[4:7], v3, s[16:19], s53 offen offset:1024
  buffer_load_dwordx4 v[4:7], v3, s[16:19], s53 offen offset:2048
  buffer_load_dwordx4 v[4:7], v3, s[16:19], s53 offen offset:3072
  s_add_u32 s53, s53, 4096
  buffer_load_dwordx4 v[4:7], v3, s[16:19], s53 offen offset:0
  buffer_load_dwordx4 v[4:7], v3, s[16:19], s53 offen offset:1024
  buffer_load_dwordx4 v[4:7], v3, s[16:19], s53 offen offset:2048
  buffer_load_dwordx4 v[4:7], v3, s[16:19], s53 offen offset:3072
  s_add_u32 s53, s53, 4096
  buffer_load_dwordx4 v[4:7], v3, s[16:19], s53 offen offset:0
  buffer_load_dwordx4 v[4:7], v3, s[16:19], s53 offen offset:1024
  buffer_load_dwordx4 v[4:7], v3, s[16:19], s53 offen offset:2048
  v_lshlrev_b32 v30, 7, v8
  s_mov_b32 s60, 0
K2_PB:
  buffer_load_dwordx2 v[26:27], v30, s[16:19], s74 offen sc1
  s_waitcnt vmcnt(0)
  v_cmp_ne_u64 vcc, s[78:79], v[26:27]
  s_nop 0
  s_cmp_eq_u64 vcc, 0
  s_cbranch_scc1 K2_PB_OK
  s_sleep 4
  s_add_u32 s60, s60, 1
  s_cmp_lt_u32 s60, 0x40000
  s_cbranch_scc1 K2_PB
K2_PB_OK:
  s_add_u32 s56, s69, 18432
  s_add_u32 s57, s69, 22528
  buffer_load_dwordx4 v[32:35], v3, s[16:19], s56 offen offset:0
  buffer_load_dwordx4 v[36:39], v3, s[16:19], s56 offen offset:1024
  buffer_load_dwordx4 v[40:43], v3, s[16:19], s56 offen offset:2048
  buffer_load_dwordx4 v[44:47], v3, s[16:19], s56 offen offset:3072
  buffer_load_dwordx4 v[48:51], v3, s[16:19], s57 offen offset:0
  buffer_load_dwordx4 v[52:55], v3, s[16:19], s57 offen offset:1024
  s_add_u32 s56, s69, 6144
  buffer_load_dwordx4 v[4:7], v3, s[16:19], s56 offen offset:0
  buffer_load_dwordx4 v[4:7], v3, s[16:19], s56 offen offset:1024
  buffer_load_dwordx4 v[4:7], v3, s[16:19], s56 offen offset:2048
  buffer_load_dwordx4 v[4:7], v3, s[16:19], s56 offen offset:3072
  s_add_u32 s56, s69, 10240
  buffer_load_dwordx4 v[4:7], v3, s[16:19], s56 offen offset:0
  buffer_load_dwordx4 v[4:7], v3, s[16:19], s56 offen offset:1024
  buffer_load_dwordx4 v[4:7], v3, s[16:19], s56 offen offset:2048
  buffer_load_dwordx4 v[4:7], v3, s[16:19], s56 offen offset:3072
  s_add_u32 s56, s69, 14336
  buffer_load_dwordx4 v[4:7], v3, s[16:19], s56 offen offset:0
  buffer_load_dwordx4 v[4:7], v3, s[16:19], s56 offen offset:1024
  buffer_load_dwordx4 v[4:7], v3, s[16:19], s56 offen offset:2048
  buffer_load_dwordx4 v[4:7], v3, s[16:19], s56 offen offset:3072
  s_cmp_eq_u32 s39, 1
  s_mov_b32 s52, 4096
  s_cselect_b32 s52, 16384, s52
  s_cmp_eq_u32 s39, 2
  s_cselect_b32 s52, 47104, s52
  s_cmp_eq_u32 s39, 3
  s_cselect_b32 s52, 77824, s52
  s_add_u32 s52, s52, s67
  buffer_load_dwordx4 v[8:11], v3, s[16:19], s52 offen
  s_cmp_eq_u32 s39, 1
  s_mov_b32 s52, 5120
  s_cselect_b32 s52, 17408, s52
  s_cmp_eq_u32 s39, 2
  s_cselect_b32 s52, 48128, s52
  s_cmp_eq_u32 s39, 3
  s_cselect_b32 s52, 78848, s52
  s_add_u32 s52, s52, s67
  buffer_load_dwordx4 v[12:15], v3, s[16:19], s52 offen
  s_cmp_eq_u32 s39, 1
  s_mov_b32 s52, 6144
  s_cselect_b32 s52, 36864, s52
  s_cmp_eq_u32 s39, 2
  s_cselect_b32 s52, 49152, s52
  s_cmp_eq_u32 s39, 3
  s_cselect_b32 s52, 79872, s52
  s_add_u32 s52, s52, s67
  buffer_load_dwordx4 v[16:19], v3, s[16:19], s52 offen
  s_cmp_eq_u32 s39, 1
  s_mov_b32 s52, 7168
  s_cselect_b32 s52, 37888, s52
  s_cmp_eq_u32 s39, 2
  s_cselect_b32 s52, 50176, s52
  s_cmp_eq_u32 s39, 3
  s_cselect_b32 s52, 80896, s52
  s_add_u32 s52, s52, s67
  buffer_load_dwordx4 v[20:23], v3, s[16:19], s52 offen
  s_cmp_eq_u32 s39, 1
  s_mov_b32 s52, 8192
  s_cselect_b32 s52, 38912, s52
  s_cmp_eq_u32 s39, 2
  s_cselect_b32 s52, 51200, s52
  s_cmp_eq_u32 s39, 3
  s_cselect_b32 s52, 81920, s52
  s_add_u32 s52, s52, s67
  buffer_load_dwordx4 v[24:27], v3, s[16:19], s52 offen
  s_mul_i32 s45, s39, 18432
  v_add_u32 v29, s45, v3
  s_mul_i32 s45, s39, 12288
  s_add_u32 s45, s45, 73728
  v_add_u32 v28, s45, v3
  s_waitcnt vmcnt(0)
  s_setprio 0
  s_barrier
  s_barrier
  ds_write_b128 v29, v[80:83] offset:0
  ds_write_b128 v29, v[84:87] offset:1024
  ds_write_b128 v29, v[88:91] offset:2048
  ds_write_b128 v29, v[92:95] offset:3072
  ds_write_b128 v29, v[96:99] offset:4096
  ds_write_b128 v29, v[100:103] offset:5120
  ds_write_b128 v29, v[104:107] offset:6144
  ds_write_b128 v29, v[108:111] offset:7168
  ds_write_b128 v29, v[112:115] offset:8192
  ds_write_b128 v29, v[116:119] offset:9216
  ds_write_b128 v29, v[120:123] offset:10240
  ds_write_b128 v29, v[124:127] offset:11264
  ds_write_b128 v29, v[128:131] offset:12288
  ds_write_b128 v29, v[132:135] offset:13312
  ds_write_b128 v29, v[136:139] offset:14336
  s_waitcnt lgkmcnt(14)
  ds_write_b128 v29, v[140:143] offset:15360
  s_waitcnt lgkmcnt(14)
  ds_write_b128 v29, v[144:147] offset:16384
  s_waitcnt lgkmcnt(14)
  ds_write_b128 v29, v[148:151] offset:17408
  s_waitcnt lgkmcnt(0)
  s_barrier
  ds_write_b128 v28, v[152:155] offset:0
  ds_write_b128 v28, v[156:159] offset:1024
  ds_write_b128 v28, v[160:163] offset:2048
  ds_write_b128 v28, v[164:167] offset:3072
  ds_write_b128 v28, v[8:11] offset:4096
  ds_write_b128 v28, v[12:15] offset:5120
  ds_write_b128 v28, v[16:19] offset:6144
  ds_write_b128 v28, v[20:23] offset:7168
  ds_write_b128 v28, v[24:27] offset:8192
  s_add_u32 m0, s45, 9216
  s_cmp_eq_u32 s39, 1
  s_mov_b32 s52, 9216
  s_cselect_b32 s52, 39936, s52
  s_cmp_eq_u32 s39, 2
  s_cselect_b32 s52, 52224, s52
  s_cmp_eq_u32 s39, 3
  s_cselect_b32 s52, 82944, s52
  s_add_u32 s52, s52, s67
  buffer_load_dwordx4 v3, s[16:19], s52 offen lds
  s_add_u32 m0, s45, 10240
  s_cmp_eq_u32 s39, 1
  s_mov_b32 s52, 10240
  s_cselect_b32 s52, 40960, s52
  s_cmp_eq_u32 s39, 2
  s_cselect_b32 s52, 53248, s52
  s_cmp_eq_u32 s39, 3
  s_cselect_b32 s52, 83968, s52
  s_add_u32 s52, s52, s67
  buffer_load_dwordx4 v3, s[16:19], s52 offen lds
  s_add_u32 m0, s45, 11264
  s_cmp_eq_u32 s39, 1
  s_mov_b32 s52, 11264
  s_cselect_b32 s52, 41984, s52
  s_cmp_eq_u32 s39, 2
  s_cselect_b32 s52, 54272, s52
  s_cmp_eq_u32 s39, 3
  s_cselect_b32 s52, 84992, s52
  s_add_u32 s52, s52, s67
  buffer_load_dwordx4 v3, s[16:19], s52 offen lds
  s_waitcnt lgkmcnt(0)
K2_P3:
  s_nop 1
  s_cmp_ge_u32 s68, 0x7FF00000
  s_cbranch_scc1 K2_P3_4
  v_add_u32 v6, s66, v3
  v_add_u32 v7, 73728, v6
  ds_read_b128 v[128:131], v6 offset:0
  ds_read_b128 v[132:135], v6 offset:18432
  ds_read_b128 v[136:139], v6 offset:36864
  ds_read_b128 v[140:143], v6 offset:55296
  ds_read_b128 v[144:147], v6 offset:1024
  ds_read_b128 v[148:151], v6 offset:19456
  ds_read_b128 v[152:155], v6 offset:37888
  ds_read_b128 v[156:159], v6 offset:56320
  s_add_u32 s56, s68, 4096
  s_add_u32 s57, s69, 4096
  s_waitcnt vmcnt(14) lgkmcnt(7)
  v_mfma_f32_16x16x32_bf16 v[8:11], v[128:131], v[32:35], 0
  s_waitcnt lgkmcnt(6)
  v_mfma_f32_16x16x32_bf16 v[12:15], v[132:135], v[32:35], 0
  s_waitcnt lgkmcnt(5)
  v_mfma_f32_16x16x32_bf16 v[16:19], v[136:139], v[32:35], 0
  s_waitcnt lgkmcnt(4)
  v_mfma_f32_16x16x32_bf16 v[20:23], v[140:143], v[32:35], 0
  s_waitcnt vmcnt(8)
  v_mfma_f32_16x16x32_bf16 v[24:27], v[56:59], v[32:35], 0
  ds_read_b128 v[128:131], v6 offset:2048
  ds_read_b128 v[132:135], v6 offset:20480
  ds_read_b128 v[136:139], v6 offset:38912
  ds_read_b128 v[140:143], v6 offset:57344
  buffer_load_dwordx4 v[104:107], v3, s[16:19], s68 offen offset:0
  buffer_load_dwordx4 v[108:111], v3, s[16:19], s68 offen offset:1024
  buffer_load_dwordx4 v[112:115], v3, s[16:19], s68 offen offset:2048
  s_waitcnt lgkmcnt(7)
  v_mfma_f32_16x16x32_bf16 v[8:11], v[144:147], v[36:39], v[8:11]
  s_waitcnt lgkmcnt(6)
  v_mfma_f32_16x16x32_bf16 v[12:15], v[148:151], v[36:39], v[12:15]
  s_waitcnt lgkmcnt(5)
  v_mfma_f32_16x16x32_bf16 v[16:19], v[152:155], v[36:39], v[16:19]
  s_waitcnt lgkmcnt(4)
  v_mfma_f32_16x16x32_bf16 v[20:23], v[156:159], v[36:39], v[20:23]
  s_waitcnt vmcnt(10)
  v_mfma_f32_16x16x32_bf16 v[24:27], v[60:63], v[36:39], v[24:27]
  ds_read_b128 v[144:147], v6 offset:3072
  ds_read_b128 v[148:151], v6 offset:21504
  ds_read_b128 v[152:155], v6 offset:39936
  ds_read_b128 v[156:159], v6 offset:58368
  buffer_load_dwordx4 v[116:119], v3, s[16:19], s68 offen offset:3072
  buffer_load_dwordx4 v[120:123], v3, s[16:19], s56 offen offset:0
  buffer_load_dwordx4 v[124:127], v3, s[16:19], s56 offen offset:1024
  s_waitcnt lgkmcnt(7)
  v_mfma_f32_16x16x32_bf16 v[8:11], v[128:131], v[40:43], v[8:11]
  s_waitcnt lgkmcnt(6)
  v_mfma_f32_16x16x32_bf16 v[12:15], v[132:135], v[40:43], v[12:15]
  s_waitcnt lgkmcnt(5)
  v_mfma_f32_16x16x32_bf16 v[16:19], v[136:139], v[40:43], v[16:19]
  s_waitcnt lgkmcnt(4)
  v_mfma_f32_16x16x32_bf16 v[20:23], v[140:143], v[40:43], v[20:23]
  s_waitcnt vmcnt(12)
  v_mfma_f32_16x16x32_bf16 v[24:27], v[64:67], v[40:43], v[24:27]
  ds_read_b128 v[128:131], v6 offset:4096
  ds_read_b128 v[132:135], v6 offset:22528
  ds_read_b128 v[136:139], v6 offset:40960
  ds_read_b128 v[140:143], v6 offset:59392
  s_waitcnt lgkmcnt(7)
  v_mfma_f32_16x16x32_bf16 v[8:11], v[144:147], v[44:47], v[8:11]
  s_waitcnt lgkmcnt(6)
  v_mfma_f32_16x16x32_bf16 v[12:15], v[148:151], v[44:47], v[12:15]
  s_waitcnt lgkmcnt(5)
  v_mfma_f32_16x16x32_bf16 v[16:19], v[152:155], v[44:47], v[16:19]
  s_waitcnt lgkmcnt(4)
  v_mfma_f32_16x16x32_bf16 v[20:23], v[156:159], v[44:47], v[20:23]
  s_waitcnt vmcnt(11)
  v_mfma_f32_16x16x32_bf16 v[24:27], v[68:71], v[44:47], v[24:27]
  ds_read_b128 v[144:147], v6 offset:5120
  ds_read_b128 v[148:151], v6 offset:23552
  ds_read_b128 v[152:155], v6 offset:41984
  ds_read_b128 v[156:159], v6 offset:60416
  buffer_load_dwordx4 v[80:83], v3, s[16:19], s69 offen offset:0
  buffer_load_dwordx4 v[84:87], v3, s[16:19], s69 offen offset:1024
  s_waitcnt lgkmcnt(7)
  v_mfma_f32_16x16x32_bf16 v[8:11], v[128:131], v[48:51], v[8:11]
  s_waitcnt lgkmcnt(6)
  v_mfma_f32_16x16x32_bf16 v[12:15], v[132:135], v[48:51], v[12:15]
  s_waitcnt lgkmcnt(5)
  v_mfma_f32_16x16x32_bf16 v[16:19], v[136:139], v[48:51], v[16:19]
  s_waitcnt lgkmcnt(4)
  v_mfma_f32_16x16x32_bf16 v[20:23], v[140:143], v[48:51], v[20:23]
  s_waitcnt vmcnt(12)
  v_mfma_f32_16x16x32_bf16 v[24:27], v[72:75], v[48:51], v[24:27]
  buffer_load_dwordx4 v[88:91], v3, s[16:19], s69 offen offset:2048
  buffer_load_dwordx4 v[92:95], v3, s[16:19], s69 offen offset:3072
  s_waitcnt lgkmcnt(3)
  v_mfma_f32_16x16x32_bf16 v[8:11], v[144:147], v[52:55], v[8:11]
  s_waitcnt lgkmcnt(2)
  v_mfma_f32_16x16x32_bf16 v[12:15], v[148:151], v[52:55], v[12:15]
  s_waitcnt lgkmcnt(1)
  v_mfma_f32_16x16x32_bf16 v[16:19], v[152:155], v[52:55], v[16:19]
  s_waitcnt lgkmcnt(0)
  v_mfma_f32_16x16x32_bf16 v[20:23], v[156:159], v[52:55], v[20:23]
  s_waitcnt vmcnt(13)
  v_mfma_f32_16x16x32_bf16 v[24:27], v[76:79], v[52:55], v[24:27]
  buffer_load_dwordx4 v[96:99], v3, s[16:19], s57 offen offset:0
  buffer_load_dwordx4 v[100:103], v3, s[16:19], s57 offen offset:1024
  s_mov_b32 s20, s4
  s_mov_b32 s21, s5
  s_mov_b32 s22, 2359296
  s_mov_b32 s23, 0x00020000
  v_and_b32 v5, 15, v2
  v_lshrrev_b32 v31, 4, v2
  s_lshl_b32 s58, s73, 4
  v_add_u32 v5, s58, v5
  v_mul_u32_u24 v5, 1152, v5
  v_lshl_add_u32 v28, v31, 3, v5
  v_and_b32 v29, 1, v31
  v_lshl_add_u32 v5, v29, 5, v5
  v_lshrrev_b32 v29, 1, v31
  v_lshl_add_u32 v29, v29, 4, v5
  s_mov_b32 s60, 0
  s_waitcnt vmcnt(0)
  s_barrier
  ds_read_b128 v[128:131], v7 offset:0
  ds_read_b128 v[132:135], v7 offset:18432
  ds_read_b128 v[136:139], v7 offset:36864
  ds_read_b128 v[140:143], v7 offset:55296
  ds_read_b128 v[144:147], v7 offset:1024
  ds_read_b128 v[148:151], v7 offset:19456
  ds_read_b128 v[152:155], v7 offset:37888
  ds_read_b128 v[156:159], v7 offset:56320
  s_branch K2_P3CHK5
K2_P3RETRY5:
  s_add_u32 s56, s69, 0
  s_add_u32 s57, s69, 4096
  buffer_load_dwordx4 v[80:83], v3, s[16:19], s56 offen offset:0 sc1
  buffer_load_dwordx4 v[84:87], v3, s[16:19], s56 offen offset:1024 sc1
  buffer_load_dwordx4 v[88:91], v3, s[16:19], s56 offen offset:2048 sc1
  buffer_load_dwordx4 v[92:95], v3, s[16:19], s56 offen offset:3072 sc1
  buffer_load_dwordx4 v[96:99], v3, s[16:19], s57 offen offset:0 sc1
  buffer_load_dwordx4 v[100:103], v3, s[16:19], s57 offen offset:1024 sc1
  s_waitcnt vmcnt(0)
K2_P3CHK5:
  v_max3_u32 v31, v80, v81, v82
  v_max3_u32 v5, v83, v84, v85
  v_max3_u32 v31, v86, v87, v31
  v_max3_u32 v5, v88, v89, v5
  v_max3_u32 v31, v90, v91, v31
  v_max3_u32 v5, v92, v93, v5
  v_max3_u32 v31, v94, v95, v31
  v_max3_u32 v5, v96, v97, v5
  v_max3_u32 v31, v98, v99, v31
  v_max3_u32 v5, v100, v101, v5
  v_max3_u32 v31, v102, v103, v31
  v_max_u32 v31, v31, v5
  v_cmp_eq_u32 vcc, -1, v31
  s_add_u32 s60, s60, 1
  s_cmp_lt_u32 s60, 0x2000
  s_cselect_b64 s[76:77], -1, 0
  s_and_b64 vcc, vcc, s[76:77]
  s_cbranch_scc1 K2_P3RETRY5
  s_mul_i32 s58, s36, 5120
  v_add_u32 v6, s58, v3
  s_waitcnt lgkmcnt(7)
  v_mfma_f32_16x16x32_bf16 v[8:11], v[128:131], v[80:83], v[8:11]
  s_waitcnt lgkmcnt(6)
  v_mfma_f32_16x16x32_bf16 v[12:15], v[132:135], v[80:83], v[12:15]
  s_waitcnt lgkmcnt(5)
  v_mfma_f32_16x16x32_bf16 v[16:19], v[136:139], v[80:83], v[16:19]
  s_waitcnt lgkmcnt(4)
  v_mfma_f32_16x16x32_bf16 v[20:23], v[140:143], v[80:83], v[20:23]
  v_mfma_f32_16x16x32_bf16 v[24:27], v[104:107], v[80:83], v[24:27]
  ds_read_b128 v[128:131], v7 offset:2048
  ds_read_b128 v[132:135], v7 offset:20480
  ds_read_b128 v[136:139], v7 offset:38912
  ds_read_b128 v[140:143], v7 offset:57344
  s_waitcnt lgkmcnt(7)
  v_mfma_f32_16x16x32_bf16 v[8:11], v[144:147], v[84:87], v[8:11]
  s_waitcnt lgkmcnt(6)
  v_mfma_f32_16x16x32_bf16 v[12:15], v[148:151], v[84:87], v[12:15]
  s_waitcnt lgkmcnt(5)
  v_mfma_f32_16x16x32_bf16 v[16:19], v[152:155], v[84:87], v[16:19]
  s_waitcnt lgkmcnt(4)
  v_mfma_f32_16x16x32_bf16 v[20:23], v[156:159], v[84:87], v[20:23]
  v_mfma_f32_16x16x32_bf16 v[24:27], v[108:111], v[84:87], v[24:27]
  ds_read_b128 v[144:147], v7 offset:3072
  ds_read_b128 v[148:151], v7 offset:21504
  ds_read_b128 v[152:155], v7 offset:39936
  ds_read_b128 v[156:159], v7 offset:58368
  s_waitcnt lgkmcnt(7)
  v_mfma_f32_16x16x32_bf16 v[8:11], v[128:131], v[88:91], v[8:11]
  s_waitcnt lgkmcnt(6)
  v_mfma_f32_16x16x32_bf16 v[12:15], v[132:135], v[88:91], v[12:15]
  s_waitcnt lgkmcnt(5)
  v_mfma_f32_16x16x32_bf16 v[16:19], v[136:139], v[88:91], v[16:19]
  s_waitcnt lgkmcnt(4)
  v_mfma_f32_16x16x32_bf16 v[20:23], v[140:143], v[88:91], v[20:23]
  v_mfma_f32_16x16x32_bf16 v[24:27], v[112:115], v[88:91], v[24:27]
  ds_read_b128 v[128:131], v7 offset:4096
  ds_read_b128 v[132:135], v7 offset:22528
  ds_read_b128 v[136:139], v7 offset:40960
  ds_read_b128 v[140:143], v7 offset:59392
  s_waitcnt lgkmcnt(7)
  v_mfma_f32_16x16x32_bf16 v[8:11], v[144:147], v[92:95], v[8:11]
  s_waitcnt lgkmcnt(6)
  v_mfma_f32_16x16x32_bf16 v[12:15], v[148:151], v[92:95], v[12:15]
  s_waitcnt lgkmcnt(5)
  v_mfma_f32_16x16x32_bf16 v[16:19], v[152:155], v[92:95], v[16:19]
  s_waitcnt lgkmcnt(4)
  v_mfma_f32_16x16x32_bf16 v[20:23], v[156:159], v[92:95], v[20:23]
  v_mfma_f32_16x16x32_bf16 v[24:27], v[116:119], v[92:95], v[24:27]
  ds_read_b128 v[144:147], v7 offset:5120
  ds_read_b128 v[148:151], v7 offset:23552
  ds_read_b128 v[152:155], v7 offset:41984
  ds_read_b128 v[156:159], v7 offset:60416
  s_waitcnt lgkmcnt(7)
  v_mfma_f32_16x16x32_bf16 v[8:11], v[128:131], v[96:99], v[8:11]
  s_waitcnt lgkmcnt(6)
  v_mfma_f32_16x16x32_bf16 v[12:15], v[132:135], v[96:99], v[12:15]
  s_waitcnt lgkmcnt(5)
  v_mfma_f32_16x16x32_bf16 v[16:19], v[136:139], v[96:99], v[16:19]
  s_waitcnt lgkmcnt(4)
  v_mfma_f32_16x16x32_bf16 v[20:23], v[140:143], v[96:99], v[20:23]
  v_mfma_f32_16x16x32_bf16 v[24:27], v[120:123], v[96:99], v[24:27]
  s_waitcnt lgkmcnt(3)
  v_mfma_f32_16x16x32_bf16 v[8:11], v[144:147], v[100:103], v[8:11]
  s_waitcnt lgkmcnt(2)
  v_mfma_f32_16x16x32_bf16 v[12:15], v[148:151], v[100:103], v[12:15]
  s_waitcnt lgkmcnt(1)
  v_mfma_f32_16x16x32_bf16 v[16:19], v[152:155], v[100:103], v[16:19]
  s_waitcnt lgkmcnt(0)
  v_mfma_f32_16x16x32_bf16 v[20:23], v[156:159], v[100:103], v[20:23]
  v_mfma_f32_16x16x32_bf16 v[24:27], v[124:127], v[100:103], v[24:27]
  s_cmp_eq_u32 s66, 0
  s_cbranch_scc1 K2_P3R5
  ds_write_b128 v6, v[8:11] offset:0
  ds_write_b128 v6, v[12:15] offset:1024
  s_nop 0
  ds_write_b128 v6, v[16:19] offset:2048
  s_nop 0
  ds_write_b128 v6, v[20:23] offset:3072
  ds_write_b128 v6, v[24:27] offset:4096
  s_waitcnt lgkmcnt(0)
  s_barrier
  s_branch K2_FIN
K2_P3R5:
  s_barrier
  ds_read_b128 v[32:35], v6 offset:20480
  ds_read_b128 v[36:39], v6 offset:21504
  ds_read_b128 v[40:43], v6 offset:22528
  ds_read_b128 v[44:47], v6 offset:23552
  ds_read_b128 v[48:51], v6 offset:24576
  ds_read_b128 v[52:55], v6 offset:40960
  ds_read_b128 v[56:59], v6 offset:41984
  ds_read_b128 v[60:63], v6 offset:43008
  ds_read_b128 v[64:67], v6 offset:44032
  ds_read_b128 v[68:71], v6 offset:45056
  s_waitcnt lgkmcnt(9)
  v_pk_add_f32 v[8:9], v[8:9], v[32:33]
  v_pk_add_f32 v[10:11], v[10:11], v[34:35]
  s_waitcnt lgkmcnt(4)
  v_pk_add_f32 v[8:9], v[8:9], v[52:53]
  v_pk_add_f32 v[10:11], v[10:11], v[54:55]
  v_cvt_pk_bf16_f32 v80, v8, v9
  v_cvt_pk_bf16_f32 v81, v10, v11
  v_pk_add_f32 v[12:13], v[12:13], v[36:37]
  v_pk_add_f32 v[14:15], v[14:15], v[38:39]
  s_waitcnt lgkmcnt(3)
  v_pk_add_f32 v[12:13], v[12:13], v[56:57]
  v_pk_add_f32 v[14:15], v[14:15], v[58:59]
  v_cvt_pk_bf16_f32 v82, v12, v13
  v_cvt_pk_bf16_f32 v83, v14, v15
  s_nop 0
  v_permlane16_swap_b32 v80, v82
  v_permlane16_swap_b32 v81, v83
  buffer_store_dwordx4 v[80:83], v29, s[20:23], s72 offen offset:0
  v_pk_add_f32 v[16:17], v[16:17], v[40:41]
  v_pk_add_f32 v[18:19], v[18:19], v[42:43]
  s_waitcnt lgkmcnt(2)
  v_pk_add_f32 v[16:17], v[16:17], v[60:61]
  v_pk_add_f32 v[18:19], v[18:19], v[62:63]
  v_cvt_pk_bf16_f32 v84, v16, v17
  v_cvt_pk_bf16_f32 v85, v18, v19
  v_pk_add_f32 v[20:21], v[20:21], v[44:45]
  v_pk_add_f32 v[22:23], v[22:23], v[46:47]
  s_waitcnt lgkmcnt(1)
  v_pk_add_f32 v[20:21], v[20:21], v[64:65]
  v_pk_add_f32 v[22:23], v[22:23], v[66:67]
  v_cvt_pk_bf16_f32 v86, v20, v21
  v_cvt_pk_bf16_f32 v87, v22, v23
  s_nop 0
  v_permlane16_swap_b32 v84, v86
  v_permlane16_swap_b32 v85, v87
  buffer_store_dwordx4 v[84:87], v29, s[20:23], s72 offen offset:64
  v_pk_add_f32 v[24:25], v[24:25], v[48:49]
  v_pk_add_f32 v[26:27], v[26:27], v[50:51]
  s_waitcnt lgkmcnt(0)
  v_pk_add_f32 v[24:25], v[24:25], v[68:69]
  v_pk_add_f32 v[26:27], v[26:27], v[70:71]
  v_cvt_pk_bf16_f32 v88, v24, v25
  v_cvt_pk_bf16_f32 v89, v26, v27
  buffer_store_dwordx2 v[88:89], v28, s[20:23], s71 offen
  s_branch K2_FIN
K2_P3_4:
  v_add_u32 v6, s66, v3
  v_add_u32 v7, 73728, v6
  ds_read_b128 v[128:131], v6 offset:0
  ds_read_b128 v[132:135], v6 offset:18432
  ds_read_b128 v[136:139], v6 offset:36864
  ds_read_b128 v[140:143], v6 offset:55296
  ds_read_b128 v[144:147], v6 offset:1024
  ds_read_b128 v[148:151], v6 offset:19456
  ds_read_b128 v[152:155], v6 offset:37888
  ds_read_b128 v[156:159], v6 offset:56320
  s_add_u32 s56, s68, 4096
  s_add_u32 s57, s69, 4096
  s_waitcnt vmcnt(8) lgkmcnt(7)
  v_mfma_f32_16x16x32_bf16 v[8:11], v[128:131], v[32:35], 0
  s_waitcnt lgkmcnt(6)
  v_mfma_f32_16x16x32_bf16 v[12:15], v[132:135], v[32:35], 0
  s_waitcnt lgkmcnt(5)
  v_mfma_f32_16x16x32_bf16 v[16:19], v[136:139], v[32:35], 0
  s_waitcnt lgkmcnt(4)
  v_mfma_f32_16x16x32_bf16 v[20:23], v[140:143], v[32:35], 0
  ds_read_b128 v[128:131], v6 offset:2048
  ds_read_b128 v[132:135], v6 offset:20480
  ds_read_b128 v[136:139], v6 offset:38912
  ds_read_b128 v[140:143], v6 offset:57344
  s_waitcnt vmcnt(7) lgkmcnt(7)
  v_mfma_f32_16x16x32_bf16 v[8:11], v[144:147], v[36:39], v[8:11]
  s_waitcnt lgkmcnt(6)
  v_mfma_f32_16x16x32_bf16 v[12:15], v[148:151], v[36:39], v[12:15]
  s_waitcnt lgkmcnt(5)
  v_mfma_f32_16x16x32_bf16 v[16:19], v[152:155], v[36:39], v[16:19]
  s_waitcnt lgkmcnt(4)
  v_mfma_f32_16x16x32_bf16 v[20:23], v[156:159], v[36:39], v[20:23]
  ds_read_b128 v[144:147], v6 offset:3072
  ds_read_b128 v[148:151], v6 offset:21504
  ds_read_b128 v[152:155], v6 offset:39936
  ds_read_b128 v[156:159], v6 offset:58368
  s_waitcnt vmcnt(6) lgkmcnt(7)
  v_mfma_f32_16x16x32_bf16 v[8:11], v[128:131], v[40:43], v[8:11]
  s_waitcnt lgkmcnt(6)
  v_mfma_f32_16x16x32_bf16 v[12:15], v[132:135], v[40:43], v[12:15]
  s_waitcnt lgkmcnt(5)
  v_mfma_f32_16x16x32_bf16 v[16:19], v[136:139], v[40:43], v[16:19]
  s_waitcnt lgkmcnt(4)
  v_mfma_f32_16x16x32_bf16 v[20:23], v[140:143], v[40:43], v[20:23]
  ds_read_b128 v[128:131], v6 offset:4096
  ds_read_b128 v[132:135], v6 offset:22528
  ds_read_b128 v[136:139], v6 offset:40960
  ds_read_b128 v[140:143], v6 offset:59392
  s_waitcnt vmcnt(5) lgkmcnt(7)
  v_mfma_f32_16x16x32_bf16 v[8:11], v[144:147], v[44:47], v[8:11]
  s_waitcnt lgkmcnt(6)
  v_mfma_f32_16x16x32_bf16 v[12:15], v[148:151], v[44:47], v[12:15]
  s_waitcnt lgkmcnt(5)
  v_mfma_f32_16x16x32_bf16 v[16:19], v[152:155], v[44:47], v[16:19]
  s_waitcnt lgkmcnt(4)
  v_mfma_f32_16x16x32_bf16 v[20:23], v[156:159], v[44:47], v[20:23]
  ds_read_b128 v[144:147], v6 offset:5120
  ds_read_b128 v[148:151], v6 offset:23552
  ds_read_b128 v[152:155], v6 offset:41984
  ds_read_b128 v[156:159], v6 offset:60416
  buffer_load_dwordx4 v[80:83], v3, s[16:19], s69 offen offset:0
  buffer_load_dwordx4 v[84:87], v3, s[16:19], s69 offen offset:1024
  s_waitcnt vmcnt(6) lgkmcnt(7)
  v_mfma_f32_16x16x32_bf16 v[8:11], v[128:131], v[48:51], v[8:11]
  s_waitcnt lgkmcnt(6)
  v_mfma_f32_16x16x32_bf16 v[12:15], v[132:135], v[48:51], v[12:15]
  s_waitcnt lgkmcnt(5)
  v_mfma_f32_16x16x32_bf16 v[16:19], v[136:139], v[48:51], v[16:19]
  s_waitcnt lgkmcnt(4)
  v_mfma_f32_16x16x32_bf16 v[20:23], v[140:143], v[48:51], v[20:23]
  buffer_load_dwordx4 v[88:91], v3, s[16:19], s69 offen offset:2048
  buffer_load_dwordx4 v[92:95], v3, s[16:19], s69 offen offset:3072
  s_waitcnt vmcnt(7) lgkmcnt(3)
  v_mfma_f32_16x16x32_bf16 v[8:11], v[144:147], v[52:55], v[8:11]
  s_waitcnt lgkmcnt(2)
  v_mfma_f32_16x16x32_bf16 v[12:15], v[148:151], v[52:55], v[12:15]
  s_waitcnt lgkmcnt(1)
  v_mfma_f32_16x16x32_bf16 v[16:19], v[152:155], v[52:55], v[16:19]
  s_waitcnt lgkmcnt(0)
  v_mfma_f32_16x16x32_bf16 v[20:23], v[156:159], v[52:55], v[20:23]
  buffer_load_dwordx4 v[96:99], v3, s[16:19], s57 offen offset:0
  buffer_load_dwordx4 v[100:103], v3, s[16:19], s57 offen offset:1024
  s_mov_b32 s20, s4
  s_mov_b32 s21, s5
  s_mov_b32 s22, 2359296
  s_mov_b32 s23, 0x00020000
  v_and_b32 v5, 15, v2
  v_lshrrev_b32 v31, 4, v2
  s_lshl_b32 s58, s73, 4
  v_add_u32 v5, s58, v5
  v_mul_u32_u24 v5, 1152, v5
  v_lshl_add_u32 v28, v31, 3, v5
  v_and_b32 v29, 1, v31
  v_lshl_add_u32 v5, v29, 5, v5
  v_lshrrev_b32 v29, 1, v31
  v_lshl_add_u32 v29, v29, 4, v5
  s_mov_b32 s60, 0
  s_waitcnt vmcnt(0)
  s_barrier
  ds_read_b128 v[128:131], v7 offset:0
  ds_read_b128 v[132:135], v7 offset:18432
  ds_read_b128 v[136:139], v7 offset:36864
  ds_read_b128 v[140:143], v7 offset:55296
  ds_read_b128 v[144:147], v7 offset:1024
  ds_read_b128 v[148:151], v7 offset:19456
  ds_read_b128 v[152:155], v7 offset:37888
  ds_read_b128 v[156:159], v7 offset:56320
  s_branch K2_P3CHK4
K2_P3RETRY4:
  s_add_u32 s56, s69, 0
  s_add_u32 s57, s69, 4096
  buffer_load_dwordx4 v[80:83], v3, s[16:19], s56 offen offset:0 sc1
  buffer_load_dwordx4 v[84:87], v3, s[16:19], s56 offen offset:1024 sc1
  buffer_load_dwordx4 v[88:91], v3, s[16:19], s56 offen offset:2048 sc1
  buffer_load_dwordx4 v[92:95], v3, s[16:19], s56 offen offset:3072 sc1
  buffer_load_dwordx4 v[96:99], v3, s[16:19], s57 offen offset:0 sc1
  buffer_load_dwordx4 v[100:103], v3, s[16:19], s57 offen offset:1024 sc1
  s_waitcnt vmcnt(0)
K2_P3CHK4:
  v_max3_u32 v31, v80, v81, v82
  v_max3_u32 v5, v83, v84, v85
  v_max3_u32 v31, v86, v87, v31
  v_max3_u32 v5, v88, v89, v5
  v_max3_u32 v31, v90, v91, v31
  v_max3_u32 v5, v92, v93, v5
  v_max3_u32 v31, v94, v95, v31
  v_max3_u32 v5, v96, v97, v5
  v_max3_u32 v31, v98, v99, v31
  v_max3_u32 v5, v100, v101, v5
  v_max3_u32 v31, v102, v103, v31
  v_max_u32 v31, v31, v5
  v_cmp_eq_u32 vcc, -1, v31
  s_add_u32 s60, s60, 1
  s_cmp_lt_u32 s60, 0x2000
  s_cselect_b64 s[76:77], -1, 0
  s_and_b64 vcc, vcc, s[76:77]
  s_cbranch_scc1 K2_P3RETRY4
  s_mul_i32 s58, s36, 5120
  v_add_u32 v6, s58, v3
  s_waitcnt lgkmcnt(7)
  v_mfma_f32_16x16x32_bf16 v[8:11], v[128:131], v[80:83], v[8:11]
  s_waitcnt lgkmcnt(6)
  v_mfma_f32_16x16x32_bf16 v[12:15], v[132:135], v[80:83], v[12:15]
  s_waitcnt lgkmcnt(5)
  v_mfma_f32_16x16x32_bf16 v[16:19], v[136:139], v[80:83], v[16:19]
  s_waitcnt lgkmcnt(4)
  v_mfma_f32_16x16x32_bf16 v[20:23], v[140:143], v[80:83], v[20:23]
  ds_read_b128 v[128:131], v7 offset:2048
  ds_read_b128 v[132:135], v7 offset:20480
  ds_read_b128 v[136:139], v7 offset:38912
  ds_read_b128 v[140:143], v7 offset:57344
  s_waitcnt lgkmcnt(7)
  v_mfma_f32_16x16x32_bf16 v[8:11], v[144:147], v[84:87], v[8:11]
  s_waitcnt lgkmcnt(6)
  v_mfma_f32_16x16x32_bf16 v[12:15], v[148:151], v[84:87], v[12:15]
  s_waitcnt lgkmcnt(5)
  v_mfma_f32_16x16x32_bf16 v[16:19], v[152:155], v[84:87], v[16:19]
  s_waitcnt lgkmcnt(4)
  v_mfma_f32_16x16x32_bf16 v[20:23], v[156:159], v[84:87], v[20:23]
  ds_read_b128 v[144:147], v7 offset:3072
  ds_read_b128 v[148:151], v7 offset:21504
  ds_read_b128 v[152:155], v7 offset:39936
  ds_read_b128 v[156:159], v7 offset:58368
  s_waitcnt lgkmcnt(7)
  v_mfma_f32_16x16x32_bf16 v[8:11], v[128:131], v[88:91], v[8:11]
  s_waitcnt lgkmcnt(6)
  v_mfma_f32_16x16x32_bf16 v[12:15], v[132:135], v[88:91], v[12:15]
  s_waitcnt lgkmcnt(5)
  v_mfma_f32_16x16x32_bf16 v[16:19], v[136:139], v[88:91], v[16:19]
  s_waitcnt lgkmcnt(4)
  v_mfma_f32_16x16x32_bf16 v[20:23], v[140:143], v[88:91], v[20:23]
  ds_read_b128 v[128:131], v7 offset:4096
  ds_read_b128 v[132:135], v7 offset:22528
  ds_read_b128 v[136:139], v7 offset:40960
  ds_read_b128 v[140:143], v7 offset:59392
  s_waitcnt lgkmcnt(7)
  v_mfma_f32_16x16x32_bf16 v[8:11], v[144:147], v[92:95], v[8:11]
  s_waitcnt lgkmcnt(6)
  v_mfma_f32_16x16x32_bf16 v[12:15], v[148:151], v[92:95], v[12:15]
  s_waitcnt lgkmcnt(5)
  v_mfma_f32_16x16x32_bf16 v[16:19], v[152:155], v[92:95], v[16:19]
  s_waitcnt lgkmcnt(4)
  v_mfma_f32_16x16x32_bf16 v[20:23], v[156:159], v[92:95], v[20:23]
  ds_read_b128 v[144:147], v7 offset:5120
  ds_read_b128 v[148:151], v7 offset:23552
  ds_read_b128 v[152:155], v7 offset:41984
  ds_read_b128 v[156:159], v7 offset:60416
  s_waitcnt lgkmcnt(7)
  v_mfma_f32_16x16x32_bf16 v[8:11], v[128:131], v[96:99], v[8:11]
  s_waitcnt lgkmcnt(6)
  v_mfma_f32_16x16x32_bf16 v[12:15], v[132:135], v[96:99], v[12:15]
  s_waitcnt lgkmcnt(5)
  v_mfma_f32_16x16x32_bf16 v[16:19], v[136:139], v[96:99], v[16:19]
  s_waitcnt lgkmcnt(4)
  v_mfma_f32_16x16x32_bf16 v[20:23], v[140:143], v[96:99], v[20:23]
  s_waitcnt lgkmcnt(3)
  v_mfma_f32_16x16x32_bf16 v[8:11], v[144:147], v[100:103], v[8:11]
  s_waitcnt lgkmcnt(2)
  v_mfma_f32_16x16x32_bf16 v[12:15], v[148:151], v[100:103], v[12:15]
  s_waitcnt lgkmcnt(1)
  v_mfma_f32_16x16x32_bf16 v[16:19], v[152:155], v[100:103], v[16:19]
  s_waitcnt lgkmcnt(0)
  v_mfma_f32_16x16x32_bf16 v[20:23], v[156:159], v[100:103], v[20:23]
  s_cmp_eq_u32 s66, 0
  s_cbranch_scc1 K2_P3R4
  ds_write_b128 v6, v[8:11] offset:0
  s_nop 0
  ds_write_b128 v6, v[12:15] offset:1024
  s_nop 0
  ds_write_b128 v6, v[16:19] offset:2048
  s_nop 0
  ds_write_b128 v6, v[20:23] offset:3072
  s_waitcnt lgkmcnt(0)
  s_barrier
  s_branch K2_FIN
K2_P3R4:
  s_barrier
  ds_read_b128 v[32:35], v6 offset:20480
  ds_read_b128 v[36:39], v6 offset:21504
  ds_read_b128 v[40:43], v6 offset:22528
  ds_read_b128 v[44:47], v6 offset:23552
  ds_read_b128 v[52:55], v6 offset:40960
  ds_read_b128 v[56:59], v6 offset:41984
  ds_read_b128 v[60:63], v6 offset:43008
  ds_read_b128 v[64:67], v6 offset:44032
  s_waitcnt lgkmcnt(7)
  v_pk_add_f32 v[8:9], v[8:9], v[32:33]
  v_pk_add_f32 v[10:11], v[10:11], v[34:35]
  s_waitcnt lgkmcnt(3)
  v_pk_add_f32 v[8:9], v[8:9], v[52:53]
  v_pk_add_f32 v[10:11], v[10:11], v[54:55]
  v_cvt_pk_bf16_f32 v80, v8, v9
  v_cvt_pk_bf16_f32 v81, v10, v11
  v_pk_add_f32 v[12:13], v[12:13], v[36:37]
  v_pk_add_f32 v[14:15], v[14:15], v[38:39]
  s_waitcnt lgkmcnt(2)
  v_pk_add_f32 v[12:13], v[12:13], v[56:57]
  v_pk_add_f32 v[14:15], v[14:15], v[58:59]
  v_cvt_pk_bf16_f32 v82, v12, v13
  v_cvt_pk_bf16_f32 v83, v14, v15
  s_nop 0
  v_permlane16_swap_b32 v80, v82
  v_permlane16_swap_b32 v81, v83
  buffer_store_dwordx4 v[80:83], v29, s[20:23], s72 offen offset:0
  v_pk_add_f32 v[16:17], v[16:17], v[40:41]
  v_pk_add_f32 v[18:19], v[18:19], v[42:43]
  s_waitcnt lgkmcnt(1)
  v_pk_add_f32 v[16:17], v[16:17], v[60:61]
  v_pk_add_f32 v[18:19], v[18:19], v[62:63]
  v_cvt_pk_bf16_f32 v84, v16, v17
  v_cvt_pk_bf16_f32 v85, v18, v19
  v_pk_add_f32 v[20:21], v[20:21], v[44:45]
  v_pk_add_f32 v[22:23], v[22:23], v[46:47]
  s_waitcnt lgkmcnt(0)
  v_pk_add_f32 v[20:21], v[20:21], v[64:65]
  v_pk_add_f32 v[22:23], v[22:23], v[66:67]
  v_cvt_pk_bf16_f32 v86, v20, v21
  v_cvt_pk_bf16_f32 v87, v22, v23
  s_nop 0
  v_permlane16_swap_b32 v84, v86
  v_permlane16_swap_b32 v85, v87
  buffer_store_dwordx4 v[84:87], v29, s[20:23], s72 offen offset:64
K2_FIN:
K2_END:
  s_endpgm
K2_TEXT_END:
.section .rodata,"a"
.p2align 6
.amdhsa_kernel gated_mix__mha_block__linear_attn_block__prompt_kernel
  .amdhsa_next_free_vgpr 168
  .amdhsa_next_free_sgpr 102
  .amdhsa_accum_offset 168
  .amdhsa_group_segment_fixed_size 0
  .amdhsa_kernarg_size 80
  .amdhsa_user_sgpr_count 2
  .amdhsa_user_sgpr_kernarg_segment_ptr 1
  .amdhsa_system_sgpr_workgroup_id_x 1
.end_amdhsa_kernel
```
